```python
import torch

def _softmax(x, axis=-1):
    return torch.softmax(x, dim=axis)
def _gelu(x):
    return torch.nn.functional.gelu(x, approximate="tanh")
def _silu(x):
    return torch.nn.functional.silu(x)
def _sigmoid(x):
    return torch.sigmoid(x)
def _layernorm(x, axis=-1, eps=1e-5):
    m = x.mean(dim=axis, keepdim=True)
    v = x.var(dim=axis, keepdim=True, unbiased=False)
    return (x - m) / torch.sqrt(v + eps)
def _scatter_add(tgt, idx, src, axis=0):
    return tgt.clone().index_add_(axis, idx, src)
def _segment_sum(src, seg, n):
    out = torch.zeros((n,) + src.shape[1:], dtype=src.dtype)
    return out.index_add_(0, seg, src)
def _pad(x, pw):
    flat = tuple(v for pair in reversed(pw) for v in pair)
    return torch.nn.functional.pad(x, flat)

kernel_name = 'gated_mix__ssm_conv_s4d__swiglu_ffn__prompt'

def setup_inputs():

    _w = (lambda a: (lambda t: t.to(torch.bfloat16) if t.is_floating_point() else t)(torch.as_tensor(a)))
    def _A_setup():
        Bsz, L, D, N = 1, 2048, 576, 128
        return {
            "u": _w((lambda *s: torch.randn(*s, dtype=torch.bfloat16) * 0.05)(Bsz, L, D)),
            "log_A_real": _w((lambda *s: torch.randn(*s, dtype=torch.bfloat16) * 6.4)(D, N) * 0.5),
            "A_imag": _w((lambda *s: torch.randn(*s, dtype=torch.bfloat16) * 0.05)(D, N) * 3.14),
            "C_real": _w((lambda *s: torch.randn(*s, dtype=torch.bfloat16) * 0.05)(D, N) / N ** 0.5),
            "C_imag": _w((lambda *s: torch.randn(*s, dtype=torch.bfloat16) * 0.05)(D, N) / N ** 0.5),
            "log_dt": _w((lambda *s: torch.randn(*s, dtype=torch.bfloat16) * 0.05)(D) * 0.5 - 4.0),
            "D_skip": _w((lambda *s: torch.randn(*s, dtype=torch.bfloat16) * 0.05)(D)),
        }
    _A_in = _A_setup()

    def _B_setup():
        B, S, D, F = 1, 2048, 576, 4608
        return {
            "x": _w((lambda *s: torch.randn(*s, dtype=torch.bfloat16) * 0.05)(B, S, D)),
            "w_gate": _w((lambda *s: torch.randn(*s, dtype=torch.bfloat16) * 0.05)(D, F)),
            "w_up": _w((lambda *s: torch.randn(*s, dtype=torch.bfloat16) * 0.05)(D, F)),
            "w_down": _w((lambda *s: torch.randn(*s, dtype=torch.bfloat16) * 0.05)(F, D)),
        }
    _B_in = _B_setup()

    return {
        "A_u": _A_in["u"],
        "A_log_A_real": _A_in["log_A_real"],
        "A_A_imag": _A_in["A_imag"],
        "A_C_real": _A_in["C_real"],
        "A_C_imag": _A_in["C_imag"],
        "A_log_dt": _A_in["log_dt"],
        "A_D_skip": _A_in["D_skip"],
        "B_x": _B_in["x"],
        "B_w_gate": _B_in["w_gate"],
        "B_w_up": _B_in["w_up"],
        "B_w_down": _B_in["w_down"],
        "gate_w": _w((lambda *s: torch.randn(*s, dtype=torch.bfloat16) * 0.05)(576) * 16.0),
    }

def reference(A_u, A_log_A_real, A_A_imag, A_C_real, A_C_imag, A_log_dt, A_D_skip, B_x, B_w_gate, B_w_up, B_w_down, gate_w):
    def _A_ref(u, log_A_real, A_imag, C_real, C_imag, log_dt, D_skip):
        L = u.shape[1]
        dt = torch.exp(log_dt)
        A = -torch.exp(log_A_real) + 1j * A_imag
        C = (C_real + 1j * C_imag) * dt[:, None]
        pos = (lambda x, dt: x.to(dt))(torch.arange(L), log_dt.dtype)
        P = torch.exp((A * dt[:, None])[:, :, None] * pos[None, None, :])
        K = 2.0 * torch.einsum("dn,dnl->dl", C, P).real
        L2 = 2 * L
        u_t = (lambda x, *d: x.permute(*d))(u, 0, 2, 1)
        Kf = (lambda x, *a, **k: torch.fft.rfft(x.float(), *a, **k))(K, L2)
        Uf = (lambda x, *a, **k: torch.fft.rfft(x.float(), *a, **k))(u_t, L2)
        y = (lambda x, *a, **k: torch.fft.irfft(x, *a, **k).to(torch.bfloat16))(Uf * Kf[None, :, :], L2)[:, :, :L]
        y = (lambda x, *d: x.permute(*d))(y, 0, 2, 1)
        return y + u * D_skip[None, None, :]

    def _B_ref(x, w_gate, w_up, w_down):
        g = _silu(x @ w_gate)
        u = x @ w_up
        return (g * u) @ w_down

    x = A_u
    g = _sigmoid((x * gate_w).sum(-1, keepdims=True))
    a = _A_ref(x, A_log_A_real, A_A_imag, A_C_real, A_C_imag, A_log_dt, A_D_skip)
    b = _B_ref(x, B_w_gate, B_w_up, B_w_down)
    return g * a + (1 - g) * b
```

```asm
; @launch grid=(256,1,1) block=(256,1,1) lds=163840
.amdgcn_target "amdgcn-amd-amdhsa--gfx950"
.text
.p2align 12
.globl gated_mix__ssm_conv_s4d__swiglu_ffn__prompt_kernel
.p2align 8
.type gated_mix__ssm_conv_s4d__swiglu_ffn__prompt_kernel,@function
gated_mix__ssm_conv_s4d__swiglu_ffn__prompt_kernel:
s_cmp_ge_u32 s2, 256
s_cbranch_scc1 KF_done
s_load_dwordx2 s[4:5], s[0:1], 0
s_load_dwordx2 s[8:9], s[0:1], 64
s_load_dwordx2 s[12:13], s[0:1], 72
s_getpc_b64 s[44:45]
KF_pc:
s_bfe_u32 s56, s2, 0x30003
s_lshl_b32 s56, s56, 13
v_lshrrev_b32 v2, 2, v0
v_lshl_add_u32 v2, v2, 7, s56
v_min_u32 v2, KF_done-KF_pc, v2
global_load_dword v212, v2, s[44:45]
v_lshrrev_b32 v2, 6, v0
v_and_b32 v1, 63, v0
v_readfirstlane_b32 s3, v2
s_load_dwordx8 s[28:35], s[0:1], 8
s_load_dwordx4 s[36:39], s[0:1], 40
s_load_dwordx2 s[20:21], s[0:1], 112
s_load_dwordx4 s[40:43], s[0:1], 88
s_load_dwordx2 s[16:17], s[0:1], 80
s_load_dwordx2 s[24:25], s[0:1], 104
s_mov_b32 s6, 2359296
s_mov_b32 s7, 0x00020000
s_lshr_b32 s57, s2, 3
s_mul_i32 s58, s57, 43
s_lshr_b32 s58, s58, 7
s_mul_i32 s58, s58, 3
s_sub_u32 s57, s57, s58
s_mov_b32 s54, 0x76543210
s_cmp_eq_u32 s57, 1
s_cselect_b32 s54, 0x87354021, s54
s_mov_b32 s55, 88285448
s_cselect_b32 s55, 55837206, s55
s_cmp_eq_u32 s57, 2
s_cselect_b32 s54, 0x68435102, s54
s_cselect_b32 s55, 70586407, s55
s_lshl_b32 s57, s2, 2
s_lshr_b32 s57, 0x2100210, s57
s_and_b32 s57, s57, 3
s_mul_i32 s57, s57, 12
s_lshr_b64 s[54:55], s[54:55], s57
s_lshr_b32 s57, s54, 12
s_xor_b32 s57, s57, s54
s_and_b32 s57, s57, 0xfff
s_bfe_u32 s58, s2, 0x10002
s_mul_i32 s58, s58, 0x1001
s_mul_i32 s57, s57, s58
s_xor_b32 s54, s54, s57
s_and_b32 s60, s2, 7
s_mul_i32 s60, s60, 24
s_lshr_b32 s69, s2, 3
s_min_u32 s69, s69, 23
s_add_u32 s60, s60, s69
s_mul_i32 s70, s60, 768
s_mul_i32 s69, s60, 6
s_and_b32 s69, s69, 0xfffc
s_lshr_b32 s56, s2, 6
s_and_b32 s57, s2, 4
s_add_u32 s56, s56, s57
s_lshl2_add_u32 s58, s56, s3
s_mul_i32 s44, s58, 73728
s_add_u32 s45, s44, 18432
s_add_u32 s46, s44, 36864
s_add_u32 s47, s44, 55296
s_lshl_b32 s72, s3, 14
s_add_u32 s72, s72, 98304
v_lshrrev_b32 v215, 3, v1
v_mul_u32_u24 v2, 1152, v215
v_lshrrev_b32 v3, 4, v1
v_xor_b32 v3, v3, v1
v_and_b32 v3, 7, v3
v_lshl_add_u32 v224, v3, 4, v2
v_xor_b32 v2, 64, v224
v_add_u32 v225, 8192, v2
v_lshl_add_u32 v2, v1, 2, s70
s_waitcnt lgkmcnt(0)
s_load_dwordx2 s[36:37], s[36:37], s69
s_load_dwordx2 s[38:39], s[38:39], s69
s_cmp_ge_u32 s2, 192
s_cbranch_scc1 KF_pre1
global_load_dword v236, v2, s[28:29] offset:0
global_load_dword v237, v2, s[30:31] offset:0
global_load_dword v238, v2, s[32:33] offset:0
global_load_dword v239, v2, s[34:35] offset:0
global_load_dword v240, v2, s[28:29] offset:256
global_load_dword v241, v2, s[30:31] offset:256
global_load_dword v242, v2, s[32:33] offset:256
global_load_dword v243, v2, s[34:35] offset:256
global_load_dword v244, v2, s[28:29] offset:512
global_load_dword v245, v2, s[30:31] offset:512
global_load_dword v246, v2, s[32:33] offset:512
global_load_dword v247, v2, s[34:35] offset:512
KF_pre1_ret:
s_bfe_u32 s65, s54, 0x40000
s_lshl_b32 s65, s65, 7
s_add_u32 m0, s72, 0
s_add_u32 s70, s44, s65
buffer_load_dwordx4 v224, s[4:7], s70 offen offset:0  lds
buffer_load_dwordx4 v225, s[4:7], s70 offen offset:1024  lds
s_add_u32 m0, s72, 2048
s_add_u32 s70, s45, s65
buffer_load_dwordx4 v224, s[4:7], s70 offen offset:0  lds
buffer_load_dwordx4 v225, s[4:7], s70 offen offset:1024  lds
s_add_u32 m0, s72, 4096
s_add_u32 s70, s46, s65
buffer_load_dwordx4 v224, s[4:7], s70 offen offset:0  lds
buffer_load_dwordx4 v225, s[4:7], s70 offen offset:1024  lds
s_add_u32 m0, s72, 6144
s_add_u32 s70, s47, s65
buffer_load_dwordx4 v224, s[4:7], s70 offen offset:0  lds
buffer_load_dwordx4 v225, s[4:7], s70 offen offset:1024  lds
s_mov_b32 s10, 5308416
s_mov_b32 s11, 0x00020000
s_mov_b32 s14, 5308416
s_mov_b32 s15, 0x00020000
s_and_b32 s57, s2, 3
s_bfe_u32 s69, s2, 0x10005
s_lshl1_add_u32 s57, s57, s69
s_bfe_u32 s59, s2, 0x20003
s_mul_i32 s68, s57, 1152
s_lshl_b32 s69, s59, 8
s_add_u32 s62, s68, s69
s_add_u32 s63, s62, 128
s_and_b32 s69, s57, 1
s_lshl_b32 s69, s69, 7
s_add_u32 s62, s62, s69
s_sub_u32 s63, s63, s69
s_lshl_b32 s71, s3, 11
s_lshl_b32 s69, s3, 4
v_add_u32 v2, s69, v215
v_mul_u32_u24 v2, 9216, v2
v_bfe_u32 v3, v1, 4, 1
v_lshlrev_b32 v3, 1, v3
v_xor_b32 v3, v3, v1
v_and_b32 v3, 7, v3
v_lshl_add_u32 v221, v3, 4, v2
v_xor_b32 v2, 64, v221
v_add_u32 v222, 72704, v2
s_bfe_u32 s69, s54, 0x40000
s_mul_i32 s69, s69, 589824
s_add_u32 s69, s69, s62
s_add_u32 m0, s71, 0
s_nop 0
buffer_load_dwordx4 v221, s[8:11], s69 offen offset:0  lds
buffer_load_dwordx4 v222, s[8:11], s69 offen offset:1024  lds
s_mov_b32 s73, 1
s_cmp_eq_u32 s3, 0
s_cbranch_scc1 PAD_0
s_cmp_eq_u32 s3, 1
s_cbranch_scc1 PAD_1
s_cmp_eq_u32 s3, 2
s_cbranch_scc1 PAD_2
s_branch PAD_3
PAD_ret:
s_mov_b32 s73, 0
s_bfe_u32 s69, s54, 0x40000
s_mul_i32 s69, s69, 589824
s_add_u32 s69, s69, s62
s_add_u32 m0, s71, 8192
s_nop 0
buffer_load_dwordx4 v221, s[12:15], s69 offen offset:0  lds
buffer_load_dwordx4 v222, s[12:15], s69 offen offset:1024  lds
s_bfe_u32 s69, s54, 0x40004
s_mul_i32 s69, s69, 589824
s_add_u32 s69, s69, s62
s_add_u32 m0, s71, 16384
s_nop 0
buffer_load_dwordx4 v221, s[8:11], s69 offen offset:0  lds
buffer_load_dwordx4 v222, s[8:11], s69 offen offset:1024  lds
s_mov_b32 s18, 5308416
s_mov_b32 s19, 0x00020000
s_mov_b32 s22, 268435456
s_mov_b32 s23, 0x00020000
s_mov_b32 s26, 256
s_mov_b32 s27, 0x00020000
s_mov_b32 s74, 0xbfb8aa3b
s_mov_b32 s75, 0.15915494
s_lshr_b32 s58, s3, 1
s_mul_i32 s28, s58, 0x43800000
s_lshl_b32 s29, s3, 23
s_add_u32 s29, s29, 0x3f000000
s_cmp_eq_u32 s3, 0
s_cselect_b32 s29, 0x41800000, s29
s_cselect_b64 s[52:53], -1, 0
v_lshrrev_b32 v2, 4, v1
v_lshlrev_b32 v2, 10, v2
v_bfe_u32 v3, v1, 2, 2
v_lshl_add_u32 v2, v3, 7, v2
v_and_b32 v3, 3, v1
v_lshl_add_u32 v2, v3, 3, v2
v_bfe_u32 v3, v1, 3, 2
v_lshl_add_u32 v216, v3, 5, v2
v_xor_b32 v217, 32, v216
v_xor_b32 v218, 64, v216
v_xor_b32 v219, 0x60, v216
v_lshrrev_b32 v3, 5, v1
v_mul_u32_u24 v3, 2, v3
v_lshl_add_u32 v3, v215, 1, v3
v_lshlrev_b32 v231, 7, v3
v_lshrrev_b32 v215, 4, v1
s_bfe_u32 s31, s54, 0x40018
s_mul_i32 s31, s31, 43
s_lshr_b32 s31, s31, 7
s_bfe_u32 s58, s2, 0x10002
s_lshl1_add_u32 s31, s31, s58
s_mul_i32 s31, s31, 24
s_lshr_b32 s58, s2, 3
s_min_u32 s58, s58, 23
s_add_u32 s31, s31, s58
s_lshl2_add_u32 s31, s31, s3
s_mul_i32 s31, s31, 9216
s_and_b32 s58, s2, 3
s_mul_i32 s58, s58, 2304
s_add_u32 s31, s31, s58
v_and_b32 v2, 15, v1
v_lshrrev_b32 v3, 1, v2
v_xor_b32 v3, v3, v215
v_lshlrev_b32 v3, 4, v3
v_lshl_add_u32 v3, v2, 7, v3
v_add_u32 v226, s72, v3
v_xor_b32 v227, 64, v226
s_waitcnt lgkmcnt(0)
s_and_b32 s56, s60, 1
s_lshl_b32 s57, s56, 4
s_lshr_b64 s[36:37], s[36:37], s57
s_min_u32 s57, s3, 2
s_add_u32 s57, s57, s56
s_lshl_b32 s57, s57, 4
s_lshr_b64 s[38:39], s[38:39], s57
s_lshl_b32 s38, s38, 16
s_lshl_b32 s39, s37, 16
s_and_b32 s37, s36, 0xffff0000
s_lshl_b32 s36, s36, 16
s_cmp_ge_u32 s2, 192
s_cbranch_scc1 KF_pre2
s_waitcnt vmcnt(22)
v_mov_b32 v36, s36
v_lshlrev_b32 v44, 16, v236
v_and_b32 v45, 0xffff0000, v236
v_mul_f32 v36, s74, v36
v_pk_mul_f32 v[44:45], v[44:45], s[74:75] op_sel:[0,0] op_sel_hi:[1,0]
v_exp_f32 v36, -v36
v_exp_f32 v44, -v44
v_exp_f32 v45, -v45
v_lshlrev_b32 v41, 16, v237
v_and_b32 v43, 0xffff0000, v237
v_cvt_pk_bf16_f32 v36, 0, v36
v_cvt_pk_bf16_f32 v40, 0, v44
v_cvt_pk_bf16_f32 v42, 0, v45
v_pk_mul_f32 v[40:41], v[40:41], v[36:37] op_sel:[0,0] op_sel_hi:[1,0]
v_pk_mul_f32 v[42:43], v[42:43], v[36:37] op_sel:[0,0] op_sel_hi:[1,0]
v_pk_mul_f32 v[40:41], v[40:41], s[74:75]
v_pk_mul_f32 v[42:43], v[42:43], s[74:75]
v_add_f32 v36, v36, v36
v_pk_mul_f32 v[44:45], v[40:41], s[28:29] op_sel:[0,0] op_sel_hi:[1,0]
v_pk_mul_f32 v[46:47], v[42:43], s[28:29] op_sel:[0,0] op_sel_hi:[1,0]
v_pk_mul_f32 v[48:49], v[40:41], s[28:29] op_sel:[0,1] op_sel_hi:[1,1]
v_pk_mul_f32 v[50:51], v[42:43], s[28:29] op_sel:[0,1] op_sel_hi:[1,1]
v_fract_f32 v45, v45
v_fract_f32 v47, v47
v_fract_f32 v49, v49
v_fract_f32 v51, v51
v_exp_f32 v44, v44
v_exp_f32 v46, v46
v_exp_f32 v48, v48
v_exp_f32 v50, v50
v_cos_f32 v188, v45
v_sin_f32 v189, v45
v_cos_f32 v190, v47
v_sin_f32 v191, v47
v_cos_f32 v192, v49
v_sin_f32 v193, v49
v_cos_f32 v194, v51
v_sin_f32 v195, v51
v_lshlrev_b32 v236, 16, v238
v_lshlrev_b32 v237, 16, v239
v_and_b32 v238, 0xffff0000, v238
v_and_b32 v239, 0xffff0000, v239
v_pk_mul_f32 v[236:237], v[236:237], v[36:37] op_sel:[0,0] op_sel_hi:[1,0]
v_pk_mul_f32 v[238:239], v[238:239], v[36:37] op_sel:[0,0] op_sel_hi:[1,0]
v_pk_mul_f32 v[188:189], v[188:189], v[44:45] op_sel:[0,0] op_sel_hi:[1,0]
v_pk_mul_f32 v[190:191], v[190:191], v[46:47] op_sel:[0,0] op_sel_hi:[1,0]
v_pk_mul_f32 v[192:193], v[192:193], v[48:49] op_sel:[0,0] op_sel_hi:[1,0]
v_pk_mul_f32 v[194:195], v[194:195], v[50:51] op_sel:[0,0] op_sel_hi:[1,0]
v_cndmask_b32 v188, v188, v236, s[52:53]
v_cndmask_b32 v189, v189, v237, s[52:53]
v_cndmask_b32 v190, v190, v238, s[52:53]
v_cndmask_b32 v191, v191, v239, s[52:53]
s_bfe_u32 s65, s54, 0x40004
s_lshl_b32 s65, s65, 7
s_add_u32 m0, s72, 8192
s_add_u32 s70, s44, s65
buffer_load_dwordx4 v224, s[4:7], s70 offen offset:0  lds
buffer_load_dwordx4 v225, s[4:7], s70 offen offset:1024  lds
s_add_u32 m0, s72, 10240
s_add_u32 s70, s45, s65
buffer_load_dwordx4 v224, s[4:7], s70 offen offset:0  lds
buffer_load_dwordx4 v225, s[4:7], s70 offen offset:1024  lds
s_waitcnt vmcnt(22)
v_mov_b32 v36, s37
v_lshlrev_b32 v44, 16, v240
v_and_b32 v45, 0xffff0000, v240
v_mul_f32 v36, s74, v36
v_pk_mul_f32 v[44:45], v[44:45], s[74:75] op_sel:[0,0] op_sel_hi:[1,0]
v_exp_f32 v36, -v36
v_exp_f32 v44, -v44
v_exp_f32 v45, -v45
v_lshlrev_b32 v41, 16, v241
v_and_b32 v43, 0xffff0000, v241
v_cvt_pk_bf16_f32 v36, 0, v36
v_cvt_pk_bf16_f32 v40, 0, v44
v_cvt_pk_bf16_f32 v42, 0, v45
v_pk_mul_f32 v[40:41], v[40:41], v[36:37] op_sel:[0,0] op_sel_hi:[1,0]
v_pk_mul_f32 v[42:43], v[42:43], v[36:37] op_sel:[0,0] op_sel_hi:[1,0]
v_pk_mul_f32 v[40:41], v[40:41], s[74:75]
v_pk_mul_f32 v[42:43], v[42:43], s[74:75]
v_add_f32 v36, v36, v36
v_pk_mul_f32 v[44:45], v[40:41], s[28:29] op_sel:[0,0] op_sel_hi:[1,0]
v_pk_mul_f32 v[46:47], v[42:43], s[28:29] op_sel:[0,0] op_sel_hi:[1,0]
v_pk_mul_f32 v[48:49], v[40:41], s[28:29] op_sel:[0,1] op_sel_hi:[1,1]
v_pk_mul_f32 v[50:51], v[42:43], s[28:29] op_sel:[0,1] op_sel_hi:[1,1]
v_fract_f32 v45, v45
v_fract_f32 v47, v47
v_fract_f32 v49, v49
v_fract_f32 v51, v51
v_exp_f32 v44, v44
v_exp_f32 v46, v46
v_exp_f32 v48, v48
v_exp_f32 v50, v50
v_cos_f32 v196, v45
v_sin_f32 v197, v45
v_cos_f32 v198, v47
v_sin_f32 v199, v47
v_cos_f32 v200, v49
v_sin_f32 v201, v49
v_cos_f32 v202, v51
v_sin_f32 v203, v51
v_lshlrev_b32 v240, 16, v242
v_lshlrev_b32 v241, 16, v243
v_and_b32 v242, 0xffff0000, v242
v_and_b32 v243, 0xffff0000, v243
v_pk_mul_f32 v[240:241], v[240:241], v[36:37] op_sel:[0,0] op_sel_hi:[1,0]
v_pk_mul_f32 v[242:243], v[242:243], v[36:37] op_sel:[0,0] op_sel_hi:[1,0]
v_pk_mul_f32 v[196:197], v[196:197], v[44:45] op_sel:[0,0] op_sel_hi:[1,0]
v_pk_mul_f32 v[198:199], v[198:199], v[46:47] op_sel:[0,0] op_sel_hi:[1,0]
v_pk_mul_f32 v[200:201], v[200:201], v[48:49] op_sel:[0,0] op_sel_hi:[1,0]
v_pk_mul_f32 v[202:203], v[202:203], v[50:51] op_sel:[0,0] op_sel_hi:[1,0]
v_cndmask_b32 v196, v196, v240, s[52:53]
v_cndmask_b32 v197, v197, v241, s[52:53]
v_cndmask_b32 v198, v198, v242, s[52:53]
v_cndmask_b32 v199, v199, v243, s[52:53]
s_add_u32 m0, s72, 12288
s_add_u32 s70, s46, s65
buffer_load_dwordx4 v224, s[4:7], s70 offen offset:0  lds
buffer_load_dwordx4 v225, s[4:7], s70 offen offset:1024  lds
s_add_u32 m0, s72, 14336
s_add_u32 s70, s47, s65
buffer_load_dwordx4 v224, s[4:7], s70 offen offset:0  lds
buffer_load_dwordx4 v225, s[4:7], s70 offen offset:1024  lds
s_waitcnt vmcnt(22)
v_mov_b32 v36, s39
v_lshlrev_b32 v44, 16, v244
v_and_b32 v45, 0xffff0000, v244
v_mul_f32 v36, s74, v36
v_pk_mul_f32 v[44:45], v[44:45], s[74:75] op_sel:[0,0] op_sel_hi:[1,0]
v_exp_f32 v36, -v36
v_exp_f32 v44, -v44
v_exp_f32 v45, -v45
v_lshlrev_b32 v41, 16, v245
v_and_b32 v43, 0xffff0000, v245
v_cvt_pk_bf16_f32 v36, 0, v36
v_cvt_pk_bf16_f32 v40, 0, v44
v_cvt_pk_bf16_f32 v42, 0, v45
v_pk_mul_f32 v[40:41], v[40:41], v[36:37] op_sel:[0,0] op_sel_hi:[1,0]
v_pk_mul_f32 v[42:43], v[42:43], v[36:37] op_sel:[0,0] op_sel_hi:[1,0]
v_pk_mul_f32 v[40:41], v[40:41], s[74:75]
v_pk_mul_f32 v[42:43], v[42:43], s[74:75]
v_add_f32 v36, v36, v36
v_pk_mul_f32 v[44:45], v[40:41], s[28:29] op_sel:[0,0] op_sel_hi:[1,0]
v_pk_mul_f32 v[46:47], v[42:43], s[28:29] op_sel:[0,0] op_sel_hi:[1,0]
v_pk_mul_f32 v[48:49], v[40:41], s[28:29] op_sel:[0,1] op_sel_hi:[1,1]
v_pk_mul_f32 v[50:51], v[42:43], s[28:29] op_sel:[0,1] op_sel_hi:[1,1]
v_fract_f32 v45, v45
v_fract_f32 v47, v47
v_fract_f32 v49, v49
v_fract_f32 v51, v51
v_exp_f32 v44, v44
v_exp_f32 v46, v46
v_exp_f32 v48, v48
v_exp_f32 v50, v50
v_cos_f32 v204, v45
v_sin_f32 v205, v45
v_cos_f32 v206, v47
v_sin_f32 v207, v47
v_cos_f32 v208, v49
v_sin_f32 v209, v49
v_cos_f32 v210, v51
v_sin_f32 v211, v51
v_lshlrev_b32 v244, 16, v246
v_lshlrev_b32 v245, 16, v247
v_and_b32 v246, 0xffff0000, v246
v_and_b32 v247, 0xffff0000, v247
v_pk_mul_f32 v[244:245], v[244:245], v[36:37] op_sel:[0,0] op_sel_hi:[1,0]
v_pk_mul_f32 v[246:247], v[246:247], v[36:37] op_sel:[0,0] op_sel_hi:[1,0]
v_pk_mul_f32 v[204:205], v[204:205], v[44:45] op_sel:[0,0] op_sel_hi:[1,0]
v_pk_mul_f32 v[206:207], v[206:207], v[46:47] op_sel:[0,0] op_sel_hi:[1,0]
v_pk_mul_f32 v[208:209], v[208:209], v[48:49] op_sel:[0,0] op_sel_hi:[1,0]
v_pk_mul_f32 v[210:211], v[210:211], v[50:51] op_sel:[0,0] op_sel_hi:[1,0]
v_cndmask_b32 v204, v204, v244, s[52:53]
v_cndmask_b32 v205, v205, v245, s[52:53]
v_cndmask_b32 v206, v206, v246, s[52:53]
v_cndmask_b32 v207, v207, v247, s[52:53]
KF_pre2_ret:
s_waitcnt vmcnt(20)
ds_read_b128 a[0:3], v226 offset:0
ds_read_b128 a[16:19], v227 offset:0
s_waitcnt vmcnt(18)
ds_read_b128 a[4:7], v226 offset:2048
ds_read_b128 a[20:23], v227 offset:2048
s_waitcnt vmcnt(16)
ds_read_b128 a[8:11], v226 offset:4096
ds_read_b128 a[24:27], v227 offset:4096
s_waitcnt vmcnt(14)
ds_read_b128 a[12:15], v226 offset:6144
ds_read_b128 a[28:31], v227 offset:6144
s_waitcnt vmcnt(8)
s_barrier
ds_read_b64_tr_b16 v[164:165], v216 offset:0
ds_read_b64_tr_b16 v[166:167], v216 offset:512
ds_read_b64_tr_b16 v[168:169], v216 offset:4096
ds_read_b64_tr_b16 v[170:171], v216 offset:4608
ds_read_b64_tr_b16 v[172:173], v217 offset:0
ds_read_b64_tr_b16 v[174:175], v217 offset:512
ds_read_b64_tr_b16 v[176:177], v217 offset:4096
ds_read_b64_tr_b16 v[178:179], v217 offset:4608
s_waitcnt lgkmcnt(4)
v_mfma_f32_16x16x32_bf16 v[36:39], v[164:167], a[0:3], 0
s_bfe_u32 s69, s54, 0x40004
ds_read_b64_tr_b16 v[180:181], v218 offset:0
v_mov_b32 v214, 0
v_mfma_f32_16x16x32_bf16 v[36:39], v[168:171], a[16:19], v[36:39]
s_mul_i32 s69, s69, 589824
v_mov_b32 v213, 1
s_add_u32 s69, s69, s62
v_mfma_f32_16x16x32_bf16 v[40:43], v[168:171], a[20:23], 0
s_add_u32 m0, s71, 24576
ds_read_b64_tr_b16 v[182:183], v218 offset:512
s_bfe_u32 s65, s54, 0x40008
v_mfma_f32_16x16x32_bf16 v[40:43], v[164:167], a[4:7], v[40:43]
s_lshl_b32 s65, s65, 7
buffer_load_dwordx4 v221, s[12:15], s69 offen offset:0  lds
v_mfma_f32_16x16x32_bf16 v[44:47], v[164:167], a[8:11], 0
s_add_u32 s70, s44, s65
ds_read_b64_tr_b16 v[184:185], v218 offset:4096
s_lshl_b32 s56, s59, 5
v_mfma_f32_16x16x32_bf16 v[44:47], v[168:171], a[24:27], v[44:47]
s_add_u32 s68, s68, s56
buffer_load_dwordx4 v222, s[12:15], s69 offen offset:1024  lds
v_mfma_f32_16x16x32_bf16 v[48:51], v[168:171], a[28:31], 0
s_add_u32 m0, s72, 0
ds_read_b64_tr_b16 v[186:187], v218 offset:4608
s_bfe_u32 s69, s54, 0x40008
v_mfma_f32_16x16x32_bf16 v[48:51], v[164:167], a[12:15], v[48:51]
s_waitcnt lgkmcnt(4)
buffer_load_dwordx4 v224, s[4:7], s70 offen offset:0  lds
v_mfma_f32_16x16x32_bf16 v[52:55], v[172:175], a[0:3], 0
s_mul_i32 s69, s69, 589824
ds_read_b64_tr_b16 v[164:165], v219 offset:0
s_add_u32 s69, s69, s62
v_mfma_f32_16x16x32_bf16 v[52:55], v[176:179], a[16:19], v[52:55]
s_add_u32 s68, s68, 1024
buffer_load_dwordx4 v225, s[4:7], s70 offen offset:1024  lds
v_mfma_f32_16x16x32_bf16 v[56:59], v[176:179], a[20:23], 0
s_add_u32 m0, s71, 32768
ds_read_b64_tr_b16 v[166:167], v219 offset:512
s_add_u32 s70, s45, s65
v_mfma_f32_16x16x32_bf16 v[56:59], v[172:175], a[4:7], v[56:59]
s_lshr_b32 s56, s2, 6
buffer_load_dwordx4 v221, s[8:11], s69 offen offset:0  lds
v_mfma_f32_16x16x32_bf16 v[60:63], v[172:175], a[8:11], 0
s_and_b32 s57, s2, 4
ds_read_b64_tr_b16 v[168:169], v219 offset:4096
s_add_u32 s56, s56, s57
v_mfma_f32_16x16x32_bf16 v[60:63], v[176:179], a[24:27], v[60:63]
s_and_b32 s57, s2, 3
buffer_load_dwordx4 v222, s[8:11], s69 offen offset:1024  lds
v_mfma_f32_16x16x32_bf16 v[64:67], v[176:179], a[28:31], 0
s_add_u32 m0, s72, 2048
ds_read_b64_tr_b16 v[170:171], v219 offset:4608
s_bfe_u32 s69, s54, 0x40008
v_mfma_f32_16x16x32_bf16 v[64:67], v[172:175], a[12:15], v[64:67]
s_waitcnt lgkmcnt(4)
buffer_load_dwordx4 v224, s[4:7], s70 offen offset:0  lds
v_mfma_f32_16x16x32_bf16 v[68:71], v[180:183], a[0:3], 0
s_mul_i32 s69, s69, 589824
ds_read_b64_tr_b16 v[172:173], v216 offset:8192
s_add_u32 s69, s69, s62
v_mfma_f32_16x16x32_bf16 v[68:71], v[184:187], a[16:19], v[68:71]
s_bfe_u32 s58, s2, 0x10005
buffer_load_dwordx4 v225, s[4:7], s70 offen offset:1024  lds
v_mfma_f32_16x16x32_bf16 v[72:75], v[184:187], a[20:23], 0
s_add_u32 m0, s71, 40960
ds_read_b64_tr_b16 v[174:175], v216 offset:8704
s_add_u32 s70, s46, s65
v_mfma_f32_16x16x32_bf16 v[72:75], v[180:183], a[4:7], v[72:75]
s_lshl1_add_u32 s57, s57, s58
buffer_load_dwordx4 v221, s[12:15], s69 offen offset:0  lds
v_mfma_f32_16x16x32_bf16 v[76:79], v[180:183], a[8:11], 0
s_lshl3_add_u32 s76, s56, s57
ds_read_b64_tr_b16 v[176:177], v216 offset:12288
s_lshl2_add_u32 s76, s76, s3
v_mfma_f32_16x16x32_bf16 v[76:79], v[184:187], a[24:27], v[76:79]
s_lshl_b32 s76, s76, 7
buffer_load_dwordx4 v222, s[12:15], s69 offen offset:1024  lds
v_mfma_f32_16x16x32_bf16 v[80:83], v[184:187], a[28:31], 0
s_add_u32 m0, s72, 4096
ds_read_b64_tr_b16 v[178:179], v216 offset:12800
s_lshl2_add_u32 s76, s59, s76
v_mfma_f32_16x16x32_bf16 v[80:83], v[180:183], a[12:15], v[80:83]
s_waitcnt lgkmcnt(4)
buffer_load_dwordx4 v224, s[4:7], s70 offen offset:0  lds
v_mfma_f32_16x16x32_bf16 v[84:87], v[164:167], a[0:3], 0
s_add_u32 s76, s76, 47185920
ds_read_b64_tr_b16 v[180:181], v217 offset:8192
s_lshl2_add_u32 s58, s56, s3
v_mfma_f32_16x16x32_bf16 v[84:87], v[168:171], a[16:19], v[84:87]
s_lshl_b32 s58, s58, 5
buffer_load_dwordx4 v225, s[4:7], s70 offen offset:1024  lds
v_mfma_f32_16x16x32_bf16 v[88:91], v[168:171], a[20:23], 0
s_add_u32 m0, s72, 6144
ds_read_b64_tr_b16 v[182:183], v217 offset:8704
s_add_u32 s70, s47, s65
v_mfma_f32_16x16x32_bf16 v[88:91], v[164:167], a[4:7], v[88:91]
s_waitcnt vmcnt(18)
ds_read_b128 a[32:35], v226 offset:8192
s_bfe_u32 s65, s54, 0x4000c
v_mfma_f32_16x16x32_bf16 v[92:95], v[164:167], a[8:11], 0
PAD_0:
s_cmp_lg_u32 s73, 0
s_cbranch_scc1 PAD_4
s_lshl_b32 s65, s65, 7
ds_read_b64_tr_b16 v[184:185], v217 offset:12288
s_add_u32 s58, s58, s57
v_mfma_f32_16x16x32_bf16 v[92:95], v[168:171], a[24:27], v[92:95]
s_mul_i32 s48, s58, 18432
ds_read_b128 a[48:51], v227 offset:8192
s_add_u32 s48, s48, 1048576
v_mfma_f32_16x16x32_bf16 v[96:99], v[168:171], a[28:31], 0
s_add_u32 s49, s48, 147456
ds_read_b64_tr_b16 v[186:187], v217 offset:12800
s_add_u32 s50, s48, 294912
v_mfma_f32_16x16x32_bf16 v[96:99], v[164:167], a[12:15], v[96:99]
s_waitcnt lgkmcnt(6)
buffer_load_dwordx4 v224, s[4:7], s70 offen offset:0  lds
v_mfma_f32_16x16x32_bf16 v[100:103], v[172:175], a[0:3], 0
s_add_u32 s51, s48, 442368
ds_read_b64_tr_b16 v[164:165], v218 offset:8192
s_mul_i32 s77, s60, 3
v_mfma_f32_16x16x32_bf16 v[100:103], v[176:179], a[16:19], v[100:103]
s_add_u32 s77, s77, s3
buffer_load_dwordx4 v225, s[4:7], s70 offen offset:1024  lds
v_mfma_f32_16x16x32_bf16 v[104:107], v[176:179], a[20:23], 0
s_add_u32 m0, s72, 8192
ds_read_b64_tr_b16 v[166:167], v218 offset:8704
s_add_u32 s70, s44, s65
v_mfma_f32_16x16x32_bf16 v[104:107], v[172:175], a[4:7], v[104:107]
s_waitcnt vmcnt(18)
ds_read_b128 a[36:39], v226 offset:10240
s_bfe_u32 s69, s54, 0x4000c
v_mfma_f32_16x16x32_bf16 v[108:111], v[172:175], a[8:11], 0
s_mul_i32 s69, s69, 589824
ds_read_b64_tr_b16 v[168:169], v218 offset:12288
s_add_u32 s69, s69, s62
v_mfma_f32_16x16x32_bf16 v[108:111], v[176:179], a[24:27], v[108:111]
s_lshl_b32 s77, s77, 5
ds_read_b128 a[52:55], v227 offset:10240
s_add_u32 s77, s77, 47448064
v_mfma_f32_16x16x32_bf16 v[112:115], v[176:179], a[28:31], 0
s_add_u32 s56, s2, 64
ds_read_b64_tr_b16 v[170:171], v218 offset:12800
s_lshr_b32 s56, s56, 8
v_mfma_f32_16x16x32_bf16 v[112:115], v[172:175], a[12:15], v[112:115]
s_waitcnt lgkmcnt(6)
buffer_load_dwordx4 v224, s[4:7], s70 offen offset:0  lds
v_mfma_f32_16x16x32_bf16 v[116:119], v[180:183], a[0:3], 0
s_add_u32 s57, s3, 1
ds_read_b64_tr_b16 v[172:173], v219 offset:8192
v_and_b32 v2, 31, v1
v_mfma_f32_16x16x32_bf16 v[116:119], v[184:187], a[16:19], v[116:119]
s_lshr_b32 s57, s57, 2
buffer_load_dwordx4 v225, s[4:7], s70 offen offset:1024  lds
v_mfma_f32_16x16x32_bf16 v[120:123], v[184:187], a[20:23], 0
s_add_u32 m0, s72, 10240
ds_read_b64_tr_b16 v[174:175], v219 offset:8704
v_lshlrev_b32 v2, 3, v2
v_mfma_f32_16x16x32_bf16 v[120:123], v[180:183], a[4:7], v[120:123]
s_waitcnt vmcnt(18)
ds_read_b128 a[40:43], v226 offset:12288
v_lshrrev_b32 v3, 5, v1
v_mfma_f32_16x16x32_bf16 v[124:127], v[180:183], a[8:11], 0
s_add_u32 s70, s45, s65
ds_read_b64_tr_b16 v[176:177], v219 offset:12288
v_lshl_add_u32 v220, v3, 9, v2
v_mfma_f32_16x16x32_bf16 v[124:127], v[184:187], a[24:27], v[124:127]
s_add_u32 s56, s56, s57
ds_read_b128 a[56:59], v227 offset:12288
v_lshrrev_b32 v2, 1, v1
v_mfma_f32_16x16x32_bf16 v[128:131], v[184:187], a[28:31], 0
s_lshl_b32 s56, s56, 29
ds_read_b64_tr_b16 v[178:179], v219 offset:12800
v_and_b32 v2, 0x13, v2
v_mfma_f32_16x16x32_bf16 v[128:131], v[180:183], a[12:15], v[128:131]
s_waitcnt lgkmcnt(6)
buffer_load_dwordx4 v224, s[4:7], s70 offen offset:0  lds
v_mfma_f32_16x16x32_bf16 v[132:135], v[164:167], a[0:3], 0
s_add_u32 s77, s77, s56
ds_read_b64_tr_b16 v[180:181], v216 offset:16384
v_bfe_u32 v3, v1, 3, 1
v_mfma_f32_16x16x32_bf16 v[132:135], v[168:171], a[16:19], v[132:135]
s_and_b32 s56, s2, 4
buffer_load_dwordx4 v225, s[4:7], s70 offen offset:1024  lds
v_mfma_f32_16x16x32_bf16 v[136:139], v[168:171], a[20:23], 0
s_add_u32 m0, s72, 12288
ds_read_b64_tr_b16 v[182:183], v216 offset:16896
v_lshl_add_u32 v2, v3, 3, v2
v_mfma_f32_16x16x32_bf16 v[136:139], v[164:167], a[4:7], v[136:139]
s_waitcnt vmcnt(18)
ds_read_b128 a[44:47], v226 offset:14336
v_bfe_u32 v3, v1, 4, 1
v_mfma_f32_16x16x32_bf16 v[140:143], v[164:167], a[8:11], 0
s_add_u32 s70, s46, s65
ds_read_b64_tr_b16 v[184:185], v216 offset:20480
v_lshl_add_u32 v2, v3, 2, v2
v_mfma_f32_16x16x32_bf16 v[140:143], v[168:171], a[24:27], v[140:143]
s_lshr_b32 s57, s2, 3
ds_read_b128 a[60:63], v227 offset:14336
v_mul_u32_u24 v2, 9216, v2
v_mfma_f32_16x16x32_bf16 v[144:147], v[168:171], a[28:31], 0
s_lshl3_add_u32 s56, s56, s57
ds_read_b64_tr_b16 v[186:187], v216 offset:20992
v_and_b32 v3, 1, v1
v_mfma_f32_16x16x32_bf16 v[144:147], v[164:167], a[12:15], v[144:147]
s_waitcnt lgkmcnt(6)
buffer_load_dwordx4 v224, s[4:7], s70 offen offset:0  lds
v_mfma_f32_16x16x32_bf16 v[148:151], v[172:175], a[0:3], 0
s_and_b32 s57, s3, 1
ds_read_b64_tr_b16 v[164:165], v217 offset:16384
v_lshl_add_u32 v223, v3, 4, v2
v_mfma_f32_16x16x32_bf16 v[148:151], v[176:179], a[16:19], v[148:151]
s_lshr_b32 s58, s3, 1
buffer_load_dwordx4 v225, s[4:7], s70 offen offset:1024  lds
v_mfma_f32_16x16x32_bf16 v[152:155], v[176:179], a[20:23], 0
s_add_u32 m0, s72, 14336
ds_read_b64_tr_b16 v[166:167], v217 offset:16896
v_lshrrev_b32 v3, 3, v1
v_mfma_f32_16x16x32_bf16 v[152:155], v[172:175], a[4:7], v[152:155]
s_waitcnt vmcnt(16)
ds_read_b128 a[64:67], v226 offset:0
v_min_u32 v3, 5, v3
v_mfma_f32_16x16x32_bf16 v[156:159], v[172:175], a[8:11], 0
s_add_u32 s70, s47, s65
ds_read_b64_tr_b16 v[168:169], v217 offset:20480
v_mul_u32_u24 v3, 72, v3
v_mfma_f32_16x16x32_bf16 v[156:159], v[176:179], a[24:27], v[156:159]
s_bfe_u32 s65, s54, 0x40010
ds_read_b128 a[80:83], v227 offset:0
v_bfe_u32 v2, v1, 1, 2
v_mfma_f32_16x16x32_bf16 v[160:163], v[176:179], a[28:31], 0
s_lshl_b32 s65, s65, 7
ds_read_b64_tr_b16 v[170:171], v217 offset:20992
v_lshlrev_b32 v2, 3, v2
v_mfma_f32_16x16x32_bf16 v[160:163], v[172:175], a[12:15], v[160:163]
s_waitcnt lgkmcnt(6)
buffer_load_dwordx4 v224, s[4:7], s70 offen offset:0  lds
v_mfma_f32_16x16x32_bf16 v[36:39], v[180:183], a[32:35], v[36:39]
s_lshl1_add_u32 s57, s57, s58
ds_read_b64_tr_b16 v[172:173], v218 offset:16384
v_lshrrev_b32 v250, 2, v1
v_mfma_f32_16x16x32_bf16 v[36:39], v[184:187], a[48:51], v[36:39]
s_lshl2_add_u32 s56, s56, s57
buffer_load_dwordx4 v225, s[4:7], s70 offen offset:1024  lds
v_mfma_f32_16x16x32_bf16 v[40:43], v[184:187], a[52:55], v[40:43]
s_add_u32 m0, s71, 49152
ds_read_b64_tr_b16 v[174:175], v218 offset:16896
v_min_u32 v250, 13, v250
v_mfma_f32_16x16x32_bf16 v[40:43], v[180:183], a[36:39], v[40:43]
s_add_u32 s70, s44, s65
buffer_load_dwordx4 v221, s[8:11], s69 offen offset:0  lds
v_mfma_f32_16x16x32_bf16 v[44:47], v[180:183], a[40:43], v[44:47]
s_lshl_b32 s56, s56, 7
ds_read_b64_tr_b16 v[176:177], v218 offset:20480
v_lshlrev_b32 v250, 7, v250
v_mfma_f32_16x16x32_bf16 v[44:47], v[184:187], a[56:59], v[44:47]
s_and_b32 s57, s2, 3
buffer_load_dwordx4 v222, s[8:11], s69 offen offset:1024  lds
v_mfma_f32_16x16x32_bf16 v[48:51], v[184:187], a[60:63], v[48:51]
s_add_u32 m0, s72, 0
ds_read_b64_tr_b16 v[178:179], v218 offset:20992
s_bfe_u32 s69, s54, 0x40010
v_mfma_f32_16x16x32_bf16 v[48:51], v[180:183], a[44:47], v[48:51]
s_waitcnt lgkmcnt(4)
s_waitcnt vmcnt(16)
ds_read_b128 a[68:71], v226 offset:2048
v_mfma_f32_16x16x32_bf16 v[52:55], v[164:167], a[32:35], v[52:55]
s_mul_i32 s69, s69, 589824
ds_read_b64_tr_b16 v[180:181], v219 offset:16384
s_add_u32 s69, s69, s62
v_mfma_f32_16x16x32_bf16 v[52:55], v[168:171], a[48:51], v[52:55]
s_lshl2_add_u32 s56, s57, s56
ds_read_b64_tr_b16 v[182:183], v219 offset:16896
v_lshrrev_b32 v251, 5, v1
v_mfma_f32_16x16x32_bf16 v[56:59], v[168:171], a[52:55], v[56:59]
s_add_u32 s78, s56, 47316992
ds_read_b64_tr_b16 v[184:185], v219 offset:20480
v_mul_u32_u24 v251, 147456, v251
v_mfma_f32_16x16x32_bf16 v[56:59], v[164:167], a[36:39], v[56:59]
s_lshr_b32 s56, s2, 3
ds_read_b64_tr_b16 v[186:187], v219 offset:20992
s_lshl2_add_u32 s56, s56, s3
v_mfma_f32_16x16x32_bf16 v[60:63], v[164:167], a[40:43], v[60:63]
s_mul_i32 s56, s56, 55296
ds_read_b128 a[84:87], v227 offset:2048
s_mul_i32 s58, s57, 2304
v_mfma_f32_16x16x32_bf16 v[60:63], v[168:171], a[56:59], v[60:63]
s_add_u32 s28, s56, s58
buffer_load_dwordx4 v224, s[4:7], s70 offen offset:0  lds
v_mfma_f32_16x16x32_bf16 v[64:67], v[168:171], a[60:63], v[64:67]
s_lshl_b32 s57, s57, 1
buffer_load_dwordx4 v225, s[4:7], s70 offen offset:1024  lds
v_mfma_f32_16x16x32_bf16 v[64:67], v[164:167], a[44:47], v[64:67]
s_waitcnt vmcnt(16) lgkmcnt(1)
s_barrier
v_mfma_f32_16x16x32_bf16 v[68:71], v[172:175], a[32:35], v[68:71]
s_add_u32 m0, s72, 2048
ds_read_b64_tr_b16 v[164:165], v216 offset:24576
s_add_u32 s70, s45, s65
v_mfma_f32_16x16x32_bf16 v[68:71], v[176:179], a[48:51], v[68:71]
s_waitcnt vmcnt(14)
ds_read_b128 a[72:75], v226 offset:4096
s_sub_u32 s57, 3, s57
v_mfma_f32_16x16x32_bf16 v[72:75], v[176:179], a[52:55], v[72:75]
s_and_b32 s29, s57, 7
ds_read_b64_tr_b16 v[166:167], v216 offset:25088
s_lshl_b32 s56, s59, 12
v_mfma_f32_16x16x32_bf16 v[72:75], v[172:175], a[36:39], v[72:75]
s_lshl_b32 s57, s59, 9
ds_read_b128 a[88:91], v227 offset:4096
v_lshl_add_u32 v228, v1, 4, s56
v_mfma_f32_16x16x32_bf16 v[76:79], v[172:175], a[40:43], v[76:79]
s_add_u32 s57, s57, 16384
ds_read_b64_tr_b16 v[168:169], v216 offset:28672
v_lshl_add_u32 v229, v1, 3, s57
v_mfma_f32_16x16x32_bf16 v[76:79], v[176:179], a[56:59], v[76:79]
s_waitcnt lgkmcnt(5)
buffer_load_dwordx4 v224, s[4:7], s70 offen offset:0  lds
v_mfma_f32_16x16x32_bf16 v[80:83], v[176:179], a[60:63], v[80:83]
s_mul_i32 s29, s29, 0x101
ds_read_b64_tr_b16 v[170:171], v216 offset:29184
s_add_u32 s29, s29, 0x11080800
v_mfma_f32_16x16x32_bf16 v[80:83], v[172:175], a[44:47], v[80:83]
s_add_u32 s57, s2, 64
buffer_load_dwordx4 v225, s[4:7], s70 offen offset:1024  lds
v_mfma_f32_16x16x32_bf16 v[84:87], v[180:183], a[32:35], v[84:87]
s_add_u32 m0, s71, 57344
ds_read_b64_tr_b16 v[172:173], v217 offset:24576
v_bfe_u32 v2, s29, v2, 8
v_mfma_f32_16x16x32_bf16 v[84:87], v[184:187], a[48:51], v[84:87]
s_add_u32 s70, s46, s65
buffer_load_dwordx4 v221, s[8:11], s69 offen offset:0  lds
v_mfma_f32_16x16x32_bf16 v[88:91], v[184:187], a[52:55], v[88:91]
s_lshr_b32 s57, s57, 8
ds_read_b64_tr_b16 v[174:175], v217 offset:25088
v_add_lshl_u32 v249, v2, v3, 7
v_mfma_f32_16x16x32_bf16 v[88:91], v[180:183], a[36:39], v[88:91]
s_xor_b32 s57, s57, 1
buffer_load_dwordx4 v222, s[8:11], s69 offen offset:1024  lds
v_mfma_f32_16x16x32_bf16 v[92:95], v[180:183], a[40:43], v[92:95]
s_add_u32 m0, s72, 4096
ds_read_b64_tr_b16 v[176:177], v217 offset:28672
v_bfe_u32 v2, v1, 1, 4
v_mfma_f32_16x16x32_bf16 v[92:95], v[184:187], a[56:59], v[92:95]
s_waitcnt vmcnt(16)
ds_read_b128 a[76:79], v226 offset:6144
v_lshl_add_u32 v251, v2, 7, v251
v_mfma_f32_16x16x32_bf16 v[96:99], v[184:187], a[60:63], v[96:99]
s_bfe_u32 s69, s54, 0x40014
ds_read_b64_tr_b16 v[178:179], v217 offset:29184
v_lshrrev_b32 v2, 3, v1
v_mfma_f32_16x16x32_bf16 v[96:99], v[180:183], a[44:47], v[96:99]
s_waitcnt lgkmcnt(5)
ds_read_b128 a[92:95], v227 offset:6144
v_lshrrev_b32 v3, 4, v1
v_mfma_f32_16x16x32_bf16 v[100:103], v[164:167], a[32:35], v[100:103]
s_mul_i32 s69, s69, 589824
ds_read_b64_tr_b16 v[180:181], v218 offset:24576
v_lshlrev_b32 v3, 1, v3
v_mfma_f32_16x16x32_bf16 v[100:103], v[168:171], a[48:51], v[100:103]
s_add_u32 s69, s69, s62
buffer_load_dwordx4 v224, s[4:7], s70 offen offset:0  lds
v_mfma_f32_16x16x32_bf16 v[104:107], v[168:171], a[52:55], v[104:107]
s_mul_i32 s57, s57, 1073741824
ds_read_b64_tr_b16 v[182:183], v218 offset:25088
v_xor_b32 v3, v3, v1
v_mfma_f32_16x16x32_bf16 v[104:107], v[164:167], a[36:39], v[104:107]
s_add_u32 s57, s57, s56
buffer_load_dwordx4 v225, s[4:7], s70 offen offset:1024  lds
v_mfma_f32_16x16x32_bf16 v[108:111], v[164:167], a[40:43], v[108:111]
s_add_u32 m0, s72, 6144
ds_read_b64_tr_b16 v[184:185], v218 offset:28672
v_add_u32 v251, s57, v251
v_mfma_f32_16x16x32_bf16 v[108:111], v[168:171], a[56:59], v[108:111]
s_waitcnt vmcnt(16)
ds_read_b128 a[96:99], v226 offset:8192
v_and_b32 v3, 7, v3
v_mfma_f32_16x16x32_bf16 v[112:115], v[168:171], a[60:63], v[112:115]
s_add_u32 s70, s47, s65
ds_read_b64_tr_b16 v[186:187], v218 offset:29184
v_lshlrev_b32 v242, 4, v1
v_mfma_f32_16x16x32_bf16 v[112:115], v[164:167], a[44:47], v[112:115]
s_waitcnt lgkmcnt(6)
ds_read_b128 a[112:115], v227 offset:8192
v_add_u32 v243, 4096, v242
v_mfma_f32_16x16x32_bf16 v[116:119], v[172:175], a[32:35], v[116:119]
s_bfe_u32 s65, s54, 0x40014
ds_read_b64_tr_b16 v[164:165], v219 offset:24576
v_add_u32 v244, 8192, v242
v_mfma_f32_16x16x32_bf16 v[116:119], v[176:179], a[48:51], v[116:119]
s_waitcnt lgkmcnt(7)
buffer_load_dwordx4 v224, s[4:7], s70 offen offset:0  lds
v_mfma_f32_16x16x32_bf16 v[120:123], v[176:179], a[52:55], v[120:123]
s_lshl_b32 s65, s65, 7
ds_read_b64_tr_b16 v[166:167], v219 offset:25088
v_add_u32 v245, 12288, v242
v_mfma_f32_16x16x32_bf16 v[120:123], v[172:175], a[36:39], v[120:123]
s_lshr_b32 s56, s3, 1
buffer_load_dwordx4 v225, s[4:7], s70 offen offset:1024  lds
v_mfma_f32_16x16x32_bf16 v[124:127], v[172:175], a[40:43], v[124:127]
s_add_u32 m0, s71, 65536
ds_read_b64_tr_b16 v[168:169], v219 offset:28672
v_lshlrev_b32 v247, 3, v1
v_mfma_f32_16x16x32_bf16 v[124:127], v[176:179], a[56:59], v[124:127]
s_add_u32 s70, s44, s65
buffer_load_dwordx4 v221, s[8:11], s69 offen offset:0  lds
v_mfma_f32_16x16x32_bf16 v[128:131], v[176:179], a[60:63], v[128:131]
s_mul_i32 s58, s56, 73728
ds_read_b64_tr_b16 v[170:171], v219 offset:29184
v_add_u32 v246, 16384, v247
v_mfma_f32_16x16x32_bf16 v[128:131], v[172:175], a[44:47], v[128:131]
s_waitcnt lgkmcnt(5)
buffer_load_dwordx4 v222, s[8:11], s69 offen offset:1024  lds
v_mfma_f32_16x16x32_bf16 v[132:135], v[180:183], a[32:35], v[132:135]
s_add_u32 m0, s72, 8192
ds_read_b64_tr_b16 v[172:173], v216 offset:32768
v_and_b32 v215, 3, v1
v_mfma_f32_16x16x32_bf16 v[132:135], v[184:187], a[48:51], v[132:135]
s_waitcnt vmcnt(18)
ds_read_b128 a[100:103], v226 offset:10240
s_mul_i32 s56, s56, 576
v_mfma_f32_16x16x32_bf16 v[136:139], v[184:187], a[52:55], v[136:139]
s_and_b32 s57, s3, 1
ds_read_b64_tr_b16 v[174:175], v216 offset:33280
s_lshl3_add_u32 s56, s57, s56
v_mfma_f32_16x16x32_bf16 v[136:139], v[180:183], a[36:39], v[136:139]
ds_read_b128 a[116:119], v227 offset:10240
v_add_u32 v2, s56, v2
v_mfma_f32_16x16x32_bf16 v[140:143], v[180:183], a[40:43], v[140:143]
s_lshr_b32 s56, s3, 1
ds_read_b64_tr_b16 v[176:177], v216 offset:36864
v_mul_u32_u24 v2, 1152, v2
v_mfma_f32_16x16x32_bf16 v[140:143], v[184:187], a[56:59], v[140:143]
s_waitcnt lgkmcnt(9)
buffer_load_dwordx4 v224, s[4:7], s70 offen offset:0  lds
v_mfma_f32_16x16x32_bf16 v[144:147], v[184:187], a[60:63], v[144:147]
s_mul_i32 s56, s56, 663552
ds_read_b64_tr_b16 v[178:179], v216 offset:37376
v_lshl_add_u32 v236, v3, 4, v2
v_mfma_f32_16x16x32_bf16 v[144:147], v[180:183], a[44:47], v[144:147]
s_waitcnt lgkmcnt(6)
buffer_load_dwordx4 v225, s[4:7], s70 offen offset:1024  lds
v_mfma_f32_16x16x32_bf16 v[148:151], v[164:167], a[32:35], v[148:151]
s_add_u32 m0, s72, 10240
ds_read_b64_tr_b16 v[180:181], v217 offset:32768
v_add_u32 v237, s58, v236
v_mfma_f32_16x16x32_bf16 v[148:151], v[168:171], a[48:51], v[148:151]
s_waitcnt vmcnt(18)
ds_read_b128 a[104:107], v226 offset:12288
v_subrev_u32 v238, s58, v236
v_mfma_f32_16x16x32_bf16 v[152:155], v[168:171], a[52:55], v[152:155]
s_add_u32 s70, s45, s65
ds_read_b64_tr_b16 v[182:183], v217 offset:33280
v_lshrrev_b32 v2, 1, v1
v_mfma_f32_16x16x32_bf16 v[152:155], v[164:167], a[36:39], v[152:155]
ds_read_b128 a[120:123], v227 offset:12288
v_mul_u32_u24 v2, 1152, v2
v_mfma_f32_16x16x32_bf16 v[156:159], v[164:167], a[40:43], v[156:159]
ds_read_b64_tr_b16 v[184:185], v217 offset:36864
v_and_b32 v3, 1, v1
v_mfma_f32_16x16x32_bf16 v[156:159], v[168:171], a[56:59], v[156:159]
s_waitcnt lgkmcnt(7)
buffer_load_dwordx4 v224, s[4:7], s70 offen offset:0  lds
v_mfma_f32_16x16x32_bf16 v[160:163], v[168:171], a[60:63], v[160:163]
ds_read_b64_tr_b16 v[186:187], v217 offset:37376
v_lshl_add_u32 v2, v3, 4, v2
v_mfma_f32_16x16x32_bf16 v[160:163], v[164:167], a[44:47], v[160:163]
s_waitcnt lgkmcnt(6)
buffer_load_dwordx4 v225, s[4:7], s70 offen offset:1024  lds
v_mfma_f32_16x16x32_bf16 v[36:39], v[172:175], a[64:67], v[36:39]
s_add_u32 m0, s72, 12288
ds_read_b64_tr_b16 v[164:165], v218 offset:32768
v_add_u32 v239, s56, v2
v_mfma_f32_16x16x32_bf16 v[36:39], v[176:179], a[80:83], v[36:39]
s_waitcnt vmcnt(18)
ds_read_b128 a[108:111], v226 offset:14336
v_bfe_u32 v2, v1, 2, 1
v_mfma_f32_16x16x32_bf16 v[40:43], v[176:179], a[84:87], v[40:43]
s_add_u32 s70, s46, s65
ds_read_b64_tr_b16 v[166:167], v218 offset:33280
v_lshl_add_u32 v215, v2, 5, v215
v_mfma_f32_16x16x32_bf16 v[40:43], v[172:175], a[68:71], v[40:43]
s_bfe_u32 s69, s54, 0x40018
ds_read_b128 a[124:127], v227 offset:14336
v_lshlrev_b32 v215, 2, v215
v_mfma_f32_16x16x32_bf16 v[44:47], v[172:175], a[72:75], v[44:47]
s_mul_i32 s69, s69, 589824
ds_read_b64_tr_b16 v[168:169], v218 offset:36864
s_add_u32 s69, s69, s62
v_mfma_f32_16x16x32_bf16 v[44:47], v[176:179], a[88:91], v[44:47]
s_waitcnt lgkmcnt(7)
buffer_load_dwordx4 v224, s[4:7], s70 offen offset:0  lds
v_mfma_f32_16x16x32_bf16 v[48:51], v[176:179], a[92:95], v[48:51]
ds_read_b64_tr_b16 v[170:171], v218 offset:37376
v_mfma_f32_16x16x32_bf16 v[48:51], v[172:175], a[76:79], v[48:51]
s_waitcnt lgkmcnt(6)
buffer_load_dwordx4 v225, s[4:7], s70 offen offset:1024  lds
v_mfma_f32_16x16x32_bf16 v[52:55], v[180:183], a[64:67], v[52:55]
s_add_u32 m0, s72, 14336
ds_read_b64_tr_b16 v[172:173], v219 offset:32768
s_add_u32 s70, s47, s65
v_mfma_f32_16x16x32_bf16 v[52:55], v[184:187], a[80:83], v[52:55]
s_waitcnt vmcnt(16)
ds_read_b128 a[128:131], v226 offset:0
v_mfma_f32_16x16x32_bf16 v[56:59], v[184:187], a[84:87], v[56:59]
ds_read_b64_tr_b16 v[174:175], v219 offset:33280
v_mfma_f32_16x16x32_bf16 v[56:59], v[180:183], a[68:71], v[56:59]
ds_read_b128 a[144:147], v227 offset:0
v_mfma_f32_16x16x32_bf16 v[60:63], v[180:183], a[72:75], v[60:63]
ds_read_b64_tr_b16 v[176:177], v219 offset:36864
v_mfma_f32_16x16x32_bf16 v[60:63], v[184:187], a[88:91], v[60:63]
s_waitcnt lgkmcnt(7)
buffer_load_dwordx4 v224, s[4:7], s70 offen offset:0  lds
v_mfma_f32_16x16x32_bf16 v[64:67], v[184:187], a[92:95], v[64:67]
s_bfe_u32 s65, s54, 0x40018
ds_read_b64_tr_b16 v[178:179], v219 offset:37376
s_lshl_b32 s65, s65, 7
v_mfma_f32_16x16x32_bf16 v[64:67], v[180:183], a[76:79], v[64:67]
s_waitcnt lgkmcnt(6)
buffer_load_dwordx4 v225, s[4:7], s70 offen offset:1024  lds
v_mfma_f32_16x16x32_bf16 v[68:71], v[164:167], a[64:67], v[68:71]
s_add_u32 m0, s72, 0
ds_read_b64_tr_b16 v[180:181], v216 offset:40960
s_add_u32 s70, s44, s65
v_mfma_f32_16x16x32_bf16 v[68:71], v[168:171], a[80:83], v[68:71]
s_waitcnt vmcnt(16)
ds_read_b128 a[132:135], v226 offset:2048
v_mfma_f32_16x16x32_bf16 v[72:75], v[168:171], a[84:87], v[72:75]
ds_read_b64_tr_b16 v[182:183], v216 offset:41472
v_mfma_f32_16x16x32_bf16 v[72:75], v[164:167], a[68:71], v[72:75]
ds_read_b128 a[148:151], v227 offset:2048
v_mfma_f32_16x16x32_bf16 v[76:79], v[164:167], a[72:75], v[76:79]
ds_read_b64_tr_b16 v[184:185], v216 offset:45056
v_mfma_f32_16x16x32_bf16 v[76:79], v[168:171], a[88:91], v[76:79]
s_waitcnt lgkmcnt(7)
buffer_load_dwordx4 v224, s[4:7], s70 offen offset:0  lds
v_mfma_f32_16x16x32_bf16 v[80:83], v[168:171], a[92:95], v[80:83]
ds_read_b64_tr_b16 v[186:187], v216 offset:45568
v_mfma_f32_16x16x32_bf16 v[80:83], v[164:167], a[76:79], v[80:83]
s_waitcnt lgkmcnt(6)
buffer_load_dwordx4 v225, s[4:7], s70 offen offset:1024  lds
v_mfma_f32_16x16x32_bf16 v[84:87], v[172:175], a[64:67], v[84:87]
s_add_u32 m0, s72, 2048
ds_read_b64_tr_b16 v[164:165], v217 offset:40960
v_add_u32 v216, 0xc000, v216
v_mfma_f32_16x16x32_bf16 v[84:87], v[176:179], a[80:83], v[84:87]
s_waitcnt vmcnt(14)
ds_read_b128 a[136:139], v226 offset:4096
s_add_u32 s70, s45, s65
v_mfma_f32_16x16x32_bf16 v[88:91], v[176:179], a[84:87], v[88:91]
ds_read_b64_tr_b16 v[166:167], v217 offset:41472
v_mfma_f32_16x16x32_bf16 v[88:91], v[172:175], a[68:71], v[88:91]
ds_read_b128 a[152:155], v227 offset:4096
v_mfma_f32_16x16x32_bf16 v[92:95], v[172:175], a[72:75], v[92:95]
ds_read_b64_tr_b16 v[168:169], v217 offset:45056
v_mfma_f32_16x16x32_bf16 v[92:95], v[176:179], a[88:91], v[92:95]
s_waitcnt lgkmcnt(7)
buffer_load_dwordx4 v224, s[4:7], s70 offen offset:0  lds
v_mfma_f32_16x16x32_bf16 v[96:99], v[176:179], a[92:95], v[96:99]
ds_read_b64_tr_b16 v[170:171], v217 offset:45568
v_mfma_f32_16x16x32_bf16 v[96:99], v[172:175], a[76:79], v[96:99]
s_waitcnt lgkmcnt(6)
buffer_load_dwordx4 v225, s[4:7], s70 offen offset:1024  lds
v_mfma_f32_16x16x32_bf16 v[100:103], v[180:183], a[64:67], v[100:103]
s_add_u32 m0, s71, 73728
ds_read_b64_tr_b16 v[172:173], v218 offset:40960
v_add_u32 v217, 0xc000, v217
v_mfma_f32_16x16x32_bf16 v[100:103], v[184:187], a[80:83], v[100:103]
s_add_u32 s70, s46, s65
buffer_load_dwordx4 v221, s[8:11], s69 offen offset:0  lds
v_mfma_f32_16x16x32_bf16 v[104:107], v[184:187], a[84:87], v[104:107]
ds_read_b64_tr_b16 v[174:175], v218 offset:41472
v_mfma_f32_16x16x32_bf16 v[104:107], v[180:183], a[68:71], v[104:107]
buffer_load_dwordx4 v222, s[8:11], s69 offen offset:1024  lds
v_mfma_f32_16x16x32_bf16 v[108:111], v[180:183], a[72:75], v[108:111]
s_add_u32 m0, s72, 4096
ds_read_b64_tr_b16 v[176:177], v218 offset:45056
s_bfe_u32 s69, s54, 0x4001c
v_mfma_f32_16x16x32_bf16 v[108:111], v[184:187], a[88:91], v[108:111]
s_waitcnt vmcnt(16)
ds_read_b128 a[140:143], v226 offset:6144
s_mul_i32 s69, s69, 589824
v_mfma_f32_16x16x32_bf16 v[112:115], v[184:187], a[92:95], v[112:115]
s_add_u32 s69, s69, s62
ds_read_b64_tr_b16 v[178:179], v218 offset:45568
v_mfma_f32_16x16x32_bf16 v[112:115], v[180:183], a[76:79], v[112:115]
s_waitcnt lgkmcnt(5)
ds_read_b128 a[156:159], v227 offset:6144
v_mfma_f32_16x16x32_bf16 v[116:119], v[164:167], a[64:67], v[116:119]
ds_read_b64_tr_b16 v[180:181], v219 offset:40960
v_add_u32 v218, 0xc000, v218
v_mfma_f32_16x16x32_bf16 v[116:119], v[168:171], a[80:83], v[116:119]
ds_read_b64_tr_b16 v[182:183], v219 offset:41472
v_mfma_f32_16x16x32_bf16 v[120:123], v[168:171], a[84:87], v[120:123]
ds_read_b64_tr_b16 v[184:185], v219 offset:45056
v_mfma_f32_16x16x32_bf16 v[120:123], v[164:167], a[68:71], v[120:123]
ds_read_b64_tr_b16 v[186:187], v219 offset:45568
v_mfma_f32_16x16x32_bf16 v[124:127], v[164:167], a[72:75], v[124:127]
buffer_load_dwordx4 v224, s[4:7], s70 offen offset:0  lds
v_mfma_f32_16x16x32_bf16 v[124:127], v[168:171], a[88:91], v[124:127]
buffer_load_dwordx4 v225, s[4:7], s70 offen offset:1024  lds
v_mfma_f32_16x16x32_bf16 v[128:131], v[168:171], a[92:95], v[128:131]
s_waitcnt vmcnt(14)
ds_read_b128 a[160:163], v226 offset:8192
s_add_u32 m0, s72, 6144
v_mfma_f32_16x16x32_bf16 v[128:131], v[164:167], a[76:79], v[128:131]
s_waitcnt lgkmcnt(1)
s_barrier
v_mfma_f32_16x16x32_bf16 v[132:135], v[172:175], a[64:67], v[132:135]
s_add_u32 s70, s47, s65
ds_read_b64_tr_b16 v[164:165], v216 offset:0
v_add_u32 v219, 0xc000, v219
v_mfma_f32_16x16x32_bf16 v[132:135], v[176:179], a[80:83], v[132:135]
ds_read_b128 a[176:179], v227 offset:8192
v_mfma_f32_16x16x32_bf16 v[136:139], v[176:179], a[84:87], v[136:139]
ds_read_b64_tr_b16 v[166:167], v216 offset:512
v_mfma_f32_16x16x32_bf16 v[136:139], v[172:175], a[68:71], v[136:139]
buffer_load_dwordx4 v224, s[4:7], s70 offen offset:0  lds
v_mfma_f32_16x16x32_bf16 v[140:143], v[172:175], a[72:75], v[140:143]
ds_read_b64_tr_b16 v[168:169], v216 offset:4096
v_mfma_f32_16x16x32_bf16 v[140:143], v[176:179], a[88:91], v[140:143]
buffer_load_dwordx4 v225, s[4:7], s70 offen offset:1024  lds
v_mfma_f32_16x16x32_bf16 v[144:147], v[176:179], a[92:95], v[144:147]
s_add_u32 m0, s71, 81920
ds_read_b64_tr_b16 v[170:171], v216 offset:4608
s_bfe_u32 s65, s54, 0x4001c
v_mfma_f32_16x16x32_bf16 v[144:147], v[172:175], a[76:79], v[144:147]
s_lshl_b32 s65, s65, 7
buffer_load_dwordx4 v221, s[8:11], s69 offen offset:0  lds
v_mfma_f32_16x16x32_bf16 v[148:151], v[180:183], a[64:67], v[148:151]
s_add_u32 s70, s44, s65
ds_read_b64_tr_b16 v[172:173], v217 offset:0
v_mfma_f32_16x16x32_bf16 v[148:151], v[184:187], a[80:83], v[148:151]
buffer_load_dwordx4 v222, s[8:11], s69 offen offset:1024  lds
v_mfma_f32_16x16x32_bf16 v[152:155], v[184:187], a[84:87], v[152:155]
s_add_u32 m0, s72, 8192
ds_read_b64_tr_b16 v[174:175], v217 offset:512
s_bfe_u32 s69, s55, 0x40000
v_mfma_f32_16x16x32_bf16 v[152:155], v[180:183], a[68:71], v[152:155]
s_waitcnt vmcnt(16)
ds_read_b128 a[164:167], v226 offset:10240
s_mul_i32 s69, s69, 589824
v_mfma_f32_16x16x32_bf16 v[156:159], v[180:183], a[72:75], v[156:159]
s_add_u32 s69, s69, s62
ds_read_b64_tr_b16 v[176:177], v217 offset:4096
v_mfma_f32_16x16x32_bf16 v[156:159], v[184:187], a[88:91], v[156:159]
ds_read_b128 a[180:183], v227 offset:10240
v_mfma_f32_16x16x32_bf16 v[160:163], v[184:187], a[92:95], v[160:163]
ds_read_b64_tr_b16 v[178:179], v217 offset:4608
v_mfma_f32_16x16x32_bf16 v[160:163], v[180:183], a[76:79], v[160:163]
s_waitcnt lgkmcnt(6)
buffer_load_dwordx4 v224, s[4:7], s70 offen offset:0  lds
v_mfma_f32_16x16x32_bf16 v[36:39], v[164:167], a[96:99], v[36:39]
ds_read_b64_tr_b16 v[180:181], v218 offset:0
v_mfma_f32_16x16x32_bf16 v[36:39], v[168:171], a[112:115], v[36:39]
buffer_load_dwordx4 v225, s[4:7], s70 offen offset:1024  lds
v_mfma_f32_16x16x32_bf16 v[40:43], v[168:171], a[116:119], v[40:43]
s_add_u32 m0, s72, 10240
ds_read_b64_tr_b16 v[182:183], v218 offset:512
s_add_u32 s70, s45, s65
v_mfma_f32_16x16x32_bf16 v[40:43], v[164:167], a[100:103], v[40:43]
s_waitcnt vmcnt(16)
ds_read_b128 a[168:171], v226 offset:12288
v_mfma_f32_16x16x32_bf16 v[44:47], v[164:167], a[104:107], v[44:47]
ds_read_b64_tr_b16 v[184:185], v218 offset:4096
v_mfma_f32_16x16x32_bf16 v[44:47], v[168:171], a[120:123], v[44:47]
ds_read_b128 a[184:187], v227 offset:12288
v_mfma_f32_16x16x32_bf16 v[48:51], v[168:171], a[124:127], v[48:51]
ds_read_b64_tr_b16 v[186:187], v218 offset:4608
v_mfma_f32_16x16x32_bf16 v[48:51], v[164:167], a[108:111], v[48:51]
s_waitcnt lgkmcnt(6)
buffer_load_dwordx4 v224, s[4:7], s70 offen offset:0  lds
v_mfma_f32_16x16x32_bf16 v[52:55], v[172:175], a[96:99], v[52:55]
ds_read_b64_tr_b16 v[164:165], v219 offset:0
v_mfma_f32_16x16x32_bf16 v[52:55], v[176:179], a[112:115], v[52:55]
buffer_load_dwordx4 v225, s[4:7], s70 offen offset:1024  lds
v_mfma_f32_16x16x32_bf16 v[56:59], v[176:179], a[116:119], v[56:59]
s_add_u32 m0, s71, 90112
ds_read_b64_tr_b16 v[166:167], v219 offset:512
s_add_u32 s70, s46, s65
v_mfma_f32_16x16x32_bf16 v[56:59], v[172:175], a[100:103], v[56:59]
buffer_load_dwordx4 v221, s[8:11], s69 offen offset:0  lds
v_mfma_f32_16x16x32_bf16 v[60:63], v[172:175], a[104:107], v[60:63]
ds_read_b64_tr_b16 v[168:169], v219 offset:4096
v_mfma_f32_16x16x32_bf16 v[60:63], v[176:179], a[120:123], v[60:63]
buffer_load_dwordx4 v222, s[8:11], s69 offen offset:1024  lds
v_mfma_f32_16x16x32_bf16 v[64:67], v[176:179], a[124:127], v[64:67]
PAD_1:
s_cmp_lg_u32 s73, 0
s_cbranch_scc1 PAD_5
s_add_u32 m0, s72, 12288
ds_read_b64_tr_b16 v[170:171], v219 offset:4608
v_mfma_f32_16x16x32_bf16 v[64:67], v[172:175], a[108:111], v[64:67]
s_waitcnt lgkmcnt(4)
s_waitcnt vmcnt(18)
ds_read_b128 a[172:175], v226 offset:14336
v_mfma_f32_16x16x32_bf16 v[68:71], v[180:183], a[96:99], v[68:71]
ds_read_b64_tr_b16 v[172:173], v216 offset:8192
v_mfma_f32_16x16x32_bf16 v[68:71], v[184:187], a[112:115], v[68:71]
ds_read_b128 a[188:191], v227 offset:14336
v_mfma_f32_16x16x32_bf16 v[72:75], v[184:187], a[116:119], v[72:75]
ds_read_b64_tr_b16 v[174:175], v216 offset:8704
v_mfma_f32_16x16x32_bf16 v[72:75], v[180:183], a[100:103], v[72:75]
buffer_load_dwordx4 v224, s[4:7], s70 offen offset:0  lds
v_mfma_f32_16x16x32_bf16 v[76:79], v[180:183], a[104:107], v[76:79]
ds_read_b64_tr_b16 v[176:177], v216 offset:12288
v_mfma_f32_16x16x32_bf16 v[76:79], v[184:187], a[120:123], v[76:79]
buffer_load_dwordx4 v225, s[4:7], s70 offen offset:1024  lds
v_mfma_f32_16x16x32_bf16 v[80:83], v[184:187], a[124:127], v[80:83]
s_add_u32 m0, s72, 14336
ds_read_b64_tr_b16 v[178:179], v216 offset:12800
s_add_u32 s70, s47, s65
v_mfma_f32_16x16x32_bf16 v[80:83], v[180:183], a[108:111], v[80:83]
s_waitcnt lgkmcnt(6)
s_waitcnt vmcnt(18)
ds_read_b128 a[192:195], v226 offset:0
v_mfma_f32_16x16x32_bf16 v[84:87], v[164:167], a[96:99], v[84:87]
ds_read_b64_tr_b16 v[180:181], v217 offset:8192
v_mfma_f32_16x16x32_bf16 v[84:87], v[168:171], a[112:115], v[84:87]
ds_read_b128 a[208:211], v227 offset:0
v_mfma_f32_16x16x32_bf16 v[88:91], v[168:171], a[116:119], v[88:91]
ds_read_b64_tr_b16 v[182:183], v217 offset:8704
v_mfma_f32_16x16x32_bf16 v[88:91], v[164:167], a[100:103], v[88:91]
s_waitcnt lgkmcnt(7)
buffer_load_dwordx4 v224, s[4:7], s70 offen offset:0  lds
v_mfma_f32_16x16x32_bf16 v[92:95], v[164:167], a[104:107], v[92:95]
ds_read_b64_tr_b16 v[184:185], v217 offset:12288
v_mfma_f32_16x16x32_bf16 v[92:95], v[168:171], a[120:123], v[92:95]
buffer_load_dwordx4 v225, s[4:7], s70 offen offset:1024  lds
v_mfma_f32_16x16x32_bf16 v[96:99], v[168:171], a[124:127], v[96:99]
ds_read_b64_tr_b16 v[186:187], v217 offset:12800
v_mfma_f32_16x16x32_bf16 v[96:99], v[164:167], a[108:111], v[96:99]
s_waitcnt lgkmcnt(6)
s_waitcnt vmcnt(18)
ds_read_b128 a[196:199], v226 offset:2048
v_mfma_f32_16x16x32_bf16 v[36:39], v[172:175], a[128:131], v[36:39]
s_bfe_u32 s65, s55, 0x40000
ds_read_b64_tr_b16 v[164:165], v218 offset:8192
s_lshl_b32 s65, s65, 7
v_mfma_f32_16x16x32_bf16 v[36:39], v[176:179], a[144:147], v[36:39]
s_add_u32 m0, s72, 0
ds_read_b128 a[212:215], v227 offset:2048
s_add_u32 s70, s44, s65
v_mfma_f32_16x16x32_bf16 v[40:43], v[176:179], a[148:151], v[40:43]
s_bfe_u32 s69, s54, 0x4000c
ds_read_b64_tr_b16 v[166:167], v218 offset:8704
s_mul_i32 s69, s69, 589824
v_mfma_f32_16x16x32_bf16 v[40:43], v[172:175], a[132:135], v[40:43]
s_waitcnt lgkmcnt(7)
buffer_load_dwordx4 v224, s[4:7], s70 offen offset:0  lds
v_mfma_f32_16x16x32_bf16 v[44:47], v[172:175], a[136:139], v[44:47]
s_add_u32 s69, s69, s62
ds_read_b64_tr_b16 v[168:169], v218 offset:12288
v_mfma_f32_16x16x32_bf16 v[44:47], v[176:179], a[152:155], v[44:47]
buffer_load_dwordx4 v225, s[4:7], s70 offen offset:1024  lds
v_mfma_f32_16x16x32_bf16 v[48:51], v[176:179], a[156:159], v[48:51]
ds_read_b64_tr_b16 v[170:171], v218 offset:12800
v_mfma_f32_16x16x32_bf16 v[48:51], v[172:175], a[140:143], v[48:51]
s_waitcnt lgkmcnt(6)
v_mfma_f32_16x16x32_bf16 v[52:55], v[180:183], a[128:131], v[52:55]
ds_read_b64_tr_b16 v[172:173], v219 offset:8192
v_mfma_f32_16x16x32_bf16 v[52:55], v[184:187], a[144:147], v[52:55]
s_waitcnt vmcnt(16)
ds_read_b128 a[200:203], v226 offset:4096
s_add_u32 m0, s72, 2048
v_mfma_f32_16x16x32_bf16 v[56:59], v[184:187], a[148:151], v[56:59]
s_add_u32 s70, s45, s65
ds_read_b64_tr_b16 v[174:175], v219 offset:8704
v_mfma_f32_16x16x32_bf16 v[56:59], v[180:183], a[132:135], v[56:59]
ds_read_b128 a[216:219], v227 offset:4096
v_mfma_f32_16x16x32_bf16 v[60:63], v[180:183], a[136:139], v[60:63]
ds_read_b64_tr_b16 v[176:177], v219 offset:12288
v_mfma_f32_16x16x32_bf16 v[60:63], v[184:187], a[152:155], v[60:63]
s_waitcnt lgkmcnt(8)
buffer_load_dwordx4 v224, s[4:7], s70 offen offset:0  lds
v_mfma_f32_16x16x32_bf16 v[64:67], v[184:187], a[156:159], v[64:67]
ds_read_b64_tr_b16 v[178:179], v219 offset:12800
v_mfma_f32_16x16x32_bf16 v[64:67], v[180:183], a[140:143], v[64:67]
s_waitcnt lgkmcnt(6)
buffer_load_dwordx4 v225, s[4:7], s70 offen offset:1024  lds
v_mfma_f32_16x16x32_bf16 v[68:71], v[164:167], a[128:131], v[68:71]
ds_read_b64_tr_b16 v[180:181], v216 offset:16384
v_mfma_f32_16x16x32_bf16 v[68:71], v[168:171], a[144:147], v[68:71]
v_mfma_f32_16x16x32_bf16 v[72:75], v[168:171], a[148:151], v[72:75]
ds_read_b64_tr_b16 v[182:183], v216 offset:16896
v_mfma_f32_16x16x32_bf16 v[72:75], v[164:167], a[132:135], v[72:75]
s_waitcnt vmcnt(16)
ds_read_b128 a[204:207], v226 offset:6144
s_add_u32 m0, s72, 4096
v_mfma_f32_16x16x32_bf16 v[76:79], v[164:167], a[136:139], v[76:79]
s_add_u32 s70, s46, s65
ds_read_b64_tr_b16 v[184:185], v216 offset:20480
v_mfma_f32_16x16x32_bf16 v[76:79], v[168:171], a[152:155], v[76:79]
ds_read_b128 a[220:223], v227 offset:6144
v_mfma_f32_16x16x32_bf16 v[80:83], v[168:171], a[156:159], v[80:83]
ds_read_b64_tr_b16 v[186:187], v216 offset:20992
v_mfma_f32_16x16x32_bf16 v[80:83], v[164:167], a[140:143], v[80:83]
s_waitcnt lgkmcnt(6)
buffer_load_dwordx4 v224, s[4:7], s70 offen offset:0  lds
v_mfma_f32_16x16x32_bf16 v[84:87], v[172:175], a[128:131], v[84:87]
ds_read_b64_tr_b16 v[164:165], v217 offset:16384
v_mfma_f32_16x16x32_bf16 v[84:87], v[176:179], a[144:147], v[84:87]
buffer_load_dwordx4 v225, s[4:7], s70 offen offset:1024  lds
v_mfma_f32_16x16x32_bf16 v[88:91], v[176:179], a[148:151], v[88:91]
ds_read_b64_tr_b16 v[166:167], v217 offset:16896
v_mfma_f32_16x16x32_bf16 v[88:91], v[172:175], a[132:135], v[88:91]
v_mfma_f32_16x16x32_bf16 v[92:95], v[172:175], a[136:139], v[92:95]
ds_read_b64_tr_b16 v[168:169], v217 offset:20480
v_mfma_f32_16x16x32_bf16 v[92:95], v[176:179], a[152:155], v[92:95]
v_mfma_f32_16x16x32_bf16 v[96:99], v[176:179], a[156:159], v[96:99]
s_add_u32 m0, s72, 6144
ds_read_b64_tr_b16 v[170:171], v217 offset:20992
s_add_u32 s70, s47, s65
v_mfma_f32_16x16x32_bf16 v[96:99], v[172:175], a[140:143], v[96:99]
s_waitcnt lgkmcnt(4)
s_waitcnt vmcnt(14)
ds_read_b128 a[224:227], v226 offset:8192
v_mfma_f32_16x16x32_bf16 v[36:39], v[180:183], a[160:163], v[36:39]
ds_read_b64_tr_b16 v[172:173], v218 offset:16384
v_mfma_f32_16x16x32_bf16 v[36:39], v[184:187], a[176:179], v[36:39]
ds_read_b128 a[240:243], v227 offset:8192
v_mfma_f32_16x16x32_bf16 v[40:43], v[184:187], a[180:183], v[40:43]
ds_read_b64_tr_b16 v[174:175], v218 offset:16896
v_mfma_f32_16x16x32_bf16 v[40:43], v[180:183], a[164:167], v[40:43]
buffer_load_dwordx4 v224, s[4:7], s70 offen offset:0  lds
v_mfma_f32_16x16x32_bf16 v[44:47], v[180:183], a[168:171], v[44:47]
ds_read_b64_tr_b16 v[176:177], v218 offset:20480
v_mfma_f32_16x16x32_bf16 v[44:47], v[184:187], a[184:187], v[44:47]
buffer_load_dwordx4 v225, s[4:7], s70 offen offset:1024  lds
v_mfma_f32_16x16x32_bf16 v[48:51], v[184:187], a[188:191], v[48:51]
s_add_u32 m0, s71, 0
ds_read_b64_tr_b16 v[178:179], v218 offset:20992
v_mfma_f32_16x16x32_bf16 v[48:51], v[180:183], a[172:175], v[48:51]
s_waitcnt lgkmcnt(6)
buffer_load_dwordx4 v221, s[12:15], s69 offen offset:0  lds
v_mfma_f32_16x16x32_bf16 v[52:55], v[164:167], a[160:163], v[52:55]
ds_read_b64_tr_b16 v[180:181], v219 offset:16384
v_mfma_f32_16x16x32_bf16 v[52:55], v[168:171], a[176:179], v[52:55]
ds_read_b64_tr_b16 v[182:183], v219 offset:16896
v_mfma_f32_16x16x32_bf16 v[56:59], v[168:171], a[180:183], v[56:59]
ds_read_b64_tr_b16 v[184:185], v219 offset:20480
v_mfma_f32_16x16x32_bf16 v[56:59], v[164:167], a[164:167], v[56:59]
ds_read_b64_tr_b16 v[186:187], v219 offset:20992
v_mfma_f32_16x16x32_bf16 v[60:63], v[164:167], a[168:171], v[60:63]
buffer_load_dwordx4 v222, s[12:15], s69 offen offset:1024  lds
v_mfma_f32_16x16x32_bf16 v[60:63], v[168:171], a[184:187], v[60:63]
s_waitcnt vmcnt(16)
ds_read_b128 a[228:231], v226 offset:10240
s_bfe_u32 s69, s54, 0x40010
v_mfma_f32_16x16x32_bf16 v[64:67], v[168:171], a[188:191], v[64:67]
s_mul_i32 s69, s69, 589824
ds_read_b128 a[244:247], v227 offset:10240
s_add_u32 s69, s69, s62
v_mfma_f32_16x16x32_bf16 v[64:67], v[164:167], a[172:175], v[64:67]
s_waitcnt vmcnt(14) lgkmcnt(2)
s_barrier
v_mfma_f32_16x16x32_bf16 v[68:71], v[172:175], a[160:163], v[68:71]
s_add_u32 m0, s71, 8192
ds_read_b64_tr_b16 v[164:165], v216 offset:24576
v_mfma_f32_16x16x32_bf16 v[68:71], v[176:179], a[176:179], v[68:71]
buffer_load_dwordx4 v221, s[12:15], s69 offen offset:0  lds
v_mfma_f32_16x16x32_bf16 v[72:75], v[176:179], a[180:183], v[72:75]
ds_read_b64_tr_b16 v[166:167], v216 offset:25088
v_mfma_f32_16x16x32_bf16 v[72:75], v[172:175], a[164:167], v[72:75]
s_waitcnt vmcnt(13)
ds_read_b128 a[232:235], v226 offset:12288
v_mfma_f32_16x16x32_bf16 v[76:79], v[172:175], a[168:171], v[76:79]
ds_read_b64_tr_b16 v[168:169], v216 offset:28672
v_mfma_f32_16x16x32_bf16 v[76:79], v[176:179], a[184:187], v[76:79]
ds_read_b128 a[248:251], v227 offset:12288
v_mfma_f32_16x16x32_bf16 v[80:83], v[176:179], a[188:191], v[80:83]
ds_read_b64_tr_b16 v[170:171], v216 offset:29184
v_mfma_f32_16x16x32_bf16 v[80:83], v[172:175], a[172:175], v[80:83]
buffer_load_dwordx4 v222, s[12:15], s69 offen offset:1024  lds
v_mfma_f32_16x16x32_bf16 v[84:87], v[180:183], a[160:163], v[84:87]
s_bfe_u32 s69, s54, 0x40014
ds_read_b64_tr_b16 v[172:173], v217 offset:24576
s_mul_i32 s69, s69, 589824
v_mfma_f32_16x16x32_bf16 v[84:87], v[184:187], a[176:179], v[84:87]
s_add_u32 s69, s69, s62
s_add_u32 m0, s71, 16384
v_mfma_f32_16x16x32_bf16 v[88:91], v[184:187], a[180:183], v[88:91]
ds_read_b64_tr_b16 v[174:175], v217 offset:25088
v_mfma_f32_16x16x32_bf16 v[88:91], v[180:183], a[164:167], v[88:91]
buffer_load_dwordx4 v221, s[12:15], s69 offen offset:0  lds
v_mfma_f32_16x16x32_bf16 v[92:95], v[180:183], a[168:171], v[92:95]
s_sub_u32 s61, s2, 192
ds_read_b64_tr_b16 v[176:177], v217 offset:28672
v_add_lshl_u32 v248, v1, s3, 12
v_mfma_f32_16x16x32_bf16 v[92:95], v[184:187], a[184:187], v[92:95]
s_waitcnt vmcnt(13)
ds_read_b128 a[236:239], v226 offset:14336
s_and_b32 s61, s61, 0xfff
v_mfma_f32_16x16x32_bf16 v[96:99], v[184:187], a[188:191], v[96:99]
s_lshl_b32 s61, s61, 2
ds_read_b64_tr_b16 v[178:179], v217 offset:29184
v_mfma_f32_16x16x32_bf16 v[96:99], v[180:183], a[172:175], v[96:99]
s_waitcnt lgkmcnt(5)
buffer_store_dword v213, v248, s[24:27], s61 offen sc1
v_mfma_f32_16x16x32_bf16 v[36:39], v[164:167], a[192:195], v[36:39]
ds_read_b64_tr_b16 v[180:181], v218 offset:24576
v_lshlrev_b32 v248, 2, v1
v_mfma_f32_16x16x32_bf16 v[36:39], v[168:171], a[208:211], v[36:39]
ds_read_b128 a[252:255], v227 offset:14336
v_mfma_f32_16x16x32_bf16 v[40:43], v[168:171], a[212:215], v[40:43]
ds_read_b64_tr_b16 v[182:183], v218 offset:25088
v_mfma_f32_16x16x32_bf16 v[40:43], v[164:167], a[196:199], v[40:43]
buffer_load_dwordx4 v222, s[12:15], s69 offen offset:1024  lds
v_mfma_f32_16x16x32_bf16 v[44:47], v[164:167], a[200:203], v[44:47]
ds_read_b64_tr_b16 v[184:185], v218 offset:28672
v_mfma_f32_16x16x32_bf16 v[44:47], v[168:171], a[216:219], v[44:47]
v_mfma_f32_16x16x32_bf16 v[48:51], v[168:171], a[220:223], v[48:51]
ds_read_b64_tr_b16 v[186:187], v218 offset:29184
v_mfma_f32_16x16x32_bf16 v[48:51], v[164:167], a[204:207], v[48:51]
s_waitcnt lgkmcnt(5)
s_waitcnt vmcnt(13)
ds_read_b128 v[4:7], v226 offset:0
v_mfma_f32_16x16x32_bf16 v[52:55], v[172:175], a[192:195], v[52:55]
ds_read_b64_tr_b16 v[164:165], v219 offset:24576
v_mfma_f32_16x16x32_bf16 v[52:55], v[176:179], a[208:211], v[52:55]
ds_read_b128 v[20:23], v227 offset:0
v_mfma_f32_16x16x32_bf16 v[56:59], v[176:179], a[212:215], v[56:59]
ds_read_b64_tr_b16 v[166:167], v219 offset:25088
v_mfma_f32_16x16x32_bf16 v[56:59], v[172:175], a[196:199], v[56:59]
v_mfma_f32_16x16x32_bf16 v[60:63], v[172:175], a[200:203], v[60:63]
ds_read_b64_tr_b16 v[168:169], v219 offset:28672
v_mfma_f32_16x16x32_bf16 v[60:63], v[176:179], a[216:219], v[60:63]
buffer_load_dword v212, v249, s[8:11], s28 offen
v_mfma_f32_16x16x32_bf16 v[64:67], v[176:179], a[220:223], v[64:67]
ds_read_b64_tr_b16 v[170:171], v219 offset:29184
v_mfma_f32_16x16x32_bf16 v[64:67], v[172:175], a[204:207], v[64:67]
s_waitcnt lgkmcnt(6)
v_mfma_f32_16x16x32_bf16 v[68:71], v[180:183], a[192:195], v[68:71]
ds_read_b64_tr_b16 v[172:173], v216 offset:32768
v_mfma_f32_16x16x32_bf16 v[68:71], v[184:187], a[208:211], v[68:71]
s_waitcnt vmcnt(12)
ds_read_b128 v[8:11], v226 offset:2048
v_mfma_f32_16x16x32_bf16 v[72:75], v[184:187], a[212:215], v[72:75]
ds_read_b64_tr_b16 v[174:175], v216 offset:33280
v_mfma_f32_16x16x32_bf16 v[72:75], v[180:183], a[196:199], v[72:75]
ds_read_b128 v[24:27], v227 offset:2048
v_mfma_f32_16x16x32_bf16 v[76:79], v[180:183], a[200:203], v[76:79]
ds_read_b64_tr_b16 v[176:177], v216 offset:36864
v_mfma_f32_16x16x32_bf16 v[76:79], v[184:187], a[216:219], v[76:79]
v_mfma_f32_16x16x32_bf16 v[80:83], v[184:187], a[220:223], v[80:83]
ds_read_b64_tr_b16 v[178:179], v216 offset:37376
v_mfma_f32_16x16x32_bf16 v[80:83], v[180:183], a[204:207], v[80:83]
s_waitcnt lgkmcnt(6)
v_mfma_f32_16x16x32_bf16 v[84:87], v[164:167], a[192:195], v[84:87]
s_bfe_u32 s69, s54, 0x40018
ds_read_b64_tr_b16 v[180:181], v217 offset:32768
s_mul_i32 s69, s69, 589824
v_mfma_f32_16x16x32_bf16 v[84:87], v[168:171], a[208:211], v[84:87]
s_add_u32 s69, s69, s62
s_add_u32 m0, s71, 24576
v_mfma_f32_16x16x32_bf16 v[88:91], v[168:171], a[212:215], v[88:91]
ds_read_b64_tr_b16 v[182:183], v217 offset:33280
v_mfma_f32_16x16x32_bf16 v[88:91], v[164:167], a[196:199], v[88:91]
s_waitcnt vmcnt(10)
ds_read_b128 v[12:15], v226 offset:4096
v_mfma_f32_16x16x32_bf16 v[92:95], v[164:167], a[200:203], v[92:95]
ds_read_b64_tr_b16 v[184:185], v217 offset:36864
v_mfma_f32_16x16x32_bf16 v[92:95], v[168:171], a[216:219], v[92:95]
ds_read_b128 v[28:31], v227 offset:4096
v_mfma_f32_16x16x32_bf16 v[96:99], v[168:171], a[220:223], v[96:99]
ds_read_b64_tr_b16 v[186:187], v217 offset:37376
v_mfma_f32_16x16x32_bf16 v[96:99], v[164:167], a[204:207], v[96:99]
s_waitcnt lgkmcnt(6)
buffer_load_dwordx4 v221, s[12:15], s69 offen offset:0  lds
v_mfma_f32_16x16x32_bf16 v[36:39], v[172:175], a[224:227], v[36:39]
ds_read_b64_tr_b16 v[164:165], v218 offset:32768
v_mfma_f32_16x16x32_bf16 v[36:39], v[176:179], a[240:243], v[36:39]
buffer_load_dwordx4 v222, s[12:15], s69 offen offset:1024  lds
v_mfma_f32_16x16x32_bf16 v[40:43], v[176:179], a[244:247], v[40:43]
s_bfe_u32 s69, s54, 0x4001c
ds_read_b64_tr_b16 v[166:167], v218 offset:33280
s_mul_i32 s69, s69, 589824
v_mfma_f32_16x16x32_bf16 v[40:43], v[172:175], a[228:231], v[40:43]
s_add_u32 s69, s69, s62
s_add_u32 m0, s71, 32768
v_mfma_f32_16x16x32_bf16 v[44:47], v[172:175], a[232:235], v[44:47]
ds_read_b64_tr_b16 v[168:169], v218 offset:36864
v_mfma_f32_16x16x32_bf16 v[44:47], v[176:179], a[248:251], v[44:47]
s_waitcnt vmcnt(10)
ds_read_b128 v[16:19], v226 offset:6144
v_mfma_f32_16x16x32_bf16 v[48:51], v[176:179], a[252:255], v[48:51]
ds_read_b64_tr_b16 v[170:171], v218 offset:37376
v_mfma_f32_16x16x32_bf16 v[48:51], v[172:175], a[236:239], v[48:51]
s_waitcnt lgkmcnt(5)
ds_read_b128 v[32:35], v227 offset:6144
v_mfma_f32_16x16x32_bf16 v[52:55], v[180:183], a[224:227], v[52:55]
ds_read_b64_tr_b16 v[172:173], v219 offset:32768
v_mfma_f32_16x16x32_bf16 v[52:55], v[184:187], a[240:243], v[52:55]
v_mfma_f32_16x16x32_bf16 v[56:59], v[184:187], a[244:247], v[56:59]
ds_read_b64_tr_b16 v[174:175], v219 offset:33280
v_mfma_f32_16x16x32_bf16 v[56:59], v[180:183], a[228:231], v[56:59]
buffer_load_dwordx4 v221, s[12:15], s69 offen offset:0  lds
v_mfma_f32_16x16x32_bf16 v[60:63], v[180:183], a[232:235], v[60:63]
ds_read_b64_tr_b16 v[176:177], v219 offset:36864
v_mfma_f32_16x16x32_bf16 v[60:63], v[184:187], a[248:251], v[60:63]
v_mfma_f32_16x16x32_bf16 v[64:67], v[184:187], a[252:255], v[64:67]
ds_read_b64_tr_b16 v[178:179], v219 offset:37376
v_mfma_f32_16x16x32_bf16 v[64:67], v[180:183], a[236:239], v[64:67]
s_waitcnt lgkmcnt(5)
v_mfma_f32_16x16x32_bf16 v[68:71], v[164:167], a[224:227], v[68:71]
ds_read_b64_tr_b16 v[180:181], v216 offset:40960
v_mfma_f32_16x16x32_bf16 v[68:71], v[168:171], a[240:243], v[68:71]
v_mfma_f32_16x16x32_bf16 v[72:75], v[168:171], a[244:247], v[72:75]
ds_read_b64_tr_b16 v[182:183], v216 offset:41472
v_mfma_f32_16x16x32_bf16 v[72:75], v[164:167], a[228:231], v[72:75]
buffer_load_dwordx4 v222, s[12:15], s69 offen offset:1024  lds
v_mfma_f32_16x16x32_bf16 v[76:79], v[164:167], a[232:235], v[76:79]
s_bfe_u32 s69, s55, 0x40000
ds_read_b64_tr_b16 v[184:185], v216 offset:45056
s_mul_i32 s69, s69, 589824
v_mfma_f32_16x16x32_bf16 v[76:79], v[168:171], a[248:251], v[76:79]
s_add_u32 s69, s69, s62
s_add_u32 m0, s71, 40960
v_mfma_f32_16x16x32_bf16 v[80:83], v[168:171], a[252:255], v[80:83]
ds_read_b64_tr_b16 v[186:187], v216 offset:45568
v_mfma_f32_16x16x32_bf16 v[80:83], v[164:167], a[236:239], v[80:83]
s_waitcnt lgkmcnt(4)
v_mfma_f32_16x16x32_bf16 v[84:87], v[172:175], a[224:227], v[84:87]
ds_read_b64_tr_b16 v[164:165], v217 offset:40960
v_add_u32 v216, 0xffff4000, v216
v_mfma_f32_16x16x32_bf16 v[84:87], v[176:179], a[240:243], v[84:87]
v_mfma_f32_16x16x32_bf16 v[88:91], v[176:179], a[244:247], v[88:91]
ds_read_b64_tr_b16 v[166:167], v217 offset:41472
v_mfma_f32_16x16x32_bf16 v[88:91], v[172:175], a[228:231], v[88:91]
v_mfma_f32_16x16x32_bf16 v[92:95], v[172:175], a[232:235], v[92:95]
ds_read_b64_tr_b16 v[168:169], v217 offset:45056
v_mfma_f32_16x16x32_bf16 v[92:95], v[176:179], a[248:251], v[92:95]
buffer_load_dwordx4 v221, s[12:15], s69 offen offset:0  lds
v_mfma_f32_16x16x32_bf16 v[96:99], v[176:179], a[252:255], v[96:99]
ds_read_b64_tr_b16 v[170:171], v217 offset:45568
v_mfma_f32_16x16x32_bf16 v[96:99], v[172:175], a[236:239], v[96:99]
s_waitcnt lgkmcnt(4)
v_mfma_f32_16x16x32_bf16 v[36:39], v[180:183], v[4:7], v[36:39]
ds_read_b64_tr_b16 v[172:173], v218 offset:40960
v_add_u32 v217, 0xffff4000, v217
v_mfma_f32_16x16x32_bf16 v[36:39], v[184:187], v[20:23], v[36:39]
v_mfma_f32_16x16x32_bf16 v[40:43], v[184:187], v[24:27], v[40:43]
ds_read_b64_tr_b16 v[174:175], v218 offset:41472
v_mfma_f32_16x16x32_bf16 v[40:43], v[180:183], v[8:11], v[40:43]
v_mfma_f32_16x16x32_bf16 v[44:47], v[180:183], v[12:15], v[44:47]
ds_read_b64_tr_b16 v[176:177], v218 offset:45056
v_mfma_f32_16x16x32_bf16 v[44:47], v[184:187], v[28:31], v[44:47]
buffer_load_dwordx4 v222, s[12:15], s69 offen offset:1024  lds
v_mfma_f32_16x16x32_bf16 v[48:51], v[184:187], v[32:35], v[48:51]
ds_read_b64_tr_b16 v[178:179], v218 offset:45568
v_mul_f32 v230, s74, v36
v_mfma_f32_16x16x32_bf16 v[48:51], v[180:183], v[16:19], v[48:51]
s_waitcnt lgkmcnt(4)
v_exp_f32 v230, v230
v_mfma_f32_16x16x32_bf16 v[52:55], v[164:167], v[4:7], v[52:55]
ds_read_b64_tr_b16 v[180:181], v219 offset:40960
v_add_u32 v218, 0xffff4000, v218
v_mfma_f32_16x16x32_bf16 v[52:55], v[168:171], v[20:23], v[52:55]
ds_read_b64_tr_b16 v[182:183], v219 offset:41472
v_add_f32 v230, 1.0, v230
v_mfma_f32_16x16x32_bf16 v[56:59], v[168:171], v[24:27], v[56:59]
ds_read_b64_tr_b16 v[184:185], v219 offset:45056
v_mul_f32 v231, s74, v37
v_mfma_f32_16x16x32_bf16 v[56:59], v[164:167], v[8:11], v[56:59]
ds_read_b64_tr_b16 v[186:187], v219 offset:45568
v_mul_f32 v232, s74, v38
v_mfma_f32_16x16x32_bf16 v[60:63], v[164:167], v[12:15], v[60:63]
v_rcp_f32 v230, v230
v_mfma_f32_16x16x32_bf16 v[60:63], v[168:171], v[28:31], v[60:63]
v_exp_f32 v231, v231
v_mfma_f32_16x16x32_bf16 v[64:67], v[168:171], v[32:35], v[64:67]
s_bfe_u32 s69, s54, 0x40000
v_exp_f32 v232, v232
v_mfma_f32_16x16x32_bf16 v[64:67], v[164:167], v[16:19], v[64:67]
s_waitcnt vmcnt(7) lgkmcnt(0)
s_barrier
v_mfma_f32_16x16x32_bf16 v[68:71], v[172:175], v[4:7], v[68:71]
s_mul_i32 s69, s69, 589824
ds_read_b64_tr_b16 v[164:165], v216 offset:0
v_add_u32 v219, 0xffff4000, v219
v_mfma_f32_16x16x32_bf16 v[68:71], v[176:179], v[20:23], v[68:71]
s_add_u32 s69, s69, s63
v_mul_f32 v36, v36, v230
v_add_f32 v231, 1.0, v231
v_mfma_f32_16x16x32_bf16 v[72:75], v[176:179], v[24:27], v[72:75]
s_add_u32 m0, s71, 49152
ds_read_b64_tr_b16 v[166:167], v216 offset:512
v_add_f32 v232, 1.0, v232
v_mfma_f32_16x16x32_bf16 v[72:75], v[172:175], v[8:11], v[72:75]
s_lshr_b32 s56, s2, 5
buffer_load_dwordx4 v221, s[8:11], s69 offen offset:0  lds
v_mfma_f32_16x16x32_bf16 v[76:79], v[172:175], v[12:15], v[76:79]
s_and_b32 s57, s2, 4
ds_read_b64_tr_b16 v[168:169], v216 offset:4096
v_mul_f32 v230, s74, v39
v_mfma_f32_16x16x32_bf16 v[76:79], v[176:179], v[28:31], v[76:79]
s_lshl1_add_u32 s56, s57, s56
v_rcp_f32 v231, v231
v_mfma_f32_16x16x32_bf16 v[80:83], v[176:179], v[32:35], v[80:83]
s_and_b32 s32, s2, 3
ds_read_b64_tr_b16 v[170:171], v216 offset:4608
v_mul_f32 v37, v37, v231
v_mfma_f32_16x16x32_bf16 v[80:83], v[172:175], v[16:19], v[80:83]
s_lshr_b32 s33, s3, 1
buffer_load_dwordx4 v222, s[8:11], s69 offen offset:1024  lds
v_mfma_f32_16x16x32_bf16 v[84:87], v[180:183], v[4:7], v[84:87]
s_bfe_u32 s69, s54, 0x40004
ds_read_b64_tr_b16 v[172:173], v217 offset:0
v_mul_f32 v231, s74, v40
v_mfma_f32_16x16x32_bf16 v[84:87], v[184:187], v[20:23], v[84:87]
s_mul_i32 s69, s69, 589824
v_rcp_f32 v232, v232
v_mfma_f32_16x16x32_bf16 v[88:91], v[184:187], v[24:27], v[88:91]
s_add_u32 s69, s69, s63
ds_read_b64_tr_b16 v[174:175], v217 offset:512
v_mul_f32 v38, v38, v232
v_mfma_f32_16x16x32_bf16 v[88:91], v[180:183], v[8:11], v[88:91]
s_add_u32 m0, s71, 57344
v_exp_f32 v230, v230
v_mfma_f32_16x16x32_bf16 v[92:95], v[180:183], v[12:15], v[92:95]
s_mul_i32 s30, s32, 1327104
ds_read_b64_tr_b16 v[176:177], v217 offset:4096
v_add_f32 v230, 1.0, v230
v_mfma_f32_16x16x32_bf16 v[92:95], v[184:187], v[28:31], v[92:95]
s_lshl_b32 s31, s59, 5
v_rcp_f32 v230, v230
v_mfma_f32_16x16x32_bf16 v[96:99], v[184:187], v[32:35], v[96:99]
s_add_u32 s31, s31, s30
ds_read_b64_tr_b16 v[178:179], v217 offset:4608
v_mul_f32 v39, v39, v230
v_mfma_f32_16x16x32_bf16 v[96:99], v[180:183], v[16:19], v[96:99]
s_waitcnt lgkmcnt(4)
v_exp_f32 v231, v231
v_mfma_f32_16x16x32_bf16 v[100:103], v[164:167], a[96:99], v[100:103]
s_add_u32 s31, s31, 1024
ds_read_b64_tr_b16 v[180:181], v218 offset:0
v_add_f32 v231, 1.0, v231
v_mfma_f32_16x16x32_bf16 v[100:103], v[168:171], a[112:115], v[100:103]
s_lshl_b32 s57, s59, 8
buffer_load_dwordx4 v221, s[8:11], s69 offen offset:0  lds
v_mfma_f32_16x16x32_bf16 v[104:107], v[168:171], a[116:119], v[104:107]
s_add_u32 s30, s30, s57
ds_read_b64_tr_b16 v[182:183], v218 offset:512
v_mul_f32 v232, s74, v41
v_mfma_f32_16x16x32_bf16 v[104:107], v[164:167], a[100:103], v[104:107]
s_and_b32 s57, s32, 1
v_rcp_f32 v231, v231
v_mfma_f32_16x16x32_bf16 v[108:111], v[164:167], a[104:107], v[108:111]
s_lshl_b32 s57, s57, 7
ds_read_b64_tr_b16 v[184:185], v218 offset:4096
v_mul_f32 v40, v40, v231
v_mfma_f32_16x16x32_bf16 v[108:111], v[168:171], a[120:123], v[108:111]
s_add_u32 s66, s30, s57
v_exp_f32 v232, v232
v_mfma_f32_16x16x32_bf16 v[112:115], v[168:171], a[124:127], v[112:115]
s_xor_b32 s30, s66, 128
ds_read_b64_tr_b16 v[186:187], v218 offset:4608
v_add_f32 v232, 1.0, v232
v_mfma_f32_16x16x32_bf16 v[112:115], v[164:167], a[108:111], v[112:115]
s_waitcnt lgkmcnt(4)
v_rcp_f32 v232, v232
v_mfma_f32_16x16x32_bf16 v[116:119], v[172:175], a[96:99], v[116:119]
s_and_b32 s57, s3, 1
ds_read_b64_tr_b16 v[164:165], v219 offset:0
v_mul_f32 v41, v41, v232
v_mfma_f32_16x16x32_bf16 v[116:119], v[176:179], a[112:115], v[116:119]
s_mul_i32 s35, s33, 10
buffer_load_dwordx4 v222, s[8:11], s69 offen offset:1024  lds
v_mfma_f32_16x16x32_bf16 v[120:123], v[176:179], a[116:119], v[120:123]
s_bfe_u32 s69, s54, 0x40008
ds_read_b64_tr_b16 v[166:167], v219 offset:512
v_mul_f32 v230, s74, v42
v_mfma_f32_16x16x32_bf16 v[120:123], v[172:175], a[100:103], v[120:123]
s_mul_i32 s69, s69, 589824
v_exp_f32 v230, v230
v_mfma_f32_16x16x32_bf16 v[124:127], v[172:175], a[104:107], v[124:127]
s_add_u32 s69, s69, s63
ds_read_b64_tr_b16 v[168:169], v219 offset:4096
v_add_f32 v230, 1.0, v230
v_mfma_f32_16x16x32_bf16 v[124:127], v[176:179], a[120:123], v[124:127]
s_add_u32 m0, s71, 65536
v_rcp_f32 v230, v230
v_mfma_f32_16x16x32_bf16 v[128:131], v[176:179], a[124:127], v[128:131]
s_add_u32 s35, s35, s57
ds_read_b64_tr_b16 v[170:171], v219 offset:4608
v_mul_f32 v42, v42, v230
v_mfma_f32_16x16x32_bf16 v[128:131], v[172:175], a[108:111], v[128:131]
s_waitcnt lgkmcnt(4)
v_mul_f32 v231, s74, v43
v_mul_f32 v232, s74, v44
v_mfma_f32_16x16x32_bf16 v[132:135], v[180:183], a[96:99], v[132:135]
s_lshl_b32 s35, s35, 10
ds_read_b64_tr_b16 v[172:173], v216 offset:8192
v_mul_f32 v230, s74, v45
v_mfma_f32_16x16x32_bf16 v[132:135], v[184:187], a[112:115], v[132:135]
s_mul_i32 s34, s33, 12
v_exp_f32 v231, v231
v_mfma_f32_16x16x32_bf16 v[136:139], v[184:187], a[116:119], v[136:139]
s_add_u32 s34, s34, s57
ds_read_b64_tr_b16 v[174:175], v216 offset:8704
v_add_f32 v231, 1.0, v231
v_mfma_f32_16x16x32_bf16 v[136:139], v[180:183], a[100:103], v[136:139]
s_lshl_b32 s34, s34, 10
buffer_load_dwordx4 v221, s[8:11], s69 offen offset:0  lds
v_mfma_f32_16x16x32_bf16 v[140:143], v[180:183], a[104:107], v[140:143]
s_mul_i32 s83, s33, 64
ds_read_b64_tr_b16 v[176:177], v216 offset:12288
v_mul_f32 v235, s74, v68
v_mfma_f32_16x16x32_bf16 v[140:143], v[184:187], a[120:123], v[140:143]
s_xor_b32 s57, s57, 1
v_rcp_f32 v231, v231
v_mfma_f32_16x16x32_bf16 v[144:147], v[184:187], a[124:127], v[144:147]
s_mul_i32 s84, s83, s57
ds_read_b64_tr_b16 v[178:179], v216 offset:12800
v_mul_f32 v43, v43, v231
v_mfma_f32_16x16x32_bf16 v[144:147], v[180:183], a[108:111], v[144:147]
s_waitcnt lgkmcnt(4)
v_exp_f32 v232, v232
v_mfma_f32_16x16x32_bf16 v[148:151], v[164:167], a[96:99], v[148:151]
s_lshr_b32 s57, s56, 1
ds_read_b64_tr_b16 v[180:181], v217 offset:8192
v_add_f32 v232, 1.0, v232
v_mfma_f32_16x16x32_bf16 v[148:151], v[168:171], a[112:115], v[148:151]
s_lshl2_add_u32 s57, s57, s32
v_rcp_f32 v232, v232
v_mfma_f32_16x16x32_bf16 v[152:155], v[168:171], a[116:119], v[152:155]
s_lshl1_add_u32 s57, s57, s33
ds_read_b64_tr_b16 v[182:183], v217 offset:8704
v_mul_f32 v44, v44, v232
v_mfma_f32_16x16x32_bf16 v[152:155], v[164:167], a[100:103], v[152:155]
s_and_b32 s58, s56, 1
buffer_load_dwordx4 v222, s[8:11], s69 offen offset:1024  lds
v_mfma_f32_16x16x32_bf16 v[156:159], v[164:167], a[104:107], v[156:159]
s_lshl1_add_u32 s57, s57, s58
ds_read_b64_tr_b16 v[184:185], v217 offset:12288
v_mul_f32 v231, s74, v46
v_mfma_f32_16x16x32_bf16 v[156:159], v[168:171], a[120:123], v[156:159]
s_lshl_b32 s57, s57, 8
v_exp_f32 v230, v230
v_mfma_f32_16x16x32_bf16 v[160:163], v[168:171], a[124:127], v[160:163]
s_add_u32 s72, s57, 47185920
ds_read_b64_tr_b16 v[186:187], v217 offset:12800
v_add_f32 v230, 1.0, v230
v_mfma_f32_16x16x32_bf16 v[160:163], v[164:167], a[108:111], v[160:163]
s_waitcnt lgkmcnt(4)
v_rcp_f32 v230, v230
v_mfma_f32_16x16x32_bf16 v[100:103], v[172:175], a[128:131], v[100:103]
s_lshr_b32 s58, s32, 1
ds_read_b64_tr_b16 v[164:165], v218 offset:8192
v_mul_f32 v45, v45, v230
v_mfma_f32_16x16x32_bf16 v[100:103], v[176:179], a[144:147], v[100:103]
s_lshl1_add_u32 s56, s56, s58
v_exp_f32 v231, v231
v_mfma_f32_16x16x32_bf16 v[104:107], v[176:179], a[148:151], v[104:107]
s_and_b32 s58, s3, 1
ds_read_b64_tr_b16 v[166:167], v218 offset:8704
v_add_f32 v231, 1.0, v231
v_mfma_f32_16x16x32_bf16 v[104:107], v[172:175], a[132:135], v[104:107]
s_lshl1_add_u32 s56, s56, s58
v_rcp_f32 v231, v231
v_mfma_f32_16x16x32_bf16 v[108:111], v[172:175], a[136:139], v[108:111]
s_bfe_u32 s69, s54, 0x4000c
ds_read_b64_tr_b16 v[168:169], v218 offset:12288
v_mul_f32 v46, v46, v231
v_mfma_f32_16x16x32_bf16 v[108:111], v[176:179], a[152:155], v[108:111]
s_mul_i32 s69, s69, 589824
v_exp_f32 v235, v235
v_mfma_f32_16x16x32_bf16 v[112:115], v[176:179], a[156:159], v[112:115]
s_add_u32 s69, s69, s63
ds_read_b64_tr_b16 v[170:171], v218 offset:12800
v_mul_f32 v232, s74, v47
v_mfma_f32_16x16x32_bf16 v[112:115], v[172:175], a[140:143], v[112:115]
s_waitcnt lgkmcnt(4)
v_exp_f32 v232, v232
v_mfma_f32_16x16x32_bf16 v[116:119], v[180:183], a[128:131], v[116:119]
s_add_u32 m0, s71, 73728
ds_read_b64_tr_b16 v[172:173], v219 offset:8192
v_add_f32 v232, 1.0, v232
v_mfma_f32_16x16x32_bf16 v[116:119], v[184:187], a[144:147], v[116:119]
PAD_2:
s_cmp_lg_u32 s73, 0
s_cbranch_scc1 PAD_6
s_lshl1_add_u32 s67, s56, s33
buffer_load_dwordx4 v221, s[8:11], s69 offen offset:0  lds
v_mfma_f32_16x16x32_bf16 v[120:123], v[184:187], a[148:151], v[120:123]
s_lshl1_add_u32 s57, s32, s33
ds_read_b64_tr_b16 v[174:175], v219 offset:8704
v_mul_f32 v230, s74, v48
v_mfma_f32_16x16x32_bf16 v[120:123], v[180:183], a[132:135], v[120:123]
s_mul_i32 s57, s57, 18432
v_rcp_f32 v232, v232
v_mfma_f32_16x16x32_bf16 v[124:127], v[180:183], a[136:139], v[124:127]
s_add_u32 s57, s57, 1048576
ds_read_b64_tr_b16 v[176:177], v219 offset:12288
v_mul_f32 v47, v47, v232
v_mfma_f32_16x16x32_bf16 v[124:127], v[184:187], a[152:155], v[124:127]
s_xor_b32 s58, s67, 4
buffer_load_dwordx4 v222, s[8:11], s69 offen offset:1024  lds
v_mfma_f32_16x16x32_bf16 v[128:131], v[184:187], a[156:159], v[128:131]
s_bfe_u32 s69, s54, 0x40010
ds_read_b64_tr_b16 v[178:179], v219 offset:12800
v_mul_f32 v231, s74, v49
v_mfma_f32_16x16x32_bf16 v[128:131], v[180:183], a[140:143], v[128:131]
s_waitcnt lgkmcnt(4)
v_exp_f32 v230, v230
v_mfma_f32_16x16x32_bf16 v[132:135], v[164:167], a[128:131], v[132:135]
s_mul_i32 s69, s69, 589824
ds_read_b64_tr_b16 v[180:181], v216 offset:16384
v_add_f32 v230, 1.0, v230
v_mfma_f32_16x16x32_bf16 v[132:135], v[168:171], a[144:147], v[132:135]
s_add_u32 s69, s69, s63
v_rcp_f32 v230, v230
v_mfma_f32_16x16x32_bf16 v[136:139], v[168:171], a[148:151], v[136:139]
s_add_u32 m0, s71, 81920
ds_read_b64_tr_b16 v[182:183], v216 offset:16896
v_mul_f32 v48, v48, v230
v_mfma_f32_16x16x32_bf16 v[136:139], v[164:167], a[132:135], v[136:139]
s_mul_i32 s58, s58, 147456
v_exp_f32 v231, v231
v_mfma_f32_16x16x32_bf16 v[140:143], v[164:167], a[136:139], v[140:143]
s_add_u32 s44, s58, s57
ds_read_b64_tr_b16 v[184:185], v216 offset:20480
v_add_f32 v231, 1.0, v231
v_mfma_f32_16x16x32_bf16 v[140:143], v[168:171], a[152:155], v[140:143]
s_xor_b32 s58, s67, 0
v_rcp_f32 v231, v231
v_mfma_f32_16x16x32_bf16 v[144:147], v[168:171], a[156:159], v[144:147]
s_mul_i32 s58, s58, 147456
ds_read_b64_tr_b16 v[186:187], v216 offset:20992
v_mul_f32 v49, v49, v231
v_mfma_f32_16x16x32_bf16 v[144:147], v[164:167], a[140:143], v[144:147]
s_waitcnt lgkmcnt(4)
buffer_load_dwordx4 v221, s[8:11], s69 offen offset:0  lds
v_mfma_f32_16x16x32_bf16 v[148:151], v[172:175], a[128:131], v[148:151]
s_add_u32 s45, s58, s57
ds_read_b64_tr_b16 v[164:165], v217 offset:16384
v_mul_f32 v232, s74, v50
v_mfma_f32_16x16x32_bf16 v[148:151], v[176:179], a[144:147], v[148:151]
s_xor_b32 s58, s67, 5
v_exp_f32 v232, v232
v_mfma_f32_16x16x32_bf16 v[152:155], v[176:179], a[148:151], v[152:155]
s_mul_i32 s58, s58, 147456
ds_read_b64_tr_b16 v[166:167], v217 offset:16896
v_add_f32 v232, 1.0, v232
v_mfma_f32_16x16x32_bf16 v[152:155], v[172:175], a[132:135], v[152:155]
s_add_u32 s46, s58, s57
v_rcp_f32 v232, v232
v_mfma_f32_16x16x32_bf16 v[156:159], v[172:175], a[136:139], v[156:159]
s_xor_b32 s58, s67, 1
ds_read_b64_tr_b16 v[168:169], v217 offset:20480
v_mul_f32 v50, v50, v232
v_mfma_f32_16x16x32_bf16 v[156:159], v[176:179], a[152:155], v[156:159]
s_mul_i32 s58, s58, 147456
v_mul_f32 v230, s74, v51
v_mul_f32 v231, s74, v52
v_mfma_f32_16x16x32_bf16 v[160:163], v[176:179], a[156:159], v[160:163]
s_add_u32 s47, s58, s57
ds_read_b64_tr_b16 v[170:171], v217 offset:20992
v_mul_f32 v232, s74, v53
v_mfma_f32_16x16x32_bf16 v[160:163], v[172:175], a[140:143], v[160:163]
s_waitcnt lgkmcnt(4)
buffer_load_dwordx4 v222, s[8:11], s69 offen offset:1024  lds
v_mfma_f32_16x16x32_bf16 v[100:103], v[180:183], a[160:163], v[100:103]
s_bfe_u32 s69, s54, 0x40014
ds_read_b64_tr_b16 v[172:173], v218 offset:16384
v_add_f32 v235, 1.0, v235
v_mfma_f32_16x16x32_bf16 v[100:103], v[184:187], a[176:179], v[100:103]
s_mul_i32 s69, s69, 589824
v_exp_f32 v230, v230
v_mfma_f32_16x16x32_bf16 v[104:107], v[184:187], a[180:183], v[104:107]
s_add_u32 s69, s69, s63
ds_read_b64_tr_b16 v[174:175], v218 offset:16896
v_add_f32 v230, 1.0, v230
v_mfma_f32_16x16x32_bf16 v[104:107], v[180:183], a[164:167], v[104:107]
s_add_u32 m0, s71, 90112
v_rcp_f32 v230, v230
v_mfma_f32_16x16x32_bf16 v[108:111], v[180:183], a[168:171], v[108:111]
s_lshr_b32 s56, s67, 3
ds_read_b64_tr_b16 v[176:177], v218 offset:20480
v_mul_f32 v51, v51, v230
v_mfma_f32_16x16x32_bf16 v[108:111], v[184:187], a[184:187], v[108:111]
s_and_b32 s57, s67, 3
v_exp_f32 v231, v231
v_mfma_f32_16x16x32_bf16 v[112:115], v[184:187], a[188:191], v[112:115]
s_lshl2_add_u32 s56, s56, s59
ds_read_b64_tr_b16 v[178:179], v218 offset:20992
v_add_f32 v231, 1.0, v231
v_mfma_f32_16x16x32_bf16 v[112:115], v[180:183], a[172:175], v[112:115]
s_waitcnt lgkmcnt(4)
v_rcp_f32 v231, v231
v_mfma_f32_16x16x32_bf16 v[116:119], v[164:167], a[160:163], v[116:119]
s_lshl2_add_u32 s56, s56, s57
ds_read_b64_tr_b16 v[180:181], v219 offset:16384
v_mul_f32 v52, v52, v231
v_mfma_f32_16x16x32_bf16 v[116:119], v[168:171], a[176:179], v[116:119]
s_mul_i32 s56, s56, 9344
ds_read_b64_tr_b16 v[182:183], v219 offset:16896
v_mul_f32 v230, s74, v54
v_mfma_f32_16x16x32_bf16 v[120:123], v[168:171], a[180:183], v[120:123]
s_lshl_b32 s57, s32, 22
ds_read_b64_tr_b16 v[184:185], v219 offset:20480
v_mul_f32 v231, s74, v55
v_mfma_f32_16x16x32_bf16 v[120:123], v[164:167], a[164:167], v[120:123]
s_add_u32 s56, s56, s57
ds_read_b64_tr_b16 v[186:187], v219 offset:20992
v_mov_b32 v224, -1
v_mfma_f32_16x16x32_bf16 v[124:127], v[164:167], a[168:171], v[124:127]
s_add_u32 s82, s56, 20971520
buffer_load_dwordx4 v221, s[8:11], s69 offen offset:0  lds
v_mfma_f32_16x16x32_bf16 v[124:127], v[168:171], a[184:187], v[124:127]
s_xor_b32 s57, s56, 4194304
v_exp_f32 v232, v232
v_mfma_f32_16x16x32_bf16 v[128:131], v[168:171], a[188:191], v[128:131]
s_add_u32 s79, s57, 20971520
v_exp_f32 v230, v230
v_mfma_f32_16x16x32_bf16 v[128:131], v[164:167], a[172:175], v[128:131]
s_waitcnt vmcnt(11) lgkmcnt(0)
s_barrier
v_mfma_f32_16x16x32_bf16 v[132:135], v[172:175], a[160:163], v[132:135]
s_xor_b32 s57, s56, 12582912
ds_read_b64_tr_b16 v[164:165], v216 offset:24576
v_add_f32 v232, 1.0, v232
v_mfma_f32_16x16x32_bf16 v[132:135], v[176:179], a[176:179], v[132:135]
s_add_u32 s80, s57, 20973568
buffer_load_dwordx4 v222, s[8:11], s69 offen offset:1024  lds
v_mfma_f32_16x16x32_bf16 v[136:139], v[176:179], a[180:183], v[136:139]
s_xor_b32 s57, s56, 8388608
ds_read_b64_tr_b16 v[166:167], v216 offset:25088
v_add_f32 v230, 1.0, v230
v_mfma_f32_16x16x32_bf16 v[136:139], v[172:175], a[164:167], v[136:139]
s_add_u32 s81, s57, 20975616
v_rcp_f32 v232, v232
v_mfma_f32_16x16x32_bf16 v[140:143], v[172:175], a[168:171], v[140:143]
s_xor_b32 s57, s32, s33
ds_read_b64_tr_b16 v[168:169], v216 offset:28672
v_mul_f32 v53, v53, v232
v_mfma_f32_16x16x32_bf16 v[140:143], v[176:179], a[184:187], v[140:143]
s_and_b32 s57, s57, 1
v_rcp_f32 v230, v230
v_mfma_f32_16x16x32_bf16 v[144:147], v[176:179], a[188:191], v[144:147]
s_lshl_b32 s58, s57, 22
ds_read_b64_tr_b16 v[170:171], v216 offset:29184
v_mul_f32 v54, v54, v230
v_mfma_f32_16x16x32_bf16 v[144:147], v[172:175], a[172:175], v[144:147]
s_xor_b32 s56, s56, s58
v_exp_f32 v231, v231
v_mfma_f32_16x16x32_bf16 v[148:151], v[180:183], a[160:163], v[148:151]
s_xor_b32 s40, s56, 8388608
ds_read_b64_tr_b16 v[172:173], v217 offset:24576
v_add_f32 v231, 1.0, v231
v_mfma_f32_16x16x32_bf16 v[148:151], v[184:187], a[176:179], v[148:151]
s_lshl_b32 s58, s57, 9
v_rcp_f32 v231, v231
v_mfma_f32_16x16x32_bf16 v[152:155], v[184:187], a[180:183], v[152:155]
s_bfe_u32 s69, s54, 0x40018
ds_read_b64_tr_b16 v[174:175], v217 offset:25088
v_mul_f32 v55, v55, v231
v_mfma_f32_16x16x32_bf16 v[152:155], v[180:183], a[164:167], v[152:155]
s_mul_i32 s69, s69, 589824
v_rcp_f32 v235, v235
v_mfma_f32_16x16x32_bf16 v[156:159], v[180:183], a[168:171], v[156:159]
s_add_u32 s69, s69, s63
ds_read_b64_tr_b16 v[176:177], v217 offset:28672
v_mul_f32 v232, s74, v56
v_mfma_f32_16x16x32_bf16 v[156:159], v[184:187], a[184:187], v[156:159]
s_add_u32 m0, s71, 0
v_exp_f32 v232, v232
v_mfma_f32_16x16x32_bf16 v[160:163], v[184:187], a[188:191], v[160:163]
s_add_u32 s40, s40, s58
ds_read_b64_tr_b16 v[178:179], v217 offset:29184
v_add_f32 v232, 1.0, v232
v_mfma_f32_16x16x32_bf16 v[160:163], v[180:183], a[172:175], v[160:163]
s_waitcnt lgkmcnt(4)
buffer_load_dwordx4 v221, s[8:11], s69 offen offset:0  lds
v_mfma_f32_16x16x32_bf16 v[100:103], v[164:167], a[192:195], v[100:103]
s_add_u32 s40, s40, 20978176
ds_read_b64_tr_b16 v[180:181], v218 offset:24576
v_mul_f32 v230, s74, v57
v_mfma_f32_16x16x32_bf16 v[100:103], v[168:171], a[208:211], v[100:103]
s_lshl_b32 s57, s57, 30
v_rcp_f32 v232, v232
v_mfma_f32_16x16x32_bf16 v[104:107], v[168:171], a[212:215], v[104:107]
s_xor_b32 s58, s57, 1073741824
ds_read_b64_tr_b16 v[182:183], v218 offset:25088
v_mul_f32 v56, v56, v232
v_mfma_f32_16x16x32_bf16 v[104:107], v[164:167], a[196:199], v[104:107]
s_add_u32 s56, s56, s58
buffer_load_dwordx4 v222, s[8:11], s69 offen offset:1024  lds
v_mfma_f32_16x16x32_bf16 v[108:111], v[164:167], a[200:203], v[108:111]
s_bfe_u32 s69, s54, 0x4001c
ds_read_b64_tr_b16 v[184:185], v218 offset:28672
v_mul_f32 v231, s74, v58
v_mfma_f32_16x16x32_bf16 v[108:111], v[168:171], a[216:219], v[108:111]
s_mul_i32 s69, s69, 589824
v_exp_f32 v230, v230
v_mfma_f32_16x16x32_bf16 v[112:115], v[168:171], a[220:223], v[112:115]
s_add_u32 s69, s69, s63
ds_read_b64_tr_b16 v[186:187], v218 offset:29184
v_add_f32 v230, 1.0, v230
v_mfma_f32_16x16x32_bf16 v[112:115], v[164:167], a[204:207], v[112:115]
s_waitcnt lgkmcnt(4)
v_rcp_f32 v230, v230
v_mfma_f32_16x16x32_bf16 v[116:119], v[172:175], a[192:195], v[116:119]
s_add_u32 m0, s71, 8192
ds_read_b64_tr_b16 v[164:165], v219 offset:24576
v_mul_f32 v57, v57, v230
v_mfma_f32_16x16x32_bf16 v[116:119], v[176:179], a[208:211], v[116:119]
s_add_u32 s41, s56, 20977664
v_exp_f32 v231, v231
v_mfma_f32_16x16x32_bf16 v[120:123], v[176:179], a[212:215], v[120:123]
s_add_u32 s36, s82, s57
ds_read_b64_tr_b16 v[166:167], v219 offset:25088
v_add_f32 v231, 1.0, v231
v_mfma_f32_16x16x32_bf16 v[120:123], v[172:175], a[196:199], v[120:123]
s_add_u32 s36, s36, 6144
v_rcp_f32 v231, v231
v_mfma_f32_16x16x32_bf16 v[124:127], v[172:175], a[200:203], v[124:127]
s_mov_b32 s37, s57
ds_read_b64_tr_b16 v[168:169], v219 offset:28672
v_mul_f32 v58, v58, v231
v_mfma_f32_16x16x32_bf16 v[124:127], v[176:179], a[216:219], v[124:127]
s_lshr_b32 s56, s2, 3
buffer_load_dwordx4 v221, s[8:11], s69 offen offset:0  lds
v_mfma_f32_16x16x32_bf16 v[128:131], v[176:179], a[220:223], v[128:131]
s_lshl2_add_u32 s56, s56, s3
ds_read_b64_tr_b16 v[170:171], v219 offset:29184
v_mul_f32 v232, s74, v59
v_mfma_f32_16x16x32_bf16 v[128:131], v[172:175], a[204:207], v[128:131]
s_waitcnt lgkmcnt(4)
v_exp_f32 v232, v232
v_mfma_f32_16x16x32_bf16 v[132:135], v[180:183], a[192:195], v[132:135]
s_mul_i32 s56, s56, 10368
ds_read_b64_tr_b16 v[172:173], v216 offset:32768
v_add_f32 v232, 1.0, v232
v_mfma_f32_16x16x32_bf16 v[132:135], v[184:187], a[208:211], v[132:135]
s_mul_i32 s57, s32, 1327104
v_rcp_f32 v232, v232
v_mfma_f32_16x16x32_bf16 v[136:139], v[184:187], a[212:215], v[136:139]
s_add_u32 s56, s56, s57
ds_read_b64_tr_b16 v[174:175], v216 offset:33280
v_mul_f32 v59, v59, v232
v_mfma_f32_16x16x32_bf16 v[136:139], v[180:183], a[196:199], v[136:139]
s_bfe_u32 s57, s2, 0x10002
v_mul_f32 v230, s74, v60
v_mul_f32 v231, s74, v61
v_mfma_f32_16x16x32_bf16 v[140:143], v[180:183], a[200:203], v[140:143]
s_mul_i32 s57, s57, 5376
ds_read_b64_tr_b16 v[176:177], v216 offset:36864
v_mul_f32 v232, s74, v62
v_mfma_f32_16x16x32_bf16 v[140:143], v[184:187], a[216:219], v[140:143]
s_sub_u32 s58, s56, s57
buffer_load_dword v212, v249, s[12:15], s28 offen
v_mfma_f32_16x16x32_bf16 v[144:147], v[184:187], a[220:223], v[144:147]
s_add_u32 s56, s56, s57
ds_read_b64_tr_b16 v[178:179], v216 offset:37376
v_mov_b32 v225, -1
v_mfma_f32_16x16x32_bf16 v[144:147], v[180:183], a[204:207], v[144:147]
s_waitcnt lgkmcnt(4)
buffer_load_dwordx4 v222, s[8:11], s69 offen offset:1024  lds
v_mfma_f32_16x16x32_bf16 v[148:151], v[164:167], a[192:195], v[148:151]
s_bfe_u32 s69, s55, 0x40000
ds_read_b64_tr_b16 v[180:181], v217 offset:32768
v_mov_b32 v226, -1
v_mfma_f32_16x16x32_bf16 v[148:151], v[168:171], a[208:211], v[148:151]
s_mul_i32 s69, s69, 589824
v_exp_f32 v230, v230
v_mfma_f32_16x16x32_bf16 v[152:155], v[168:171], a[212:215], v[152:155]
s_add_u32 s69, s69, s63
ds_read_b64_tr_b16 v[182:183], v217 offset:33280
v_add_f32 v230, 1.0, v230
v_mfma_f32_16x16x32_bf16 v[152:155], v[164:167], a[196:199], v[152:155]
s_add_u32 m0, s71, 16384
v_rcp_f32 v230, v230
v_mfma_f32_16x16x32_bf16 v[156:159], v[164:167], a[200:203], v[156:159]
s_add_u32 s57, s58, 5376
ds_read_b64_tr_b16 v[184:185], v217 offset:36864
v_mul_f32 v60, v60, v230
v_mfma_f32_16x16x32_bf16 v[156:159], v[168:171], a[216:219], v[156:159]
v_exp_f32 v231, v231
v_mfma_f32_16x16x32_bf16 v[160:163], v[168:171], a[220:223], v[160:163]
ds_read_b64_tr_b16 v[186:187], v217 offset:37376
v_add_f32 v231, 1.0, v231
v_mfma_f32_16x16x32_bf16 v[160:163], v[164:167], a[204:207], v[160:163]
s_waitcnt lgkmcnt(4)
buffer_load_dwordx4 v221, s[8:11], s69 offen offset:0  lds
v_mfma_f32_16x16x32_bf16 v[100:103], v[172:175], a[224:227], v[100:103]
ds_read_b64_tr_b16 v[164:165], v218 offset:32768
v_mul_f32 v230, s74, v63
v_mfma_f32_16x16x32_bf16 v[100:103], v[176:179], a[240:243], v[100:103]
v_rcp_f32 v231, v231
v_mfma_f32_16x16x32_bf16 v[104:107], v[176:179], a[244:247], v[104:107]
ds_read_b64_tr_b16 v[166:167], v218 offset:33280
v_mul_f32 v61, v61, v231
v_mfma_f32_16x16x32_bf16 v[104:107], v[172:175], a[228:231], v[104:107]
v_exp_f32 v232, v232
v_mfma_f32_16x16x32_bf16 v[108:111], v[172:175], a[232:235], v[108:111]
ds_read_b64_tr_b16 v[168:169], v218 offset:36864
v_add_f32 v232, 1.0, v232
v_mfma_f32_16x16x32_bf16 v[108:111], v[176:179], a[248:251], v[108:111]
v_rcp_f32 v232, v232
v_mfma_f32_16x16x32_bf16 v[112:115], v[176:179], a[252:255], v[112:115]
ds_read_b64_tr_b16 v[170:171], v218 offset:37376
v_mul_f32 v62, v62, v232
v_mfma_f32_16x16x32_bf16 v[112:115], v[172:175], a[236:239], v[112:115]
s_waitcnt lgkmcnt(4)
buffer_load_dwordx4 v222, s[8:11], s69 offen offset:1024  lds
v_mfma_f32_16x16x32_bf16 v[116:119], v[180:183], a[224:227], v[116:119]
ds_read_b64_tr_b16 v[172:173], v219 offset:32768
v_mul_f32 v231, s74, v64
v_mfma_f32_16x16x32_bf16 v[116:119], v[184:187], a[240:243], v[116:119]
v_exp_f32 v230, v230
v_mfma_f32_16x16x32_bf16 v[120:123], v[184:187], a[244:247], v[120:123]
ds_read_b64_tr_b16 v[174:175], v219 offset:33280
v_add_f32 v230, 1.0, v230
v_mfma_f32_16x16x32_bf16 v[120:123], v[180:183], a[228:231], v[120:123]
v_rcp_f32 v230, v230
v_mfma_f32_16x16x32_bf16 v[124:127], v[180:183], a[232:235], v[124:127]
ds_read_b64_tr_b16 v[176:177], v219 offset:36864
v_mul_f32 v63, v63, v230
v_mfma_f32_16x16x32_bf16 v[124:127], v[184:187], a[248:251], v[124:127]
v_exp_f32 v231, v231
v_mfma_f32_16x16x32_bf16 v[128:131], v[184:187], a[252:255], v[128:131]
ds_read_b64_tr_b16 v[178:179], v219 offset:37376
v_add_f32 v231, 1.0, v231
v_mfma_f32_16x16x32_bf16 v[128:131], v[180:183], a[236:239], v[128:131]
s_waitcnt lgkmcnt(4)
v_rcp_f32 v231, v231
v_mfma_f32_16x16x32_bf16 v[132:135], v[164:167], a[224:227], v[132:135]
ds_read_b64_tr_b16 v[180:181], v216 offset:40960
v_mul_f32 v64, v64, v231
v_mfma_f32_16x16x32_bf16 v[132:135], v[168:171], a[240:243], v[132:135]
v_mul_f32 v232, s74, v65
v_mul_f32 v230, s74, v66
v_mfma_f32_16x16x32_bf16 v[136:139], v[168:171], a[244:247], v[136:139]
ds_read_b64_tr_b16 v[182:183], v216 offset:41472
v_mul_f32 v231, s74, v67
v_mfma_f32_16x16x32_bf16 v[136:139], v[164:167], a[228:231], v[136:139]
v_exp_f32 v232, v232
v_mfma_f32_16x16x32_bf16 v[140:143], v[164:167], a[232:235], v[140:143]
ds_read_b64_tr_b16 v[184:185], v216 offset:45056
v_add_f32 v232, 1.0, v232
v_mfma_f32_16x16x32_bf16 v[140:143], v[168:171], a[248:251], v[140:143]
v_rcp_f32 v232, v232
v_mfma_f32_16x16x32_bf16 v[144:147], v[168:171], a[252:255], v[144:147]
ds_read_b64_tr_b16 v[186:187], v216 offset:45568
v_mul_f32 v65, v65, v232
v_mfma_f32_16x16x32_bf16 v[144:147], v[164:167], a[236:239], v[144:147]
s_waitcnt lgkmcnt(4)
v_exp_f32 v230, v230
v_mfma_f32_16x16x32_bf16 v[148:151], v[172:175], a[224:227], v[148:151]
ds_read_b64_tr_b16 v[164:165], v217 offset:40960
v_add_u32 v216, 0xc000, v216
v_mfma_f32_16x16x32_bf16 v[148:151], v[176:179], a[240:243], v[148:151]
v_exp_f32 v231, v231
v_mfma_f32_16x16x32_bf16 v[152:155], v[176:179], a[244:247], v[152:155]
ds_read_b64_tr_b16 v[166:167], v217 offset:41472
v_add_f32 v230, 1.0, v230
v_mfma_f32_16x16x32_bf16 v[152:155], v[172:175], a[228:231], v[152:155]
v_rcp_f32 v230, v230
v_mfma_f32_16x16x32_bf16 v[156:159], v[172:175], a[232:235], v[156:159]
ds_read_b64_tr_b16 v[168:169], v217 offset:45056
v_mul_f32 v66, v66, v230
v_mfma_f32_16x16x32_bf16 v[156:159], v[176:179], a[248:251], v[156:159]
v_add_f32 v231, 1.0, v231
v_mov_b32 v227, -1
v_mfma_f32_16x16x32_bf16 v[160:163], v[176:179], a[252:255], v[160:163]
ds_read_b64_tr_b16 v[170:171], v217 offset:45568
v_mul_f32 v68, v68, v235
v_mfma_f32_16x16x32_bf16 v[160:163], v[172:175], a[236:239], v[160:163]
s_waitcnt lgkmcnt(4)
v_rcp_f32 v231, v231
v_mfma_f32_16x16x32_bf16 v[100:103], v[180:183], v[4:7], v[100:103]
ds_read_b64_tr_b16 v[172:173], v218 offset:40960
v_add_u32 v217, 0xc000, v217
v_mfma_f32_16x16x32_bf16 v[100:103], v[184:187], v[20:23], v[100:103]
v_mul_f32 v67, v67, v231
v_mul_f32 v233, s74, v69
v_mfma_f32_16x16x32_bf16 v[104:107], v[184:187], v[24:27], v[104:107]
ds_read_b64_tr_b16 v[174:175], v218 offset:41472
v_mul_f32 v234, s74, v70
v_mfma_f32_16x16x32_bf16 v[104:107], v[180:183], v[8:11], v[104:107]
v_exp_f32 v233, v233
v_mfma_f32_16x16x32_bf16 v[108:111], v[180:183], v[12:15], v[108:111]
ds_read_b64_tr_b16 v[176:177], v218 offset:45056
v_mul_f32 v36, v36, v100
v_mfma_f32_16x16x32_bf16 v[108:111], v[184:187], v[28:31], v[108:111]
v_exp_f32 v234, v234
v_mfma_f32_16x16x32_bf16 v[112:115], v[184:187], v[32:35], v[112:115]
ds_read_b64_tr_b16 v[178:179], v218 offset:45568
v_mul_f32 v37, v37, v101
v_mfma_f32_16x16x32_bf16 v[112:115], v[180:183], v[16:19], v[112:115]
s_waitcnt lgkmcnt(4)
v_mul_f32 v38, v38, v102
v_mul_f32 v39, v39, v103
v_mfma_f32_16x16x32_bf16 v[116:119], v[164:167], v[4:7], v[116:119]
ds_read_b64_tr_b16 v[180:181], v219 offset:40960
v_add_u32 v218, 0xc000, v218
v_mfma_f32_16x16x32_bf16 v[116:119], v[168:171], v[20:23], v[116:119]
ds_read_b64_tr_b16 v[182:183], v219 offset:41472
v_cvt_pk_bf16_f32 v100, v36, v37
v_mfma_f32_16x16x32_bf16 v[120:123], v[168:171], v[24:27], v[120:123]
ds_read_b64_tr_b16 v[184:185], v219 offset:45056
v_cvt_pk_bf16_f32 v101, v38, v39
v_mfma_f32_16x16x32_bf16 v[120:123], v[164:167], v[8:11], v[120:123]
ds_read_b64_tr_b16 v[186:187], v219 offset:45568
v_mul_f32 v40, v40, v104
v_mfma_f32_16x16x32_bf16 v[124:127], v[164:167], v[12:15], v[124:127]
v_mul_f32 v41, v41, v105
v_mul_f32 v42, v42, v106
v_mfma_f32_16x16x32_bf16 v[124:127], v[168:171], v[28:31], v[124:127]
v_mul_f32 v43, v43, v107
v_cvt_pk_bf16_f32 v104, v40, v41
v_mfma_f32_16x16x32_bf16 v[128:131], v[168:171], v[32:35], v[128:131]
v_cvt_pk_bf16_f32 v105, v42, v43
v_mul_f32 v44, v44, v108
v_mfma_f32_16x16x32_bf16 v[128:131], v[164:167], v[16:19], v[128:131]
s_waitcnt vmcnt(13) lgkmcnt(0)
s_barrier
v_mfma_f32_16x16x32_bf16 v[132:135], v[172:175], v[4:7], v[132:135]
s_bfe_u32 s69, s54, 0x40000
ds_read_b64_tr_b16 v[164:165], v216 offset:0
v_add_u32 v219, 0xc000, v219
v_mfma_f32_16x16x32_bf16 v[132:135], v[176:179], v[20:23], v[132:135]
s_mul_i32 s69, s69, 589824
v_mul_f32 v45, v45, v109
v_mul_f32 v46, v46, v110
v_mfma_f32_16x16x32_bf16 v[136:139], v[176:179], v[24:27], v[136:139]
s_add_u32 s69, s69, s63
ds_read_b64_tr_b16 v[166:167], v216 offset:512
v_mul_f32 v47, v47, v111
v_mfma_f32_16x16x32_bf16 v[136:139], v[172:175], v[8:11], v[136:139]
s_add_u32 m0, s71, 24576
v_cvt_pk_bf16_f32 v108, v44, v45
v_cvt_pk_bf16_f32 v109, v46, v47
v_mfma_f32_16x16x32_bf16 v[140:143], v[172:175], v[12:15], v[140:143]
ds_read_b64_tr_b16 v[168:169], v216 offset:4096
v_mul_f32 v48, v48, v112
v_mfma_f32_16x16x32_bf16 v[140:143], v[176:179], v[28:31], v[140:143]
buffer_load_dwordx4 v221, s[12:15], s69 offen offset:0  lds
v_mfma_f32_16x16x32_bf16 v[144:147], v[176:179], v[32:35], v[144:147]
ds_read_b64_tr_b16 v[170:171], v216 offset:4608
v_mul_f32 v49, v49, v113
v_mfma_f32_16x16x32_bf16 v[144:147], v[172:175], v[16:19], v[144:147]
v_mul_f32 v50, v50, v114
v_mul_f32 v51, v51, v115
v_mfma_f32_16x16x32_bf16 v[148:151], v[180:183], v[4:7], v[148:151]
ds_read_b64_tr_b16 v[172:173], v217 offset:0
v_cvt_pk_bf16_f32 v112, v48, v49
v_mfma_f32_16x16x32_bf16 v[148:151], v[184:187], v[20:23], v[148:151]
v_cvt_pk_bf16_f32 v113, v50, v51
v_mul_f32 v52, v52, v116
v_mfma_f32_16x16x32_bf16 v[152:155], v[184:187], v[24:27], v[152:155]
ds_read_b64_tr_b16 v[174:175], v217 offset:512
v_mul_f32 v53, v53, v117
v_mfma_f32_16x16x32_bf16 v[152:155], v[180:183], v[8:11], v[152:155]
v_mul_f32 v54, v54, v118
v_mul_f32 v55, v55, v119
v_mfma_f32_16x16x32_bf16 v[156:159], v[180:183], v[12:15], v[156:159]
ds_read_b64_tr_b16 v[176:177], v217 offset:4096
v_cvt_pk_bf16_f32 v102, v52, v53
v_mfma_f32_16x16x32_bf16 v[156:159], v[184:187], v[28:31], v[156:159]
v_cvt_pk_bf16_f32 v103, v54, v55
v_mul_f32 v56, v56, v120
v_mfma_f32_16x16x32_bf16 v[160:163], v[184:187], v[32:35], v[160:163]
ds_read_b64_tr_b16 v[178:179], v217 offset:4608
v_mul_f32 v57, v57, v121
v_mfma_f32_16x16x32_bf16 v[160:163], v[180:183], v[16:19], v[160:163]
s_waitcnt lgkmcnt(4)
buffer_load_dwordx4 v222, s[12:15], s69 offen offset:1024  lds
v_mfma_f32_16x16x32_bf16 v[36:39], v[164:167], a[0:3], 0
s_bfe_u32 s69, s54, 0x40004
ds_read_b64_tr_b16 v[180:181], v218 offset:0
v_mul_f32 v58, v58, v122
v_mfma_f32_16x16x32_bf16 v[36:39], v[168:171], a[16:19], v[36:39]
s_mul_i32 s69, s69, 589824
buffer_store_dwordx4 v[100:103], v228, s[20:23], s48 offen offset:0 sc1
v_mfma_f32_16x16x32_bf16 v[40:43], v[168:171], a[20:23], 0
s_add_u32 s69, s69, s63
ds_read_b64_tr_b16 v[182:183], v218 offset:512
v_mul_f32 v59, v59, v123
v_mfma_f32_16x16x32_bf16 v[40:43], v[164:167], a[4:7], v[40:43]
s_add_u32 m0, s71, 32768
v_cvt_pk_bf16_f32 v106, v56, v57
v_cvt_pk_bf16_f32 v107, v58, v59
v_mfma_f32_16x16x32_bf16 v[44:47], v[164:167], a[8:11], 0
ds_read_b64_tr_b16 v[184:185], v218 offset:4096
v_mul_f32 v60, v60, v124
v_mfma_f32_16x16x32_bf16 v[44:47], v[168:171], a[24:27], v[44:47]
buffer_store_dwordx4 v[104:107], v228, s[20:23], s49 offen offset:0 sc1
v_mfma_f32_16x16x32_bf16 v[48:51], v[168:171], a[28:31], 0
ds_read_b64_tr_b16 v[186:187], v218 offset:4608
v_mul_f32 v61, v61, v125
v_mfma_f32_16x16x32_bf16 v[48:51], v[164:167], a[12:15], v[48:51]
s_waitcnt lgkmcnt(4)
v_mul_f32 v62, v62, v126
v_mul_f32 v63, v63, v127
v_mfma_f32_16x16x32_bf16 v[52:55], v[172:175], a[0:3], 0
ds_read_b64_tr_b16 v[164:165], v219 offset:0
v_cvt_pk_bf16_f32 v110, v60, v61
v_mfma_f32_16x16x32_bf16 v[52:55], v[176:179], a[16:19], v[52:55]
v_cvt_pk_bf16_f32 v111, v62, v63
v_mul_f32 v64, v64, v128
v_mfma_f32_16x16x32_bf16 v[56:59], v[176:179], a[20:23], 0
ds_read_b64_tr_b16 v[166:167], v219 offset:512
v_mul_f32 v65, v65, v129
v_mfma_f32_16x16x32_bf16 v[56:59], v[172:175], a[4:7], v[56:59]
buffer_store_dwordx4 v[108:111], v228, s[20:23], s50 offen offset:0 sc1
v_mfma_f32_16x16x32_bf16 v[60:63], v[172:175], a[8:11], 0
ds_read_b64_tr_b16 v[168:169], v219 offset:4096
v_mul_f32 v66, v66, v130
v_mfma_f32_16x16x32_bf16 v[60:63], v[176:179], a[24:27], v[60:63]
buffer_load_dwordx4 v221, s[12:15], s69 offen offset:0  lds
v_cvt_pk_bf16_f32 v114, v64, v65
v_mul_f32 v67, v67, v131
v_cvt_pk_bf16_f32 v115, v66, v67
v_mfma_f32_16x16x32_bf16 v[64:67], v[176:179], a[28:31], 0
ds_read_b64_tr_b16 v[170:171], v219 offset:4608
v_add_f32 v233, 1.0, v233
v_mfma_f32_16x16x32_bf16 v[64:67], v[172:175], a[12:15], v[64:67]
s_waitcnt lgkmcnt(4)
buffer_store_dwordx4 v[112:115], v228, s[20:23], s51 offen offset:0 sc1
v_mfma_f32_16x16x32_bf16 v[116:119], v[180:183], a[0:3], 0
ds_read_b64_tr_b16 v[172:173], v216 offset:8192
v_add_f32 v234, 1.0, v234
v_mfma_f32_16x16x32_bf16 v[116:119], v[184:187], a[16:19], v[116:119]
v_rcp_f32 v233, v233
v_mfma_f32_16x16x32_bf16 v[120:123], v[184:187], a[20:23], 0
ds_read_b64_tr_b16 v[174:175], v216 offset:8704
v_mul_f32 v69, v69, v233
v_mfma_f32_16x16x32_bf16 v[120:123], v[180:183], a[4:7], v[120:123]
v_rcp_f32 v234, v234
v_mfma_f32_16x16x32_bf16 v[124:127], v[180:183], a[8:11], 0
ds_read_b64_tr_b16 v[176:177], v216 offset:12288
v_mul_f32 v70, v70, v234
v_mfma_f32_16x16x32_bf16 v[124:127], v[184:187], a[24:27], v[124:127]
v_mul_f32 v235, s74, v71
v_mul_f32 v233, s74, v72
v_mfma_f32_16x16x32_bf16 v[128:131], v[184:187], a[28:31], 0
ds_read_b64_tr_b16 v[178:179], v216 offset:12800
v_mul_f32 v234, s74, v73
v_mfma_f32_16x16x32_bf16 v[128:131], v[180:183], a[12:15], v[128:131]
s_waitcnt lgkmcnt(4)
v_exp_f32 v235, v235
v_mfma_f32_16x16x32_bf16 v[100:103], v[164:167], a[0:3], 0
ds_read_b64_tr_b16 v[180:181], v217 offset:8192
v_add_f32 v235, 1.0, v235
v_mfma_f32_16x16x32_bf16 v[100:103], v[168:171], a[16:19], v[100:103]
buffer_load_dword v212, v250, s[16:19], s56 offen offset:0
v_mfma_f32_16x16x32_bf16 v[104:107], v[168:171], a[20:23], 0
ds_read_b64_tr_b16 v[182:183], v217 offset:8704
v_mfma_f32_16x16x32_bf16 v[104:107], v[164:167], a[4:7], v[104:107]
buffer_load_dwordx4 v222, s[12:15], s69 offen offset:1024  lds
v_mfma_f32_16x16x32_bf16 v[108:111], v[164:167], a[8:11], 0
s_bfe_u32 s69, s54, 0x40008
ds_read_b64_tr_b16 v[184:185], v217 offset:12288
s_mul_i32 s69, s69, 589824
v_mfma_f32_16x16x32_bf16 v[108:111], v[168:171], a[24:27], v[108:111]
s_add_u32 s69, s69, s63
v_rcp_f32 v235, v235
v_mfma_f32_16x16x32_bf16 v[112:115], v[168:171], a[28:31], 0
s_add_u32 m0, s71, 40960
ds_read_b64_tr_b16 v[186:187], v217 offset:12800
v_mul_f32 v71, v71, v235
v_mfma_f32_16x16x32_bf16 v[112:115], v[164:167], a[12:15], v[112:115]
s_waitcnt lgkmcnt(4)
v_exp_f32 v233, v233
v_mfma_f32_16x16x32_bf16 v[36:39], v[172:175], a[32:35], v[36:39]
ds_read_b64_tr_b16 v[164:165], v218 offset:8192
v_add_f32 v233, 1.0, v233
v_mfma_f32_16x16x32_bf16 v[36:39], v[176:179], a[48:51], v[36:39]
v_rcp_f32 v233, v233
v_mfma_f32_16x16x32_bf16 v[40:43], v[176:179], a[52:55], v[40:43]
ds_read_b64_tr_b16 v[166:167], v218 offset:8704
v_mul_f32 v72, v72, v233
v_mfma_f32_16x16x32_bf16 v[40:43], v[172:175], a[36:39], v[40:43]
v_exp_f32 v234, v234
v_mfma_f32_16x16x32_bf16 v[44:47], v[172:175], a[40:43], v[44:47]
ds_read_b64_tr_b16 v[168:169], v218 offset:12288
v_add_f32 v234, 1.0, v234
v_mfma_f32_16x16x32_bf16 v[44:47], v[176:179], a[56:59], v[44:47]
v_rcp_f32 v234, v234
v_mfma_f32_16x16x32_bf16 v[48:51], v[176:179], a[60:63], v[48:51]
ds_read_b64_tr_b16 v[170:171], v218 offset:12800
v_mul_f32 v73, v73, v234
v_mfma_f32_16x16x32_bf16 v[48:51], v[172:175], a[44:47], v[48:51]
s_waitcnt lgkmcnt(4)
v_mul_f32 v235, s74, v74
v_mul_f32 v233, s74, v75
v_mfma_f32_16x16x32_bf16 v[52:55], v[180:183], a[32:35], v[52:55]
ds_read_b64_tr_b16 v[172:173], v219 offset:8192
v_mul_f32 v234, s74, v76
v_mfma_f32_16x16x32_bf16 v[52:55], v[184:187], a[48:51], v[52:55]
buffer_load_dwordx4 v221, s[12:15], s69 offen offset:0  lds
v_mfma_f32_16x16x32_bf16 v[56:59], v[184:187], a[52:55], v[56:59]
ds_read_b64_tr_b16 v[174:175], v219 offset:8704
v_mfma_f32_16x16x32_bf16 v[56:59], v[180:183], a[36:39], v[56:59]
v_exp_f32 v235, v235
v_mfma_f32_16x16x32_bf16 v[60:63], v[180:183], a[40:43], v[60:63]
ds_read_b64_tr_b16 v[176:177], v219 offset:12288
v_add_f32 v235, 1.0, v235
v_mfma_f32_16x16x32_bf16 v[60:63], v[184:187], a[56:59], v[60:63]
v_rcp_f32 v235, v235
v_mfma_f32_16x16x32_bf16 v[64:67], v[184:187], a[60:63], v[64:67]
ds_read_b64_tr_b16 v[178:179], v219 offset:12800
v_mul_f32 v74, v74, v235
v_mfma_f32_16x16x32_bf16 v[64:67], v[180:183], a[44:47], v[64:67]
s_waitcnt lgkmcnt(4)
v_exp_f32 v233, v233
v_mfma_f32_16x16x32_bf16 v[116:119], v[164:167], a[32:35], v[116:119]
ds_read_b64_tr_b16 v[180:181], v216 offset:16384
v_add_f32 v233, 1.0, v233
v_mfma_f32_16x16x32_bf16 v[116:119], v[168:171], a[48:51], v[116:119]
PAD_3:
s_cmp_lg_u32 s73, 0
s_cbranch_scc1 PAD_7
v_rcp_f32 v233, v233
v_mfma_f32_16x16x32_bf16 v[120:123], v[168:171], a[52:55], v[120:123]
ds_read_b64_tr_b16 v[182:183], v216 offset:16896
v_mul_f32 v75, v75, v233
v_mfma_f32_16x16x32_bf16 v[120:123], v[164:167], a[36:39], v[120:123]
v_exp_f32 v234, v234
v_mfma_f32_16x16x32_bf16 v[124:127], v[164:167], a[40:43], v[124:127]
ds_read_b64_tr_b16 v[184:185], v216 offset:20480
v_add_f32 v234, 1.0, v234
v_mfma_f32_16x16x32_bf16 v[124:127], v[168:171], a[56:59], v[124:127]
v_rcp_f32 v234, v234
v_mfma_f32_16x16x32_bf16 v[128:131], v[168:171], a[60:63], v[128:131]
ds_read_b64_tr_b16 v[186:187], v216 offset:20992
v_mul_f32 v76, v76, v234
v_mfma_f32_16x16x32_bf16 v[128:131], v[164:167], a[44:47], v[128:131]
s_waitcnt lgkmcnt(4)
buffer_load_dwordx4 v222, s[12:15], s69 offen offset:1024  lds
v_mfma_f32_16x16x32_bf16 v[100:103], v[172:175], a[32:35], v[100:103]
ds_read_b64_tr_b16 v[164:165], v217 offset:16384
v_mul_f32 v235, s74, v77
v_mfma_f32_16x16x32_bf16 v[100:103], v[176:179], a[48:51], v[100:103]
v_exp_f32 v235, v235
v_mfma_f32_16x16x32_bf16 v[104:107], v[176:179], a[52:55], v[104:107]
ds_read_b64_tr_b16 v[166:167], v217 offset:16896
v_add_f32 v235, 1.0, v235
v_mfma_f32_16x16x32_bf16 v[104:107], v[172:175], a[36:39], v[104:107]
v_rcp_f32 v235, v235
v_mfma_f32_16x16x32_bf16 v[108:111], v[172:175], a[40:43], v[108:111]
ds_read_b64_tr_b16 v[168:169], v217 offset:20480
v_mul_f32 v77, v77, v235
v_mfma_f32_16x16x32_bf16 v[108:111], v[176:179], a[56:59], v[108:111]
v_mul_f32 v233, s74, v78
v_mul_f32 v234, s74, v79
v_mfma_f32_16x16x32_bf16 v[112:115], v[176:179], a[60:63], v[112:115]
ds_read_b64_tr_b16 v[170:171], v217 offset:20992
v_mul_f32 v235, s74, v80
v_mfma_f32_16x16x32_bf16 v[112:115], v[172:175], a[44:47], v[112:115]
s_waitcnt lgkmcnt(4)
v_exp_f32 v233, v233
v_mfma_f32_16x16x32_bf16 v[36:39], v[180:183], a[64:67], v[36:39]
ds_read_b64_tr_b16 v[172:173], v218 offset:16384
v_add_f32 v233, 1.0, v233
v_mfma_f32_16x16x32_bf16 v[36:39], v[184:187], a[80:83], v[36:39]
buffer_load_dword v212, v250, s[16:19], s56 offen offset:1792
v_mfma_f32_16x16x32_bf16 v[40:43], v[184:187], a[84:87], v[40:43]
ds_read_b64_tr_b16 v[174:175], v218 offset:16896
v_mfma_f32_16x16x32_bf16 v[40:43], v[180:183], a[68:71], v[40:43]
v_rcp_f32 v233, v233
v_mfma_f32_16x16x32_bf16 v[44:47], v[180:183], a[72:75], v[44:47]
ds_read_b64_tr_b16 v[176:177], v218 offset:20480
v_mul_f32 v78, v78, v233
v_mfma_f32_16x16x32_bf16 v[44:47], v[184:187], a[88:91], v[44:47]
v_exp_f32 v234, v234
v_mfma_f32_16x16x32_bf16 v[48:51], v[184:187], a[92:95], v[48:51]
ds_read_b64_tr_b16 v[178:179], v218 offset:20992
v_add_f32 v234, 1.0, v234
v_mfma_f32_16x16x32_bf16 v[48:51], v[180:183], a[76:79], v[48:51]
s_waitcnt lgkmcnt(4)
v_rcp_f32 v234, v234
v_mfma_f32_16x16x32_bf16 v[52:55], v[164:167], a[64:67], v[52:55]
ds_read_b64_tr_b16 v[180:181], v219 offset:16384
v_mul_f32 v79, v79, v234
v_mfma_f32_16x16x32_bf16 v[52:55], v[168:171], a[80:83], v[52:55]
ds_read_b64_tr_b16 v[182:183], v219 offset:16896
v_mul_f32 v233, s74, v81
v_mfma_f32_16x16x32_bf16 v[56:59], v[168:171], a[84:87], v[56:59]
ds_read_b64_tr_b16 v[184:185], v219 offset:20480
v_mul_f32 v234, s74, v82
v_mfma_f32_16x16x32_bf16 v[56:59], v[164:167], a[68:71], v[56:59]
ds_read_b64_tr_b16 v[186:187], v219 offset:20992
v_mfma_f32_16x16x32_bf16 v[60:63], v[164:167], a[72:75], v[60:63]
v_exp_f32 v235, v235
v_mfma_f32_16x16x32_bf16 v[60:63], v[168:171], a[88:91], v[60:63]
v_exp_f32 v233, v233
v_mfma_f32_16x16x32_bf16 v[64:67], v[168:171], a[92:95], v[64:67]
v_exp_f32 v234, v234
v_mfma_f32_16x16x32_bf16 v[64:67], v[164:167], a[76:79], v[64:67]
s_waitcnt vmcnt(19) lgkmcnt(0)
s_barrier
v_mfma_f32_16x16x32_bf16 v[116:119], v[172:175], a[64:67], v[116:119]
s_bfe_u32 s69, s54, 0x4000c
ds_read_b64_tr_b16 v[164:165], v216 offset:24576
v_add_f32 v235, 1.0, v235
v_mfma_f32_16x16x32_bf16 v[116:119], v[176:179], a[80:83], v[116:119]
s_mul_i32 s69, s69, 589824
v_rcp_f32 v235, v235
v_mfma_f32_16x16x32_bf16 v[120:123], v[176:179], a[84:87], v[120:123]
s_add_u32 s69, s69, s63
ds_read_b64_tr_b16 v[166:167], v216 offset:25088
v_mul_f32 v80, v80, v235
v_mfma_f32_16x16x32_bf16 v[120:123], v[172:175], a[68:71], v[120:123]
s_add_u32 m0, s71, 49152
v_add_f32 v233, 1.0, v233
v_add_f32 v234, 1.0, v234
v_mfma_f32_16x16x32_bf16 v[124:127], v[172:175], a[72:75], v[124:127]
ds_read_b64_tr_b16 v[168:169], v216 offset:28672
v_mul_f32 v235, s74, v83
v_mfma_f32_16x16x32_bf16 v[124:127], v[176:179], a[88:91], v[124:127]
buffer_load_dwordx4 v221, s[12:15], s69 offen offset:0  lds
v_mfma_f32_16x16x32_bf16 v[128:131], v[176:179], a[92:95], v[128:131]
ds_read_b64_tr_b16 v[170:171], v216 offset:29184
v_mfma_f32_16x16x32_bf16 v[128:131], v[172:175], a[76:79], v[128:131]
v_rcp_f32 v233, v233
v_mfma_f32_16x16x32_bf16 v[100:103], v[180:183], a[64:67], v[100:103]
ds_read_b64_tr_b16 v[172:173], v217 offset:24576
v_mul_f32 v81, v81, v233
v_mfma_f32_16x16x32_bf16 v[100:103], v[184:187], a[80:83], v[100:103]
v_rcp_f32 v234, v234
v_mfma_f32_16x16x32_bf16 v[104:107], v[184:187], a[84:87], v[104:107]
ds_read_b64_tr_b16 v[174:175], v217 offset:25088
v_mul_f32 v82, v82, v234
v_mfma_f32_16x16x32_bf16 v[104:107], v[180:183], a[68:71], v[104:107]
v_exp_f32 v235, v235
v_mfma_f32_16x16x32_bf16 v[108:111], v[180:183], a[72:75], v[108:111]
ds_read_b64_tr_b16 v[176:177], v217 offset:28672
v_add_f32 v235, 1.0, v235
v_mfma_f32_16x16x32_bf16 v[108:111], v[184:187], a[88:91], v[108:111]
v_rcp_f32 v235, v235
v_mfma_f32_16x16x32_bf16 v[112:115], v[184:187], a[92:95], v[112:115]
ds_read_b64_tr_b16 v[178:179], v217 offset:29184
v_mul_f32 v83, v83, v235
v_mfma_f32_16x16x32_bf16 v[112:115], v[180:183], a[76:79], v[112:115]
s_waitcnt lgkmcnt(4)
buffer_load_dwordx4 v222, s[12:15], s69 offen offset:1024  lds
v_mfma_f32_16x16x32_bf16 v[36:39], v[164:167], a[96:99], v[36:39]
s_bfe_u32 s69, s54, 0x40010
ds_read_b64_tr_b16 v[180:181], v218 offset:24576
v_mul_f32 v233, s74, v84
v_mfma_f32_16x16x32_bf16 v[36:39], v[168:171], a[112:115], v[36:39]
s_mul_i32 s69, s69, 589824
v_exp_f32 v233, v233
v_mfma_f32_16x16x32_bf16 v[40:43], v[168:171], a[116:119], v[40:43]
s_add_u32 s69, s69, s63
ds_read_b64_tr_b16 v[182:183], v218 offset:25088
v_add_f32 v233, 1.0, v233
v_mfma_f32_16x16x32_bf16 v[40:43], v[164:167], a[100:103], v[40:43]
s_add_u32 m0, s71, 57344
v_rcp_f32 v233, v233
v_mfma_f32_16x16x32_bf16 v[44:47], v[164:167], a[104:107], v[44:47]
ds_read_b64_tr_b16 v[184:185], v218 offset:28672
v_mul_f32 v84, v84, v233
v_mfma_f32_16x16x32_bf16 v[44:47], v[168:171], a[120:123], v[44:47]
v_mul_f32 v234, s74, v85
v_mul_f32 v235, s74, v86
v_mfma_f32_16x16x32_bf16 v[48:51], v[168:171], a[124:127], v[48:51]
ds_read_b64_tr_b16 v[186:187], v218 offset:29184
v_mul_f32 v233, s74, v87
v_mfma_f32_16x16x32_bf16 v[48:51], v[164:167], a[108:111], v[48:51]
s_waitcnt lgkmcnt(4)
v_exp_f32 v234, v234
v_mfma_f32_16x16x32_bf16 v[52:55], v[172:175], a[96:99], v[52:55]
ds_read_b64_tr_b16 v[164:165], v219 offset:24576
v_add_f32 v234, 1.0, v234
v_mfma_f32_16x16x32_bf16 v[52:55], v[176:179], a[112:115], v[52:55]
buffer_load_dword v212, v250, s[16:19], s56 offen offset:3584
v_mfma_f32_16x16x32_bf16 v[56:59], v[176:179], a[116:119], v[56:59]
ds_read_b64_tr_b16 v[166:167], v219 offset:25088
v_mfma_f32_16x16x32_bf16 v[56:59], v[172:175], a[100:103], v[56:59]
v_rcp_f32 v234, v234
v_mfma_f32_16x16x32_bf16 v[60:63], v[172:175], a[104:107], v[60:63]
ds_read_b64_tr_b16 v[168:169], v219 offset:28672
v_mul_f32 v85, v85, v234
v_mfma_f32_16x16x32_bf16 v[60:63], v[176:179], a[120:123], v[60:63]
buffer_load_dwordx4 v221, s[12:15], s69 offen offset:0  lds
v_mfma_f32_16x16x32_bf16 v[64:67], v[176:179], a[124:127], v[64:67]
ds_read_b64_tr_b16 v[170:171], v219 offset:29184
v_mul_f32 v234, s74, v88
v_mfma_f32_16x16x32_bf16 v[64:67], v[172:175], a[108:111], v[64:67]
s_waitcnt lgkmcnt(4)
v_exp_f32 v235, v235
v_mfma_f32_16x16x32_bf16 v[116:119], v[180:183], a[96:99], v[116:119]
ds_read_b64_tr_b16 v[172:173], v216 offset:32768
v_add_f32 v235, 1.0, v235
v_mfma_f32_16x16x32_bf16 v[116:119], v[184:187], a[112:115], v[116:119]
v_rcp_f32 v235, v235
v_mfma_f32_16x16x32_bf16 v[120:123], v[184:187], a[116:119], v[120:123]
ds_read_b64_tr_b16 v[174:175], v216 offset:33280
v_mul_f32 v86, v86, v235
v_mfma_f32_16x16x32_bf16 v[120:123], v[180:183], a[100:103], v[120:123]
v_exp_f32 v233, v233
v_mfma_f32_16x16x32_bf16 v[124:127], v[180:183], a[104:107], v[124:127]
ds_read_b64_tr_b16 v[176:177], v216 offset:36864
v_add_f32 v233, 1.0, v233
v_mfma_f32_16x16x32_bf16 v[124:127], v[184:187], a[120:123], v[124:127]
v_rcp_f32 v233, v233
v_mfma_f32_16x16x32_bf16 v[128:131], v[184:187], a[124:127], v[128:131]
ds_read_b64_tr_b16 v[178:179], v216 offset:37376
v_mul_f32 v87, v87, v233
v_mfma_f32_16x16x32_bf16 v[128:131], v[180:183], a[108:111], v[128:131]
s_waitcnt lgkmcnt(4)
v_exp_f32 v234, v234
v_mfma_f32_16x16x32_bf16 v[100:103], v[164:167], a[96:99], v[100:103]
ds_read_b64_tr_b16 v[180:181], v217 offset:32768
v_add_f32 v234, 1.0, v234
v_mfma_f32_16x16x32_bf16 v[100:103], v[168:171], a[112:115], v[100:103]
v_rcp_f32 v234, v234
v_mfma_f32_16x16x32_bf16 v[104:107], v[168:171], a[116:119], v[104:107]
ds_read_b64_tr_b16 v[182:183], v217 offset:33280
v_mul_f32 v88, v88, v234
v_mfma_f32_16x16x32_bf16 v[104:107], v[164:167], a[100:103], v[104:107]
buffer_load_dwordx4 v222, s[12:15], s69 offen offset:1024  lds
v_mfma_f32_16x16x32_bf16 v[108:111], v[164:167], a[104:107], v[108:111]
s_bfe_u32 s69, s54, 0x40014
ds_read_b64_tr_b16 v[184:185], v217 offset:36864
v_mul_f32 v235, s74, v89
v_mfma_f32_16x16x32_bf16 v[108:111], v[168:171], a[120:123], v[108:111]
s_mul_i32 s69, s69, 589824
v_exp_f32 v235, v235
v_mfma_f32_16x16x32_bf16 v[112:115], v[168:171], a[124:127], v[112:115]
s_add_u32 s69, s69, s63
ds_read_b64_tr_b16 v[186:187], v217 offset:37376
v_add_f32 v235, 1.0, v235
v_mfma_f32_16x16x32_bf16 v[112:115], v[164:167], a[108:111], v[112:115]
s_waitcnt lgkmcnt(4)
v_rcp_f32 v235, v235
v_mfma_f32_16x16x32_bf16 v[36:39], v[172:175], a[128:131], v[36:39]
s_add_u32 m0, s71, 65536
ds_read_b64_tr_b16 v[164:165], v218 offset:32768
v_mul_f32 v89, v89, v235
v_mfma_f32_16x16x32_bf16 v[36:39], v[176:179], a[144:147], v[36:39]
v_mul_f32 v233, s74, v90
v_mul_f32 v234, s74, v91
v_mfma_f32_16x16x32_bf16 v[40:43], v[176:179], a[148:151], v[40:43]
ds_read_b64_tr_b16 v[166:167], v218 offset:33280
v_mul_f32 v235, s74, v92
v_mfma_f32_16x16x32_bf16 v[40:43], v[172:175], a[132:135], v[40:43]
v_exp_f32 v233, v233
v_mfma_f32_16x16x32_bf16 v[44:47], v[172:175], a[136:139], v[44:47]
ds_read_b64_tr_b16 v[168:169], v218 offset:36864
v_add_f32 v233, 1.0, v233
v_mfma_f32_16x16x32_bf16 v[44:47], v[176:179], a[152:155], v[44:47]
v_rcp_f32 v233, v233
v_mfma_f32_16x16x32_bf16 v[48:51], v[176:179], a[156:159], v[48:51]
ds_read_b64_tr_b16 v[170:171], v218 offset:37376
v_mul_f32 v90, v90, v233
v_mfma_f32_16x16x32_bf16 v[48:51], v[172:175], a[140:143], v[48:51]
s_waitcnt lgkmcnt(4)
v_exp_f32 v234, v234
v_mfma_f32_16x16x32_bf16 v[52:55], v[180:183], a[128:131], v[52:55]
ds_read_b64_tr_b16 v[172:173], v219 offset:32768
v_add_f32 v234, 1.0, v234
v_mfma_f32_16x16x32_bf16 v[52:55], v[184:187], a[144:147], v[52:55]
buffer_load_dwordx4 v221, s[12:15], s69 offen offset:0  lds
v_mfma_f32_16x16x32_bf16 v[56:59], v[184:187], a[148:151], v[56:59]
ds_read_b64_tr_b16 v[174:175], v219 offset:33280
v_mul_f32 v233, s74, v93
v_mfma_f32_16x16x32_bf16 v[56:59], v[180:183], a[132:135], v[56:59]
v_rcp_f32 v234, v234
v_mfma_f32_16x16x32_bf16 v[60:63], v[180:183], a[136:139], v[60:63]
ds_read_b64_tr_b16 v[176:177], v219 offset:36864
v_mul_f32 v91, v91, v234
v_mfma_f32_16x16x32_bf16 v[60:63], v[184:187], a[152:155], v[60:63]
v_exp_f32 v235, v235
v_mfma_f32_16x16x32_bf16 v[64:67], v[184:187], a[156:159], v[64:67]
ds_read_b64_tr_b16 v[178:179], v219 offset:37376
v_add_f32 v235, 1.0, v235
v_mfma_f32_16x16x32_bf16 v[64:67], v[180:183], a[140:143], v[64:67]
s_waitcnt lgkmcnt(4)
v_rcp_f32 v235, v235
v_mfma_f32_16x16x32_bf16 v[116:119], v[164:167], a[128:131], v[116:119]
ds_read_b64_tr_b16 v[180:181], v216 offset:40960
v_mul_f32 v92, v92, v235
v_mfma_f32_16x16x32_bf16 v[116:119], v[168:171], a[144:147], v[116:119]
v_exp_f32 v233, v233
v_mfma_f32_16x16x32_bf16 v[120:123], v[168:171], a[148:151], v[120:123]
ds_read_b64_tr_b16 v[182:183], v216 offset:41472
v_add_f32 v233, 1.0, v233
v_mfma_f32_16x16x32_bf16 v[120:123], v[164:167], a[132:135], v[120:123]
v_rcp_f32 v233, v233
v_mfma_f32_16x16x32_bf16 v[124:127], v[164:167], a[136:139], v[124:127]
ds_read_b64_tr_b16 v[184:185], v216 offset:45056
v_mul_f32 v93, v93, v233
v_mfma_f32_16x16x32_bf16 v[124:127], v[168:171], a[152:155], v[124:127]
v_mul_f32 v234, s74, v94
v_mul_f32 v235, s74, v95
v_mfma_f32_16x16x32_bf16 v[128:131], v[168:171], a[156:159], v[128:131]
ds_read_b64_tr_b16 v[186:187], v216 offset:45568
v_mul_f32 v233, s74, v96
v_mfma_f32_16x16x32_bf16 v[128:131], v[164:167], a[140:143], v[128:131]
s_waitcnt lgkmcnt(4)
buffer_load_dwordx4 v222, s[12:15], s69 offen offset:1024  lds
v_mfma_f32_16x16x32_bf16 v[100:103], v[172:175], a[128:131], v[100:103]
ds_read_b64_tr_b16 v[164:165], v217 offset:40960
v_add_u32 v216, 0xffff4000, v216
v_mfma_f32_16x16x32_bf16 v[100:103], v[176:179], a[144:147], v[100:103]
v_exp_f32 v234, v234
v_mfma_f32_16x16x32_bf16 v[104:107], v[176:179], a[148:151], v[104:107]
ds_read_b64_tr_b16 v[166:167], v217 offset:41472
v_add_f32 v234, 1.0, v234
v_mfma_f32_16x16x32_bf16 v[104:107], v[172:175], a[132:135], v[104:107]
v_rcp_f32 v234, v234
v_mfma_f32_16x16x32_bf16 v[108:111], v[172:175], a[136:139], v[108:111]
ds_read_b64_tr_b16 v[168:169], v217 offset:45056
v_mul_f32 v94, v94, v234
v_mfma_f32_16x16x32_bf16 v[108:111], v[176:179], a[152:155], v[108:111]
v_exp_f32 v235, v235
v_mfma_f32_16x16x32_bf16 v[112:115], v[176:179], a[156:159], v[112:115]
ds_read_b64_tr_b16 v[170:171], v217 offset:45568
v_add_f32 v235, 1.0, v235
v_mfma_f32_16x16x32_bf16 v[112:115], v[172:175], a[140:143], v[112:115]
s_waitcnt lgkmcnt(4)
v_rcp_f32 v235, v235
v_mfma_f32_16x16x32_bf16 v[36:39], v[180:183], a[160:163], v[36:39]
ds_read_b64_tr_b16 v[172:173], v218 offset:40960
v_add_u32 v217, 0xffff4000, v217
v_mfma_f32_16x16x32_bf16 v[36:39], v[184:187], a[176:179], v[36:39]
v_exp_f32 v233, v233
v_mfma_f32_16x16x32_bf16 v[40:43], v[184:187], a[180:183], v[40:43]
ds_read_b64_tr_b16 v[174:175], v218 offset:41472
v_mul_f32 v95, v95, v235
v_mfma_f32_16x16x32_bf16 v[40:43], v[180:183], a[164:167], v[40:43]
v_add_f32 v233, 1.0, v233
v_mul_f32 v234, s74, v97
v_mfma_f32_16x16x32_bf16 v[44:47], v[180:183], a[168:171], v[44:47]
ds_read_b64_tr_b16 v[176:177], v218 offset:45056
v_mul_f32 v235, s74, v98
v_mfma_f32_16x16x32_bf16 v[44:47], v[184:187], a[184:187], v[44:47]
v_rcp_f32 v233, v233
v_mfma_f32_16x16x32_bf16 v[48:51], v[184:187], a[188:191], v[48:51]
ds_read_b64_tr_b16 v[178:179], v218 offset:45568
v_mul_f32 v96, v96, v233
v_mfma_f32_16x16x32_bf16 v[48:51], v[180:183], a[172:175], v[48:51]
s_waitcnt lgkmcnt(4)
v_exp_f32 v234, v234
v_mfma_f32_16x16x32_bf16 v[52:55], v[164:167], a[160:163], v[52:55]
ds_read_b64_tr_b16 v[180:181], v219 offset:40960
v_add_u32 v218, 0xffff4000, v218
v_mfma_f32_16x16x32_bf16 v[52:55], v[168:171], a[176:179], v[52:55]
ds_read_b64_tr_b16 v[182:183], v219 offset:41472
v_add_f32 v234, 1.0, v234
v_mfma_f32_16x16x32_bf16 v[56:59], v[168:171], a[180:183], v[56:59]
ds_read_b64_tr_b16 v[184:185], v219 offset:45056
v_mul_f32 v233, s74, v99
v_mfma_f32_16x16x32_bf16 v[56:59], v[164:167], a[164:167], v[56:59]
ds_read_b64_tr_b16 v[186:187], v219 offset:45568
v_mul_f32 v68, v68, v132
v_mfma_f32_16x16x32_bf16 v[60:63], v[164:167], a[168:171], v[60:63]
v_rcp_f32 v234, v234
v_mfma_f32_16x16x32_bf16 v[60:63], v[168:171], a[184:187], v[60:63]
v_exp_f32 v235, v235
v_mfma_f32_16x16x32_bf16 v[64:67], v[168:171], a[188:191], v[64:67]
v_exp_f32 v233, v233
v_mfma_f32_16x16x32_bf16 v[64:67], v[164:167], a[172:175], v[64:67]
s_waitcnt vmcnt(19) lgkmcnt(0)
s_barrier
v_mfma_f32_16x16x32_bf16 v[116:119], v[172:175], a[160:163], v[116:119]
s_bfe_u32 s69, s54, 0x40018
ds_read_b64_tr_b16 v[164:165], v216 offset:0
v_add_u32 v219, 0xffff4000, v219
v_mfma_f32_16x16x32_bf16 v[116:119], v[176:179], a[176:179], v[116:119]
s_mul_i32 s69, s69, 589824
v_mul_f32 v97, v97, v234
v_add_f32 v235, 1.0, v235
v_mfma_f32_16x16x32_bf16 v[120:123], v[176:179], a[180:183], v[120:123]
s_add_u32 s69, s69, s63
ds_read_b64_tr_b16 v[166:167], v216 offset:512
v_add_f32 v233, 1.0, v233
v_mfma_f32_16x16x32_bf16 v[120:123], v[172:175], a[164:167], v[120:123]
s_add_u32 m0, s71, 73728
v_rcp_f32 v235, v235
v_mfma_f32_16x16x32_bf16 v[124:127], v[172:175], a[168:171], v[124:127]
ds_read_b64_tr_b16 v[168:169], v216 offset:4096
v_mul_f32 v98, v98, v235
v_mfma_f32_16x16x32_bf16 v[124:127], v[176:179], a[184:187], v[124:127]
buffer_load_dwordx4 v221, s[12:15], s69 offen offset:0  lds
v_mfma_f32_16x16x32_bf16 v[128:131], v[176:179], a[188:191], v[128:131]
ds_read_b64_tr_b16 v[170:171], v216 offset:4608
v_mul_f32 v69, v69, v133
v_mfma_f32_16x16x32_bf16 v[128:131], v[172:175], a[172:175], v[128:131]
v_rcp_f32 v233, v233
v_mfma_f32_16x16x32_bf16 v[100:103], v[180:183], a[160:163], v[100:103]
ds_read_b64_tr_b16 v[172:173], v217 offset:0
v_mul_f32 v99, v99, v233
v_mfma_f32_16x16x32_bf16 v[100:103], v[184:187], a[176:179], v[100:103]
v_mul_f32 v70, v70, v134
v_mul_f32 v71, v71, v135
v_mfma_f32_16x16x32_bf16 v[104:107], v[184:187], a[180:183], v[104:107]
ds_read_b64_tr_b16 v[174:175], v217 offset:512
v_cvt_pk_bf16_f32 v132, v68, v69
v_mfma_f32_16x16x32_bf16 v[104:107], v[180:183], a[164:167], v[104:107]
v_cvt_pk_bf16_f32 v133, v70, v71
v_mul_f32 v72, v72, v136
v_mfma_f32_16x16x32_bf16 v[108:111], v[180:183], a[168:171], v[108:111]
ds_read_b64_tr_b16 v[176:177], v217 offset:4096
v_mul_f32 v73, v73, v137
v_mfma_f32_16x16x32_bf16 v[108:111], v[184:187], a[184:187], v[108:111]
v_mul_f32 v74, v74, v138
v_mul_f32 v75, v75, v139
v_mfma_f32_16x16x32_bf16 v[112:115], v[184:187], a[188:191], v[112:115]
ds_read_b64_tr_b16 v[178:179], v217 offset:4608
v_cvt_pk_bf16_f32 v136, v72, v73
v_mfma_f32_16x16x32_bf16 v[112:115], v[180:183], a[172:175], v[112:115]
s_waitcnt lgkmcnt(4)
buffer_load_dwordx4 v222, s[12:15], s69 offen offset:1024  lds
v_mfma_f32_16x16x32_bf16 v[36:39], v[164:167], a[192:195], v[36:39]
s_bfe_u32 s69, s54, 0x4001c
ds_read_b64_tr_b16 v[180:181], v218 offset:0
v_cvt_pk_bf16_f32 v137, v74, v75
v_mfma_f32_16x16x32_bf16 v[36:39], v[168:171], a[208:211], v[36:39]
s_mul_i32 s69, s69, 589824
v_mul_f32 v76, v76, v140
v_mul_f32 v77, v77, v141
v_mfma_f32_16x16x32_bf16 v[40:43], v[168:171], a[212:215], v[40:43]
s_add_u32 s69, s69, s63
ds_read_b64_tr_b16 v[182:183], v218 offset:512
v_mul_f32 v78, v78, v142
v_mfma_f32_16x16x32_bf16 v[40:43], v[164:167], a[196:199], v[40:43]
s_add_u32 m0, s71, 81920
v_mul_f32 v79, v79, v143
v_cvt_pk_bf16_f32 v140, v76, v77
v_mfma_f32_16x16x32_bf16 v[44:47], v[164:167], a[200:203], v[44:47]
ds_read_b64_tr_b16 v[184:185], v218 offset:4096
v_cvt_pk_bf16_f32 v141, v78, v79
v_mfma_f32_16x16x32_bf16 v[44:47], v[168:171], a[216:219], v[44:47]
v_mul_f32 v80, v80, v144
v_mul_f32 v81, v81, v145
v_mfma_f32_16x16x32_bf16 v[48:51], v[168:171], a[220:223], v[48:51]
ds_read_b64_tr_b16 v[186:187], v218 offset:4608
v_mul_f32 v82, v82, v146
v_mfma_f32_16x16x32_bf16 v[48:51], v[164:167], a[204:207], v[48:51]
s_waitcnt lgkmcnt(4)
v_mul_f32 v83, v83, v147
v_cvt_pk_bf16_f32 v144, v80, v81
v_mfma_f32_16x16x32_bf16 v[52:55], v[172:175], a[192:195], v[52:55]
ds_read_b64_tr_b16 v[164:165], v219 offset:0
v_cvt_pk_bf16_f32 v145, v82, v83
v_mfma_f32_16x16x32_bf16 v[52:55], v[176:179], a[208:211], v[52:55]
v_mul_f32 v84, v84, v148
v_mul_f32 v85, v85, v149
v_mfma_f32_16x16x32_bf16 v[56:59], v[176:179], a[212:215], v[56:59]
ds_read_b64_tr_b16 v[166:167], v219 offset:512
v_mul_f32 v86, v86, v150
v_mfma_f32_16x16x32_bf16 v[56:59], v[172:175], a[196:199], v[56:59]
v_mul_f32 v87, v87, v151
v_cvt_pk_bf16_f32 v134, v84, v85
v_mfma_f32_16x16x32_bf16 v[60:63], v[172:175], a[200:203], v[60:63]
ds_read_b64_tr_b16 v[168:169], v219 offset:4096
v_cvt_pk_bf16_f32 v135, v86, v87
v_mfma_f32_16x16x32_bf16 v[60:63], v[176:179], a[216:219], v[60:63]
buffer_load_dwordx4 v221, s[12:15], s69 offen offset:0  lds
v_mfma_f32_16x16x32_bf16 v[64:67], v[176:179], a[220:223], v[64:67]
ds_read_b64_tr_b16 v[170:171], v219 offset:4608
v_mul_f32 v88, v88, v152
v_mfma_f32_16x16x32_bf16 v[64:67], v[172:175], a[204:207], v[64:67]
s_waitcnt lgkmcnt(4)
buffer_store_dwordx4 v[132:135], v228, s[20:23], s48 offen offset:1024 sc1
v_mfma_f32_16x16x32_bf16 v[116:119], v[180:183], a[192:195], v[116:119]
ds_read_b64_tr_b16 v[172:173], v216 offset:8192
v_mul_f32 v89, v89, v153
v_mfma_f32_16x16x32_bf16 v[116:119], v[184:187], a[208:211], v[116:119]
v_mul_f32 v90, v90, v154
v_mul_f32 v91, v91, v155
v_mfma_f32_16x16x32_bf16 v[120:123], v[184:187], a[212:215], v[120:123]
ds_read_b64_tr_b16 v[174:175], v216 offset:8704
v_cvt_pk_bf16_f32 v138, v88, v89
v_mfma_f32_16x16x32_bf16 v[120:123], v[180:183], a[196:199], v[120:123]
v_cvt_pk_bf16_f32 v139, v90, v91
v_mul_f32 v92, v92, v156
v_mfma_f32_16x16x32_bf16 v[124:127], v[180:183], a[200:203], v[124:127]
ds_read_b64_tr_b16 v[176:177], v216 offset:12288
v_mul_f32 v93, v93, v157
v_mfma_f32_16x16x32_bf16 v[124:127], v[184:187], a[216:219], v[124:127]
buffer_store_dwordx4 v[136:139], v228, s[20:23], s49 offen offset:1024 sc1
v_mfma_f32_16x16x32_bf16 v[128:131], v[184:187], a[220:223], v[128:131]
ds_read_b64_tr_b16 v[178:179], v216 offset:12800
v_mul_f32 v94, v94, v158
v_mfma_f32_16x16x32_bf16 v[128:131], v[180:183], a[204:207], v[128:131]
s_waitcnt lgkmcnt(4)
v_mul_f32 v95, v95, v159
v_cvt_pk_bf16_f32 v142, v92, v93
v_mfma_f32_16x16x32_bf16 v[100:103], v[164:167], a[192:195], v[100:103]
ds_read_b64_tr_b16 v[180:181], v217 offset:8192
v_cvt_pk_bf16_f32 v143, v94, v95
v_mfma_f32_16x16x32_bf16 v[100:103], v[168:171], a[208:211], v[100:103]
buffer_store_dwordx4 v[140:143], v228, s[20:23], s50 offen offset:1024 sc1
v_mfma_f32_16x16x32_bf16 v[104:107], v[168:171], a[212:215], v[104:107]
ds_read_b64_tr_b16 v[182:183], v217 offset:8704
v_mul_f32 v96, v96, v160
v_mfma_f32_16x16x32_bf16 v[104:107], v[164:167], a[196:199], v[104:107]
buffer_load_dwordx4 v222, s[12:15], s69 offen offset:1024  lds
v_mfma_f32_16x16x32_bf16 v[108:111], v[164:167], a[200:203], v[108:111]
s_bfe_u32 s69, s55, 0x40000
ds_read_b64_tr_b16 v[184:185], v217 offset:12288
v_mul_f32 v97, v97, v161
v_mfma_f32_16x16x32_bf16 v[108:111], v[168:171], a[216:219], v[108:111]
s_mul_i32 s69, s69, 589824
v_mul_f32 v98, v98, v162
v_mul_f32 v99, v99, v163
v_mfma_f32_16x16x32_bf16 v[112:115], v[168:171], a[220:223], v[112:115]
s_add_u32 s69, s69, s63
ds_read_b64_tr_b16 v[186:187], v217 offset:12800
v_cvt_pk_bf16_f32 v146, v96, v97
v_mfma_f32_16x16x32_bf16 v[112:115], v[164:167], a[204:207], v[112:115]
s_waitcnt lgkmcnt(4)
v_cvt_pk_bf16_f32 v147, v98, v99
s_add_u32 m0, s71, 90112
v_mfma_f32_16x16x32_bf16 v[36:39], v[172:175], a[224:227], v[36:39]
ds_read_b64_tr_b16 v[164:165], v218 offset:8192
v_mfma_f32_16x16x32_bf16 v[36:39], v[176:179], a[240:243], v[36:39]
buffer_store_dwordx4 v[144:147], v228, s[20:23], s51 offen offset:1024 sc1
v_mfma_f32_16x16x32_bf16 v[40:43], v[176:179], a[244:247], v[40:43]
ds_read_b64_tr_b16 v[166:167], v218 offset:8704
v_mfma_f32_16x16x32_bf16 v[40:43], v[172:175], a[228:231], v[40:43]
v_mfma_f32_16x16x32_bf16 v[44:47], v[172:175], a[232:235], v[44:47]
ds_read_b64_tr_b16 v[168:169], v218 offset:12288
v_mfma_f32_16x16x32_bf16 v[44:47], v[176:179], a[248:251], v[44:47]
buffer_load_dword v255, v248, s[24:27], 0 offen sc1
v_mfma_f32_16x16x32_bf16 v[48:51], v[176:179], a[252:255], v[48:51]
ds_read_b64_tr_b16 v[170:171], v218 offset:12800
v_mfma_f32_16x16x32_bf16 v[48:51], v[172:175], a[236:239], v[48:51]
s_waitcnt lgkmcnt(4)
v_mfma_f32_16x16x32_bf16 v[52:55], v[180:183], a[224:227], v[52:55]
ds_read_b64_tr_b16 v[172:173], v219 offset:8192
v_mfma_f32_16x16x32_bf16 v[52:55], v[184:187], a[240:243], v[52:55]
buffer_load_dwordx4 v221, s[12:15], s69 offen offset:0  lds
v_mfma_f32_16x16x32_bf16 v[56:59], v[184:187], a[244:247], v[56:59]
ds_read_b64_tr_b16 v[174:175], v219 offset:8704
v_mfma_f32_16x16x32_bf16 v[56:59], v[180:183], a[228:231], v[56:59]
v_mfma_f32_16x16x32_bf16 v[60:63], v[180:183], a[232:235], v[60:63]
ds_read_b64_tr_b16 v[176:177], v219 offset:12288
v_mfma_f32_16x16x32_bf16 v[60:63], v[184:187], a[248:251], v[60:63]
v_mfma_f32_16x16x32_bf16 v[64:67], v[184:187], a[252:255], v[64:67]
ds_read_b64_tr_b16 v[178:179], v219 offset:12800
v_mfma_f32_16x16x32_bf16 v[64:67], v[180:183], a[236:239], v[64:67]
s_waitcnt lgkmcnt(4)
v_mfma_f32_16x16x32_bf16 v[116:119], v[164:167], a[224:227], v[116:119]
ds_read_b64_tr_b16 v[180:181], v216 offset:16384
v_mfma_f32_16x16x32_bf16 v[116:119], v[168:171], a[240:243], v[116:119]
v_mfma_f32_16x16x32_bf16 v[120:123], v[168:171], a[244:247], v[120:123]
ds_read_b64_tr_b16 v[182:183], v216 offset:16896
v_mfma_f32_16x16x32_bf16 v[120:123], v[164:167], a[228:231], v[120:123]
v_mfma_f32_16x16x32_bf16 v[124:127], v[164:167], a[232:235], v[124:127]
ds_read_b64_tr_b16 v[184:185], v216 offset:20480
v_mfma_f32_16x16x32_bf16 v[124:127], v[168:171], a[248:251], v[124:127]
v_mfma_f32_16x16x32_bf16 v[128:131], v[168:171], a[252:255], v[128:131]
ds_read_b64_tr_b16 v[186:187], v216 offset:20992
v_mfma_f32_16x16x32_bf16 v[128:131], v[164:167], a[236:239], v[128:131]
s_waitcnt lgkmcnt(4)
buffer_load_dwordx4 v222, s[12:15], s69 offen offset:1024  lds
v_mfma_f32_16x16x32_bf16 v[100:103], v[172:175], a[224:227], v[100:103]
ds_read_b64_tr_b16 v[164:165], v217 offset:16384
v_mfma_f32_16x16x32_bf16 v[100:103], v[176:179], a[240:243], v[100:103]
v_mfma_f32_16x16x32_bf16 v[104:107], v[176:179], a[244:247], v[104:107]
ds_read_b64_tr_b16 v[166:167], v217 offset:16896
v_mfma_f32_16x16x32_bf16 v[104:107], v[172:175], a[228:231], v[104:107]
v_mfma_f32_16x16x32_bf16 v[108:111], v[172:175], a[232:235], v[108:111]
ds_read_b64_tr_b16 v[168:169], v217 offset:20480
v_mfma_f32_16x16x32_bf16 v[108:111], v[176:179], a[248:251], v[108:111]
v_mfma_f32_16x16x32_bf16 v[112:115], v[176:179], a[252:255], v[112:115]
ds_read_b64_tr_b16 v[170:171], v217 offset:20992
v_mfma_f32_16x16x32_bf16 v[112:115], v[172:175], a[236:239], v[112:115]
s_waitcnt lgkmcnt(4)
v_mfma_f32_16x16x32_bf16 v[36:39], v[180:183], v[4:7], v[36:39]
ds_read_b64_tr_b16 v[172:173], v218 offset:16384
v_mfma_f32_16x16x32_bf16 v[36:39], v[184:187], v[20:23], v[36:39]
v_mfma_f32_16x16x32_bf16 v[40:43], v[184:187], v[24:27], v[40:43]
ds_read_b64_tr_b16 v[174:175], v218 offset:16896
v_mfma_f32_16x16x32_bf16 v[40:43], v[180:183], v[8:11], v[40:43]
v_mfma_f32_16x16x32_bf16 v[44:47], v[180:183], v[12:15], v[44:47]
ds_read_b64_tr_b16 v[176:177], v218 offset:20480
v_mfma_f32_16x16x32_bf16 v[44:47], v[184:187], v[28:31], v[44:47]
v_mfma_f32_16x16x32_bf16 v[48:51], v[184:187], v[32:35], v[48:51]
ds_read_b64_tr_b16 v[178:179], v218 offset:20992
v_mul_f32 v231, s74, v36
v_mfma_f32_16x16x32_bf16 v[48:51], v[180:183], v[16:19], v[48:51]
s_waitcnt lgkmcnt(4)
v_exp_f32 v231, v231
v_mfma_f32_16x16x32_bf16 v[52:55], v[164:167], v[4:7], v[52:55]
ds_read_b64_tr_b16 v[180:181], v219 offset:16384
v_add_f32 v231, 1.0, v231
v_mfma_f32_16x16x32_bf16 v[52:55], v[168:171], v[20:23], v[52:55]
ds_read_b64_tr_b16 v[182:183], v219 offset:16896
v_mul_f32 v232, s74, v37
v_mfma_f32_16x16x32_bf16 v[56:59], v[168:171], v[24:27], v[56:59]
ds_read_b64_tr_b16 v[184:185], v219 offset:20480
v_mul_f32 v230, s74, v38
v_mfma_f32_16x16x32_bf16 v[56:59], v[164:167], v[8:11], v[56:59]
ds_read_b64_tr_b16 v[186:187], v219 offset:20992
v_mfma_f32_16x16x32_bf16 v[60:63], v[164:167], v[12:15], v[60:63]
v_rcp_f32 v231, v231
v_mfma_f32_16x16x32_bf16 v[60:63], v[168:171], v[28:31], v[60:63]
v_exp_f32 v232, v232
v_mfma_f32_16x16x32_bf16 v[64:67], v[168:171], v[32:35], v[64:67]
v_exp_f32 v230, v230
v_mfma_f32_16x16x32_bf16 v[64:67], v[164:167], v[16:19], v[64:67]
s_waitcnt vmcnt(19) lgkmcnt(0)
s_barrier
v_mfma_f32_16x16x32_bf16 v[116:119], v[172:175], v[4:7], v[116:119]
s_lshr_b32 s70, s3, 1
ds_read_b64_tr_b16 v[164:165], v216 offset:24576
v_mul_f32 v36, v36, v231
v_mfma_f32_16x16x32_bf16 v[116:119], v[176:179], v[20:23], v[116:119]
s_lshl2_add_u32 s70, s70, 0
v_add_f32 v232, 1.0, v232
v_add_f32 v230, 1.0, v230
v_mfma_f32_16x16x32_bf16 v[120:123], v[176:179], v[24:27], v[120:123]
s_lshr_b64 s[52:53], s[54:55], s70
ds_read_b64_tr_b16 v[166:167], v216 offset:25088
v_mul_f32 v231, s74, v39
v_mfma_f32_16x16x32_bf16 v[120:123], v[172:175], v[8:11], v[120:123]
s_and_b32 s70, s52, 15
v_rcp_f32 v232, v232
v_mfma_f32_16x16x32_bf16 v[124:127], v[172:175], v[12:15], v[124:127]
s_and_b32 s69, s3, 1
ds_read_b64_tr_b16 v[168:169], v216 offset:28672
v_mul_f32 v37, v37, v232
v_mfma_f32_16x16x32_bf16 v[124:127], v[176:179], v[28:31], v[124:127]
s_lshl1_add_u32 s70, s70, s69
v_rcp_f32 v230, v230
v_mfma_f32_16x16x32_bf16 v[128:131], v[176:179], v[32:35], v[128:131]
s_mul_i32 s69, s70, 294912
ds_read_b64_tr_b16 v[170:171], v216 offset:29184
v_mul_f32 v38, v38, v230
v_mfma_f32_16x16x32_bf16 v[128:131], v[172:175], v[16:19], v[128:131]
s_add_u32 s69, s69, s68
v_exp_f32 v231, v231
v_mfma_f32_16x16x32_bf16 v[100:103], v[180:183], v[4:7], v[100:103]
PAD_4:
s_cmp_lg_u32 s73, 0
s_cbranch_scc1 PAD_8
s_lshr_b32 s70, s71, 1
ds_read_b64_tr_b16 v[172:173], v217 offset:24576
v_add_f32 v231, 1.0, v231
v_mfma_f32_16x16x32_bf16 v[100:103], v[184:187], v[20:23], v[100:103]
s_add_u32 m0, s70, 0
v_rcp_f32 v231, v231
v_mfma_f32_16x16x32_bf16 v[104:107], v[184:187], v[24:27], v[104:107]
s_lshr_b32 s70, s3, 1
ds_read_b64_tr_b16 v[174:175], v217 offset:25088
v_mul_f32 v39, v39, v231
v_mfma_f32_16x16x32_bf16 v[104:107], v[180:183], v[8:11], v[104:107]
s_lshl2_add_u32 s70, s70, 8
buffer_load_dwordx4 v223, s[8:11], s69 offen lds
v_mfma_f32_16x16x32_bf16 v[108:111], v[180:183], v[12:15], v[108:111]
s_lshr_b64 s[52:53], s[54:55], s70
ds_read_b64_tr_b16 v[176:177], v217 offset:28672
v_mul_f32 v232, s74, v40
v_mfma_f32_16x16x32_bf16 v[108:111], v[184:187], v[28:31], v[108:111]
s_and_b32 s70, s52, 15
v_exp_f32 v232, v232
v_mfma_f32_16x16x32_bf16 v[112:115], v[184:187], v[32:35], v[112:115]
s_and_b32 s69, s3, 1
ds_read_b64_tr_b16 v[178:179], v217 offset:29184
v_add_f32 v232, 1.0, v232
v_mfma_f32_16x16x32_bf16 v[112:115], v[180:183], v[16:19], v[112:115]
s_waitcnt lgkmcnt(4)
v_rcp_f32 v232, v232
v_mfma_f32_16x16x32_bf16 v[68:71], v[164:167], a[0:3], 0
s_lshl1_add_u32 s70, s70, s69
ds_read_b64_tr_b16 v[180:181], v218 offset:24576
v_mul_f32 v40, v40, v232
v_mfma_f32_16x16x32_bf16 v[68:71], v[168:171], a[16:19], v[68:71]
s_mul_i32 s69, s70, 294912
v_mul_f32 v230, s74, v41
v_mul_f32 v231, s74, v42
v_mfma_f32_16x16x32_bf16 v[72:75], v[168:171], a[20:23], 0
s_add_u32 s69, s69, s68
ds_read_b64_tr_b16 v[182:183], v218 offset:25088
v_mul_f32 v232, s74, v43
v_mfma_f32_16x16x32_bf16 v[72:75], v[164:167], a[4:7], v[72:75]
s_lshr_b32 s70, s71, 1
v_exp_f32 v230, v230
v_mfma_f32_16x16x32_bf16 v[76:79], v[164:167], a[8:11], 0
s_add_u32 m0, s70, 4096
ds_read_b64_tr_b16 v[184:185], v218 offset:28672
v_add_f32 v230, 1.0, v230
v_mfma_f32_16x16x32_bf16 v[76:79], v[168:171], a[24:27], v[76:79]
s_lshr_b32 s70, s3, 1
buffer_load_dwordx4 v223, s[8:11], s69 offen lds
v_mfma_f32_16x16x32_bf16 v[80:83], v[168:171], a[28:31], 0
s_lshl2_add_u32 s70, s70, 16
ds_read_b64_tr_b16 v[186:187], v218 offset:29184
v_mul_f32 v233, s74, v116
v_mfma_f32_16x16x32_bf16 v[80:83], v[164:167], a[12:15], v[80:83]
s_waitcnt lgkmcnt(4)
v_rcp_f32 v230, v230
v_mfma_f32_16x16x32_bf16 v[84:87], v[172:175], a[0:3], 0
s_lshr_b64 s[52:53], s[54:55], s70
ds_read_b64_tr_b16 v[164:165], v219 offset:24576
v_mul_f32 v41, v41, v230
v_mfma_f32_16x16x32_bf16 v[84:87], v[176:179], a[16:19], v[84:87]
s_and_b32 s70, s52, 15
v_exp_f32 v231, v231
v_mfma_f32_16x16x32_bf16 v[88:91], v[176:179], a[20:23], 0
s_and_b32 s69, s3, 1
ds_read_b64_tr_b16 v[166:167], v219 offset:25088
v_add_f32 v231, 1.0, v231
v_mfma_f32_16x16x32_bf16 v[88:91], v[172:175], a[4:7], v[88:91]
s_lshl1_add_u32 s70, s70, s69
v_rcp_f32 v231, v231
v_mfma_f32_16x16x32_bf16 v[92:95], v[172:175], a[8:11], 0
s_mul_i32 s69, s70, 294912
ds_read_b64_tr_b16 v[168:169], v219 offset:28672
v_mul_f32 v42, v42, v231
v_mfma_f32_16x16x32_bf16 v[92:95], v[176:179], a[24:27], v[92:95]
s_add_u32 s69, s69, s68
v_exp_f32 v232, v232
v_mfma_f32_16x16x32_bf16 v[96:99], v[176:179], a[28:31], 0
s_lshr_b32 s70, s71, 1
ds_read_b64_tr_b16 v[170:171], v219 offset:29184
v_add_f32 v232, 1.0, v232
v_mfma_f32_16x16x32_bf16 v[96:99], v[172:175], a[12:15], v[96:99]
s_waitcnt lgkmcnt(4)
v_rcp_f32 v232, v232
v_mfma_f32_16x16x32_bf16 v[132:135], v[180:183], a[0:3], 0
s_add_u32 m0, s70, 8192
ds_read_b64_tr_b16 v[172:173], v216 offset:32768
v_mul_f32 v43, v43, v232
v_mfma_f32_16x16x32_bf16 v[132:135], v[184:187], a[16:19], v[132:135]
s_lshr_b32 s70, s3, 1
v_exp_f32 v233, v233
v_mfma_f32_16x16x32_bf16 v[136:139], v[184:187], a[20:23], 0
s_lshl2_add_u32 s70, s70, 24
ds_read_b64_tr_b16 v[174:175], v216 offset:33280
v_mul_f32 v230, s74, v44
v_mfma_f32_16x16x32_bf16 v[136:139], v[180:183], a[4:7], v[136:139]
s_lshr_b64 s[52:53], s[54:55], s70
v_exp_f32 v230, v230
v_mfma_f32_16x16x32_bf16 v[140:143], v[180:183], a[8:11], 0
s_and_b32 s70, s52, 15
ds_read_b64_tr_b16 v[176:177], v216 offset:36864
v_add_f32 v230, 1.0, v230
v_mfma_f32_16x16x32_bf16 v[140:143], v[184:187], a[24:27], v[140:143]
v_rcp_f32 v230, v230
v_mfma_f32_16x16x32_bf16 v[144:147], v[184:187], a[28:31], 0
ds_read_b64_tr_b16 v[178:179], v216 offset:37376
v_mul_f32 v44, v44, v230
v_mfma_f32_16x16x32_bf16 v[144:147], v[180:183], a[12:15], v[144:147]
s_waitcnt lgkmcnt(4)
v_mul_f32 v231, s74, v45
v_mul_f32 v232, s74, v46
v_mfma_f32_16x16x32_bf16 v[148:151], v[164:167], a[0:3], 0
ds_read_b64_tr_b16 v[180:181], v217 offset:32768
v_mul_f32 v230, s74, v47
v_mfma_f32_16x16x32_bf16 v[148:151], v[168:171], a[16:19], v[148:151]
buffer_load_dwordx4 v223, s[8:11], s69 offen lds
v_mfma_f32_16x16x32_bf16 v[152:155], v[168:171], a[20:23], 0
s_and_b32 s69, s3, 1
ds_read_b64_tr_b16 v[182:183], v217 offset:33280
v_add_f32 v233, 1.0, v233
v_mfma_f32_16x16x32_bf16 v[152:155], v[164:167], a[4:7], v[152:155]
s_lshl1_add_u32 s70, s70, s69
v_exp_f32 v231, v231
v_mfma_f32_16x16x32_bf16 v[156:159], v[164:167], a[8:11], 0
s_mul_i32 s69, s70, 294912
ds_read_b64_tr_b16 v[184:185], v217 offset:36864
v_add_f32 v231, 1.0, v231
v_mfma_f32_16x16x32_bf16 v[156:159], v[168:171], a[24:27], v[156:159]
s_add_u32 s69, s69, s68
v_rcp_f32 v231, v231
v_mfma_f32_16x16x32_bf16 v[160:163], v[168:171], a[28:31], 0
s_lshr_b32 s70, s71, 1
ds_read_b64_tr_b16 v[186:187], v217 offset:37376
v_mul_f32 v45, v45, v231
v_mfma_f32_16x16x32_bf16 v[160:163], v[164:167], a[12:15], v[160:163]
s_waitcnt lgkmcnt(4)
v_exp_f32 v232, v232
v_mfma_f32_16x16x32_bf16 v[68:71], v[172:175], a[32:35], v[68:71]
s_add_u32 m0, s70, 12288
ds_read_b64_tr_b16 v[164:165], v218 offset:32768
v_add_f32 v232, 1.0, v232
v_mfma_f32_16x16x32_bf16 v[68:71], v[176:179], a[48:51], v[68:71]
s_lshr_b32 s70, s3, 1
v_rcp_f32 v232, v232
v_mfma_f32_16x16x32_bf16 v[72:75], v[176:179], a[52:55], v[72:75]
s_lshl2_add_u32 s70, s70, 32
ds_read_b64_tr_b16 v[166:167], v218 offset:33280
v_mul_f32 v46, v46, v232
v_mfma_f32_16x16x32_bf16 v[72:75], v[172:175], a[36:39], v[72:75]
s_waitcnt vmcnt(5)
v_exp_f32 v230, v230
v_mfma_f32_16x16x32_bf16 v[76:79], v[172:175], a[40:43], v[76:79]
s_lshr_b64 s[52:53], s[54:55], s70
ds_read_b64_tr_b16 v[168:169], v218 offset:36864
v_cmp_gt_u32 vcc, 1, v255
v_mfma_f32_16x16x32_bf16 v[76:79], v[176:179], a[56:59], v[76:79]
s_and_b32 s70, s52, 15
v_rcp_f32 v233, v233
v_mfma_f32_16x16x32_bf16 v[80:83], v[176:179], a[60:63], v[80:83]
s_cbranch_vccnz SLOW_guard
RET_guard:
ds_read_b64_tr_b16 v[170:171], v218 offset:37376
v_add_f32 v230, 1.0, v230
v_mfma_f32_16x16x32_bf16 v[80:83], v[172:175], a[44:47], v[80:83]
s_waitcnt lgkmcnt(4)
v_rcp_f32 v230, v230
v_mfma_f32_16x16x32_bf16 v[84:87], v[180:183], a[32:35], v[84:87]
ds_read_b64_tr_b16 v[172:173], v219 offset:32768
v_mul_f32 v47, v47, v230
v_mfma_f32_16x16x32_bf16 v[84:87], v[184:187], a[48:51], v[84:87]
buffer_store_dword v213, v214, s[20:23], s76 offen sc1
v_mfma_f32_16x16x32_bf16 v[88:91], v[184:187], a[52:55], v[88:91]
ds_read_b64_tr_b16 v[174:175], v219 offset:33280
v_mov_b32 v213, 2
v_mfma_f32_16x16x32_bf16 v[88:91], v[180:183], a[36:39], v[88:91]
v_mul_f32 v231, s74, v48
v_mul_f32 v232, s74, v49
v_mfma_f32_16x16x32_bf16 v[92:95], v[180:183], a[40:43], v[92:95]
ds_read_b64_tr_b16 v[176:177], v219 offset:36864
v_mul_f32 v230, s74, v50
v_mfma_f32_16x16x32_bf16 v[92:95], v[184:187], a[56:59], v[92:95]
buffer_load_dwordx4 v223, s[8:11], s69 offen lds
v_mfma_f32_16x16x32_bf16 v[96:99], v[184:187], a[60:63], v[96:99]
s_and_b32 s69, s3, 1
ds_read_b64_tr_b16 v[178:179], v219 offset:37376
v_mul_f32 v116, v116, v233
v_mfma_f32_16x16x32_bf16 v[96:99], v[180:183], a[44:47], v[96:99]
s_waitcnt lgkmcnt(4)
v_exp_f32 v231, v231
v_mfma_f32_16x16x32_bf16 v[132:135], v[164:167], a[32:35], v[132:135]
s_lshl1_add_u32 s70, s70, s69
ds_read_b64_tr_b16 v[180:181], v216 offset:40960
v_add_f32 v231, 1.0, v231
v_mfma_f32_16x16x32_bf16 v[132:135], v[168:171], a[48:51], v[132:135]
s_mul_i32 s69, s70, 294912
v_rcp_f32 v231, v231
v_mfma_f32_16x16x32_bf16 v[136:139], v[168:171], a[52:55], v[136:139]
s_add_u32 s69, s69, s68
ds_read_b64_tr_b16 v[182:183], v216 offset:41472
v_mul_f32 v48, v48, v231
v_mfma_f32_16x16x32_bf16 v[136:139], v[164:167], a[36:39], v[136:139]
s_lshr_b32 s70, s3, 1
v_exp_f32 v232, v232
v_mfma_f32_16x16x32_bf16 v[140:143], v[164:167], a[40:43], v[140:143]
s_lshl_b32 s70, s70, 28
ds_read_b64_tr_b16 v[184:185], v216 offset:45056
v_add_f32 v232, 1.0, v232
v_mfma_f32_16x16x32_bf16 v[140:143], v[168:171], a[56:59], v[140:143]
s_add_u32 s69, s69, s70
v_rcp_f32 v232, v232
v_mfma_f32_16x16x32_bf16 v[144:147], v[168:171], a[60:63], v[144:147]
s_lshr_b32 s70, s71, 1
ds_read_b64_tr_b16 v[186:187], v216 offset:45568
v_mul_f32 v49, v49, v232
v_mfma_f32_16x16x32_bf16 v[144:147], v[164:167], a[44:47], v[144:147]
s_waitcnt lgkmcnt(4)
v_exp_f32 v230, v230
v_mfma_f32_16x16x32_bf16 v[148:151], v[172:175], a[32:35], v[148:151]
s_add_u32 m0, s70, 16384
ds_read_b64_tr_b16 v[164:165], v217 offset:40960
v_add_u32 v216, 0xc000, v216
v_mfma_f32_16x16x32_bf16 v[148:151], v[176:179], a[48:51], v[148:151]
v_add_f32 v230, 1.0, v230
v_mul_f32 v231, s74, v51
v_mfma_f32_16x16x32_bf16 v[152:155], v[176:179], a[52:55], v[152:155]
ds_read_b64_tr_b16 v[166:167], v217 offset:41472
v_mul_f32 v232, s74, v52
v_mfma_f32_16x16x32_bf16 v[152:155], v[172:175], a[36:39], v[152:155]
v_rcp_f32 v230, v230
v_mfma_f32_16x16x32_bf16 v[156:159], v[172:175], a[40:43], v[156:159]
ds_read_b64_tr_b16 v[168:169], v217 offset:45056
v_mul_f32 v50, v50, v230
v_mfma_f32_16x16x32_bf16 v[156:159], v[176:179], a[56:59], v[156:159]
v_exp_f32 v231, v231
v_mfma_f32_16x16x32_bf16 v[160:163], v[176:179], a[60:63], v[160:163]
ds_read_b64_tr_b16 v[170:171], v217 offset:45568
v_add_f32 v231, 1.0, v231
v_mfma_f32_16x16x32_bf16 v[160:163], v[172:175], a[44:47], v[160:163]
s_waitcnt lgkmcnt(4)
v_rcp_f32 v231, v231
v_mfma_f32_16x16x32_bf16 v[68:71], v[180:183], a[64:67], v[68:71]
ds_read_b64_tr_b16 v[172:173], v218 offset:40960
v_add_u32 v217, 0xc000, v217
v_mfma_f32_16x16x32_bf16 v[68:71], v[184:187], a[80:83], v[68:71]
buffer_load_dwordx4 v223, s[8:11], s69 offen lds
v_mfma_f32_16x16x32_bf16 v[72:75], v[184:187], a[84:87], v[72:75]
ds_read_b64_tr_b16 v[174:175], v218 offset:41472
v_mul_f32 v51, v51, v231
v_mfma_f32_16x16x32_bf16 v[72:75], v[180:183], a[68:71], v[72:75]
v_exp_f32 v232, v232
v_mfma_f32_16x16x32_bf16 v[76:79], v[180:183], a[72:75], v[76:79]
ds_read_b64_tr_b16 v[176:177], v218 offset:45056
v_add_f32 v232, 1.0, v232
v_mfma_f32_16x16x32_bf16 v[76:79], v[184:187], a[88:91], v[76:79]
v_rcp_f32 v232, v232
v_mfma_f32_16x16x32_bf16 v[80:83], v[184:187], a[92:95], v[80:83]
ds_read_b64_tr_b16 v[178:179], v218 offset:45568
v_mul_f32 v52, v52, v232
v_mfma_f32_16x16x32_bf16 v[80:83], v[180:183], a[76:79], v[80:83]
s_waitcnt lgkmcnt(4)
v_mul_f32 v230, s74, v53
v_mul_f32 v231, s74, v54
v_mfma_f32_16x16x32_bf16 v[84:87], v[164:167], a[64:67], v[84:87]
ds_read_b64_tr_b16 v[180:181], v219 offset:40960
v_add_u32 v218, 0xc000, v218
v_mfma_f32_16x16x32_bf16 v[84:87], v[168:171], a[80:83], v[84:87]
ds_read_b64_tr_b16 v[182:183], v219 offset:41472
v_mul_f32 v232, s74, v55
v_mfma_f32_16x16x32_bf16 v[88:91], v[168:171], a[84:87], v[88:91]
ds_read_b64_tr_b16 v[184:185], v219 offset:45056
v_mul_f32 v234, s74, v117
v_mfma_f32_16x16x32_bf16 v[88:91], v[164:167], a[68:71], v[88:91]
ds_read_b64_tr_b16 v[186:187], v219 offset:45568
v_mul_f32 v235, s74, v118
v_mfma_f32_16x16x32_bf16 v[92:95], v[164:167], a[72:75], v[92:95]
v_exp_f32 v230, v230
v_mfma_f32_16x16x32_bf16 v[92:95], v[168:171], a[88:91], v[92:95]
v_exp_f32 v231, v231
v_mfma_f32_16x16x32_bf16 v[96:99], v[168:171], a[92:95], v[96:99]
v_exp_f32 v232, v232
v_mfma_f32_16x16x32_bf16 v[96:99], v[164:167], a[76:79], v[96:99]
s_waitcnt vmcnt(6) lgkmcnt(0)
s_barrier
v_mfma_f32_16x16x32_bf16 v[132:135], v[172:175], a[64:67], v[132:135]
ds_read_b64_tr_b16 v[164:165], v216 offset:0
v_add_u32 v219, 0xc000, v219
v_mfma_f32_16x16x32_bf16 v[132:135], v[176:179], a[80:83], v[132:135]
v_exp_f32 v234, v234
v_mfma_f32_16x16x32_bf16 v[136:139], v[176:179], a[84:87], v[136:139]
ds_read_b64_tr_b16 v[166:167], v216 offset:512
v_add_f32 v230, 1.0, v230
v_mfma_f32_16x16x32_bf16 v[136:139], v[172:175], a[68:71], v[136:139]
v_rcp_f32 v230, v230
v_mfma_f32_16x16x32_bf16 v[140:143], v[172:175], a[72:75], v[140:143]
s_lshr_b32 s70, s3, 1
ds_read_b64_tr_b16 v[168:169], v216 offset:4096
v_mul_f32 v53, v53, v230
v_mfma_f32_16x16x32_bf16 v[140:143], v[176:179], a[88:91], v[140:143]
s_lshl2_add_u32 s70, s70, 0
v_exp_f32 v235, v235
v_mfma_f32_16x16x32_bf16 v[144:147], v[176:179], a[92:95], v[144:147]
s_lshr_b64 s[52:53], s[54:55], s70
ds_read_b64_tr_b16 v[170:171], v216 offset:4608
v_add_f32 v231, 1.0, v231
v_mfma_f32_16x16x32_bf16 v[144:147], v[172:175], a[76:79], v[144:147]
s_and_b32 s70, s52, 15
v_rcp_f32 v231, v231
v_mfma_f32_16x16x32_bf16 v[148:151], v[180:183], a[64:67], v[148:151]
s_and_b32 s69, s3, 1
ds_read_b64_tr_b16 v[172:173], v217 offset:0
v_mul_f32 v54, v54, v231
v_mfma_f32_16x16x32_bf16 v[148:151], v[184:187], a[80:83], v[148:151]
s_lshl1_add_u32 s70, s70, s69
v_add_f32 v232, 1.0, v232
v_mul_f32 v230, s74, v56
v_mfma_f32_16x16x32_bf16 v[152:155], v[184:187], a[84:87], v[152:155]
s_mul_i32 s69, s70, 294912
ds_read_b64_tr_b16 v[174:175], v217 offset:512
v_mul_f32 v231, s74, v57
v_mfma_f32_16x16x32_bf16 v[152:155], v[180:183], a[68:71], v[152:155]
s_add_u32 s69, s69, s68
v_rcp_f32 v232, v232
v_mfma_f32_16x16x32_bf16 v[156:159], v[180:183], a[72:75], v[156:159]
s_lshr_b32 s70, s71, 1
ds_read_b64_tr_b16 v[176:177], v217 offset:4096
v_mul_f32 v55, v55, v232
v_mfma_f32_16x16x32_bf16 v[156:159], v[184:187], a[88:91], v[156:159]
s_add_u32 m0, s70, 24576
v_exp_f32 v230, v230
v_mfma_f32_16x16x32_bf16 v[160:163], v[184:187], a[92:95], v[160:163]
s_lshr_b32 s70, s3, 1
ds_read_b64_tr_b16 v[178:179], v217 offset:4608
v_add_f32 v230, 1.0, v230
v_mfma_f32_16x16x32_bf16 v[160:163], v[180:183], a[76:79], v[160:163]
s_waitcnt lgkmcnt(4)
buffer_load_dwordx4 v223, s[12:15], s69 offen lds
v_mfma_f32_16x16x32_bf16 v[68:71], v[164:167], a[96:99], v[68:71]
s_lshl2_add_u32 s70, s70, 8
ds_read_b64_tr_b16 v[180:181], v218 offset:0
v_mul_f32 v232, s74, v58
v_mfma_f32_16x16x32_bf16 v[68:71], v[168:171], a[112:115], v[68:71]
s_lshr_b64 s[52:53], s[54:55], s70
v_rcp_f32 v230, v230
v_mfma_f32_16x16x32_bf16 v[72:75], v[168:171], a[116:119], v[72:75]
s_and_b32 s70, s52, 15
ds_read_b64_tr_b16 v[182:183], v218 offset:512
v_mul_f32 v56, v56, v230
v_mfma_f32_16x16x32_bf16 v[72:75], v[164:167], a[100:103], v[72:75]
s_and_b32 s69, s3, 1
v_exp_f32 v231, v231
v_mfma_f32_16x16x32_bf16 v[76:79], v[164:167], a[104:107], v[76:79]
s_lshl1_add_u32 s70, s70, s69
ds_read_b64_tr_b16 v[184:185], v218 offset:4096
v_add_f32 v231, 1.0, v231
v_mfma_f32_16x16x32_bf16 v[76:79], v[168:171], a[120:123], v[76:79]
s_mul_i32 s69, s70, 294912
v_rcp_f32 v231, v231
v_mfma_f32_16x16x32_bf16 v[80:83], v[168:171], a[124:127], v[80:83]
s_add_u32 s69, s69, s68
ds_read_b64_tr_b16 v[186:187], v218 offset:4608
v_mul_f32 v57, v57, v231
v_mfma_f32_16x16x32_bf16 v[80:83], v[164:167], a[108:111], v[80:83]
s_waitcnt lgkmcnt(4)
v_exp_f32 v232, v232
v_mfma_f32_16x16x32_bf16 v[84:87], v[172:175], a[96:99], v[84:87]
s_lshr_b32 s70, s71, 1
ds_read_b64_tr_b16 v[164:165], v219 offset:0
v_add_f32 v232, 1.0, v232
v_mfma_f32_16x16x32_bf16 v[84:87], v[176:179], a[112:115], v[84:87]
s_add_u32 m0, s70, 28672
v_rcp_f32 v232, v232
v_mfma_f32_16x16x32_bf16 v[88:91], v[176:179], a[116:119], v[88:91]
s_lshr_b32 s70, s3, 1
ds_read_b64_tr_b16 v[166:167], v219 offset:512
v_mul_f32 v58, v58, v232
v_mfma_f32_16x16x32_bf16 v[88:91], v[172:175], a[100:103], v[88:91]
s_lshl2_add_u32 s70, s70, 16
buffer_load_dwordx4 v223, s[12:15], s69 offen lds
v_mfma_f32_16x16x32_bf16 v[92:95], v[172:175], a[104:107], v[92:95]
s_lshr_b64 s[52:53], s[54:55], s70
ds_read_b64_tr_b16 v[168:169], v219 offset:4096
v_mul_f32 v230, s74, v59
v_mfma_f32_16x16x32_bf16 v[92:95], v[176:179], a[120:123], v[92:95]
s_and_b32 s70, s52, 15
v_exp_f32 v230, v230
v_mfma_f32_16x16x32_bf16 v[96:99], v[176:179], a[124:127], v[96:99]
s_and_b32 s69, s3, 1
ds_read_b64_tr_b16 v[170:171], v219 offset:4608
v_add_f32 v230, 1.0, v230
v_mfma_f32_16x16x32_bf16 v[96:99], v[172:175], a[108:111], v[96:99]
s_waitcnt lgkmcnt(4)
v_rcp_f32 v230, v230
v_mfma_f32_16x16x32_bf16 v[132:135], v[180:183], a[96:99], v[132:135]
s_lshl1_add_u32 s70, s70, s69
ds_read_b64_tr_b16 v[172:173], v216 offset:8192
v_mul_f32 v59, v59, v230
v_mfma_f32_16x16x32_bf16 v[132:135], v[184:187], a[112:115], v[132:135]
s_mul_i32 s69, s70, 294912
v_mul_f32 v231, s74, v60
v_mul_f32 v232, s74, v61
v_mfma_f32_16x16x32_bf16 v[136:139], v[184:187], a[116:119], v[136:139]
s_add_u32 s69, s69, s68
ds_read_b64_tr_b16 v[174:175], v216 offset:8704
v_mul_f32 v230, s74, v62
v_mfma_f32_16x16x32_bf16 v[136:139], v[180:183], a[100:103], v[136:139]
s_lshr_b32 s70, s71, 1
v_exp_f32 v231, v231
v_mfma_f32_16x16x32_bf16 v[140:143], v[180:183], a[104:107], v[140:143]
s_add_u32 m0, s70, 32768
ds_read_b64_tr_b16 v[176:177], v216 offset:12288
v_add_f32 v231, 1.0, v231
v_mfma_f32_16x16x32_bf16 v[140:143], v[184:187], a[120:123], v[140:143]
s_lshr_b32 s70, s3, 1
v_rcp_f32 v231, v231
v_mfma_f32_16x16x32_bf16 v[144:147], v[184:187], a[124:127], v[144:147]
s_lshl2_add_u32 s70, s70, 24
ds_read_b64_tr_b16 v[178:179], v216 offset:12800
v_mul_f32 v60, v60, v231
v_mfma_f32_16x16x32_bf16 v[144:147], v[180:183], a[108:111], v[144:147]
s_waitcnt lgkmcnt(4)
v_exp_f32 v232, v232
v_mfma_f32_16x16x32_bf16 v[148:151], v[164:167], a[96:99], v[148:151]
s_lshr_b64 s[52:53], s[54:55], s70
ds_read_b64_tr_b16 v[180:181], v217 offset:8192
v_add_f32 v232, 1.0, v232
v_mfma_f32_16x16x32_bf16 v[148:151], v[168:171], a[112:115], v[148:151]
s_and_b32 s70, s52, 15
v_rcp_f32 v232, v232
v_mfma_f32_16x16x32_bf16 v[152:155], v[168:171], a[116:119], v[152:155]
ds_read_b64_tr_b16 v[182:183], v217 offset:8704
v_mul_f32 v61, v61, v232
v_mfma_f32_16x16x32_bf16 v[152:155], v[164:167], a[100:103], v[152:155]
v_exp_f32 v230, v230
v_mfma_f32_16x16x32_bf16 v[156:159], v[164:167], a[104:107], v[156:159]
ds_read_b64_tr_b16 v[184:185], v217 offset:12288
v_add_f32 v230, 1.0, v230
v_mfma_f32_16x16x32_bf16 v[156:159], v[168:171], a[120:123], v[156:159]
buffer_load_dwordx4 v223, s[12:15], s69 offen lds
v_mfma_f32_16x16x32_bf16 v[160:163], v[168:171], a[124:127], v[160:163]
s_and_b32 s69, s3, 1
ds_read_b64_tr_b16 v[186:187], v217 offset:12800
v_mul_f32 v231, s74, v63
v_mfma_f32_16x16x32_bf16 v[160:163], v[164:167], a[108:111], v[160:163]
s_waitcnt lgkmcnt(4)
v_rcp_f32 v230, v230
v_mfma_f32_16x16x32_bf16 v[68:71], v[172:175], a[128:131], v[68:71]
s_lshl1_add_u32 s70, s70, s69
ds_read_b64_tr_b16 v[164:165], v218 offset:8192
v_mul_f32 v62, v62, v230
v_mfma_f32_16x16x32_bf16 v[68:71], v[176:179], a[144:147], v[68:71]
s_mul_i32 s69, s70, 294912
v_exp_f32 v231, v231
v_mfma_f32_16x16x32_bf16 v[72:75], v[176:179], a[148:151], v[72:75]
s_add_u32 s69, s69, s68
ds_read_b64_tr_b16 v[166:167], v218 offset:8704
v_add_f32 v231, 1.0, v231
v_mfma_f32_16x16x32_bf16 v[72:75], v[172:175], a[132:135], v[72:75]
s_lshr_b32 s70, s71, 1
v_rcp_f32 v231, v231
v_mfma_f32_16x16x32_bf16 v[76:79], v[172:175], a[136:139], v[76:79]
s_add_u32 m0, s70, 36864
ds_read_b64_tr_b16 v[168:169], v218 offset:12288
v_mul_f32 v63, v63, v231
v_mfma_f32_16x16x32_bf16 v[76:79], v[176:179], a[152:155], v[76:79]
s_lshr_b32 s70, s3, 1
v_mul_f32 v232, s74, v64
v_mul_f32 v230, s74, v65
v_mfma_f32_16x16x32_bf16 v[80:83], v[176:179], a[156:159], v[80:83]
s_lshl2_add_u32 s70, s70, 32
ds_read_b64_tr_b16 v[170:171], v218 offset:12800
v_mul_f32 v231, s74, v66
v_mfma_f32_16x16x32_bf16 v[80:83], v[172:175], a[140:143], v[80:83]
s_waitcnt lgkmcnt(4)
v_exp_f32 v232, v232
v_mfma_f32_16x16x32_bf16 v[84:87], v[180:183], a[128:131], v[84:87]
s_lshr_b64 s[52:53], s[54:55], s70
ds_read_b64_tr_b16 v[172:173], v219 offset:8192
v_add_f32 v232, 1.0, v232
v_mfma_f32_16x16x32_bf16 v[84:87], v[184:187], a[144:147], v[84:87]
s_and_b32 s70, s52, 15
v_rcp_f32 v232, v232
v_mfma_f32_16x16x32_bf16 v[88:91], v[184:187], a[148:151], v[88:91]
ds_read_b64_tr_b16 v[174:175], v219 offset:8704
v_mul_f32 v64, v64, v232
v_mfma_f32_16x16x32_bf16 v[88:91], v[180:183], a[132:135], v[88:91]
v_exp_f32 v230, v230
v_mfma_f32_16x16x32_bf16 v[92:95], v[180:183], a[136:139], v[92:95]
ds_read_b64_tr_b16 v[176:177], v219 offset:12288
v_add_f32 v230, 1.0, v230
v_mfma_f32_16x16x32_bf16 v[92:95], v[184:187], a[152:155], v[92:95]
v_rcp_f32 v230, v230
v_mfma_f32_16x16x32_bf16 v[96:99], v[184:187], a[156:159], v[96:99]
ds_read_b64_tr_b16 v[178:179], v219 offset:12800
v_mul_f32 v65, v65, v230
v_mfma_f32_16x16x32_bf16 v[96:99], v[180:183], a[140:143], v[96:99]
s_waitcnt lgkmcnt(4)
v_exp_f32 v231, v231
v_mfma_f32_16x16x32_bf16 v[132:135], v[164:167], a[128:131], v[132:135]
ds_read_b64_tr_b16 v[180:181], v216 offset:16384
v_add_f32 v231, 1.0, v231
v_mfma_f32_16x16x32_bf16 v[132:135], v[168:171], a[144:147], v[132:135]
buffer_load_dwordx4 v223, s[12:15], s69 offen lds
v_mfma_f32_16x16x32_bf16 v[136:139], v[168:171], a[148:151], v[136:139]
s_and_b32 s69, s3, 1
ds_read_b64_tr_b16 v[182:183], v216 offset:16896
v_mul_f32 v232, s74, v67
v_mfma_f32_16x16x32_bf16 v[136:139], v[164:167], a[132:135], v[136:139]
s_lshl1_add_u32 s70, s70, s69
v_rcp_f32 v231, v231
v_mfma_f32_16x16x32_bf16 v[140:143], v[164:167], a[136:139], v[140:143]
s_mul_i32 s69, s70, 294912
ds_read_b64_tr_b16 v[184:185], v216 offset:20480
v_mul_f32 v66, v66, v231
v_mfma_f32_16x16x32_bf16 v[140:143], v[168:171], a[152:155], v[140:143]
s_add_u32 s69, s69, s68
v_exp_f32 v232, v232
v_mfma_f32_16x16x32_bf16 v[144:147], v[168:171], a[156:159], v[144:147]
s_lshr_b32 s70, s3, 1
ds_read_b64_tr_b16 v[186:187], v216 offset:20992
v_add_f32 v232, 1.0, v232
v_mfma_f32_16x16x32_bf16 v[144:147], v[164:167], a[140:143], v[144:147]
s_waitcnt lgkmcnt(4)
v_rcp_f32 v232, v232
v_mfma_f32_16x16x32_bf16 v[148:151], v[172:175], a[128:131], v[148:151]
s_lshl_b32 s70, s70, 28
ds_read_b64_tr_b16 v[164:165], v217 offset:16384
v_mul_f32 v67, v67, v232
v_mfma_f32_16x16x32_bf16 v[148:151], v[176:179], a[144:147], v[148:151]
s_add_u32 s69, s69, s70
v_add_f32 v234, 1.0, v234
v_add_f32 v235, 1.0, v235
v_mfma_f32_16x16x32_bf16 v[152:155], v[176:179], a[148:151], v[152:155]
s_lshr_b32 s70, s71, 1
ds_read_b64_tr_b16 v[166:167], v217 offset:16896
v_mul_f32 v233, s74, v119
v_mfma_f32_16x16x32_bf16 v[152:155], v[172:175], a[132:135], v[152:155]
s_add_u32 m0, s70, 40960
v_rcp_f32 v234, v234
v_mfma_f32_16x16x32_bf16 v[156:159], v[172:175], a[136:139], v[156:159]
ds_read_b64_tr_b16 v[168:169], v217 offset:20480
v_mul_f32 v117, v117, v234
v_mfma_f32_16x16x32_bf16 v[156:159], v[176:179], a[152:155], v[156:159]
v_rcp_f32 v235, v235
v_mfma_f32_16x16x32_bf16 v[160:163], v[176:179], a[156:159], v[160:163]
ds_read_b64_tr_b16 v[170:171], v217 offset:20992
v_mul_f32 v118, v118, v235
v_mfma_f32_16x16x32_bf16 v[160:163], v[172:175], a[140:143], v[160:163]
s_waitcnt lgkmcnt(4)
v_exp_f32 v233, v233
v_mfma_f32_16x16x32_bf16 v[68:71], v[180:183], a[160:163], v[68:71]
ds_read_b64_tr_b16 v[172:173], v218 offset:16384
v_add_f32 v233, 1.0, v233
v_mfma_f32_16x16x32_bf16 v[68:71], v[184:187], a[176:179], v[68:71]
v_rcp_f32 v233, v233
v_mfma_f32_16x16x32_bf16 v[72:75], v[184:187], a[180:183], v[72:75]
ds_read_b64_tr_b16 v[174:175], v218 offset:16896
v_mul_f32 v119, v119, v233
v_mfma_f32_16x16x32_bf16 v[72:75], v[180:183], a[164:167], v[72:75]
v_mul_f32 v234, s74, v120
v_mul_f32 v235, s74, v121
v_mfma_f32_16x16x32_bf16 v[76:79], v[180:183], a[168:171], v[76:79]
ds_read_b64_tr_b16 v[176:177], v218 offset:20480
v_mul_f32 v233, s74, v122
v_mfma_f32_16x16x32_bf16 v[76:79], v[184:187], a[184:187], v[76:79]
buffer_load_dwordx4 v223, s[12:15], s69 offen lds
v_mfma_f32_16x16x32_bf16 v[80:83], v[184:187], a[188:191], v[80:83]
ds_read_b64_tr_b16 v[178:179], v218 offset:20992
v_mfma_f32_16x16x32_bf16 v[80:83], v[180:183], a[172:175], v[80:83]
s_waitcnt lgkmcnt(4)
v_exp_f32 v234, v234
v_mfma_f32_16x16x32_bf16 v[84:87], v[164:167], a[160:163], v[84:87]
ds_read_b64_tr_b16 v[180:181], v219 offset:16384
v_add_f32 v234, 1.0, v234
v_mfma_f32_16x16x32_bf16 v[84:87], v[168:171], a[176:179], v[84:87]
v_rcp_f32 v234, v234
v_mfma_f32_16x16x32_bf16 v[88:91], v[168:171], a[180:183], v[88:91]
ds_read_b64_tr_b16 v[182:183], v219 offset:16896
v_mul_f32 v120, v120, v234
v_mfma_f32_16x16x32_bf16 v[88:91], v[164:167], a[164:167], v[88:91]
v_exp_f32 v235, v235
v_mfma_f32_16x16x32_bf16 v[92:95], v[164:167], a[168:171], v[92:95]
ds_read_b64_tr_b16 v[184:185], v219 offset:20480
v_add_f32 v235, 1.0, v235
v_mfma_f32_16x16x32_bf16 v[92:95], v[168:171], a[184:187], v[92:95]
v_rcp_f32 v235, v235
v_mfma_f32_16x16x32_bf16 v[96:99], v[168:171], a[188:191], v[96:99]
ds_read_b64_tr_b16 v[186:187], v219 offset:20992
v_mul_f32 v121, v121, v235
v_mfma_f32_16x16x32_bf16 v[96:99], v[164:167], a[172:175], v[96:99]
s_waitcnt lgkmcnt(4)
v_exp_f32 v233, v233
v_mfma_f32_16x16x32_bf16 v[132:135], v[172:175], a[160:163], v[132:135]
s_min_u32 s70, s3, 2
ds_read_b64_tr_b16 v[164:165], v216 offset:24576
v_lshrrev_b32 v2, 2, v1
v_mfma_f32_16x16x32_bf16 v[132:135], v[176:179], a[176:179], v[132:135]
s_mul_i32 s69, s70, 12352
v_mul_u32_u24 v2, 36992, v2
v_and_b32 v3, 3, v1
v_mfma_f32_16x16x32_bf16 v[136:139], v[176:179], a[180:183], v[136:139]
s_add_u32 m0, s69, 98304
ds_read_b64_tr_b16 v[166:167], v216 offset:25088
v_lshl_add_u32 v2, v3, 4, v2
v_mfma_f32_16x16x32_bf16 v[136:139], v[172:175], a[164:167], v[136:139]
s_mul_i32 s69, s60, 3
v_add_f32 v233, 1.0, v233
v_mul_f32 v234, s74, v123
v_mfma_f32_16x16x32_bf16 v[140:143], v[172:175], a[168:171], v[140:143]
s_add_u32 s69, s69, s70
ds_read_b64_tr_b16 v[168:169], v216 offset:28672
v_mul_f32 v235, s74, v124
v_mfma_f32_16x16x32_bf16 v[140:143], v[176:179], a[184:187], v[140:143]
s_lshl_b32 s69, s69, 6
v_rcp_f32 v233, v233
v_mfma_f32_16x16x32_bf16 v[144:147], v[176:179], a[188:191], v[144:147]
s_add_u32 s69, s69, 48234496
ds_read_b64_tr_b16 v[170:171], v216 offset:29184
v_mul_f32 v122, v122, v233
v_mfma_f32_16x16x32_bf16 v[144:147], v[172:175], a[172:175], v[144:147]
s_waitcnt lgkmcnt(4)
buffer_load_dwordx4 v2, s[20:23], s69 offen offset:0 sc1 lds
v_mfma_f32_16x16x32_bf16 v[148:151], v[180:183], a[160:163], v[148:151]
ds_read_b64_tr_b16 v[172:173], v217 offset:24576
v_mul_f32 v233, s74, v125
v_mfma_f32_16x16x32_bf16 v[148:151], v[184:187], a[176:179], v[148:151]
v_exp_f32 v234, v234
v_mfma_f32_16x16x32_bf16 v[152:155], v[184:187], a[180:183], v[152:155]
ds_read_b64_tr_b16 v[174:175], v217 offset:25088
v_add_f32 v234, 1.0, v234
v_mfma_f32_16x16x32_bf16 v[152:155], v[180:183], a[164:167], v[152:155]
v_rcp_f32 v234, v234
v_mfma_f32_16x16x32_bf16 v[156:159], v[180:183], a[168:171], v[156:159]
ds_read_b64_tr_b16 v[176:177], v217 offset:28672
v_mul_f32 v123, v123, v234
v_mfma_f32_16x16x32_bf16 v[156:159], v[184:187], a[184:187], v[156:159]
v_exp_f32 v235, v235
v_mfma_f32_16x16x32_bf16 v[160:163], v[184:187], a[188:191], v[160:163]
s_add_u32 s69, s69, 590848
ds_read_b64_tr_b16 v[178:179], v217 offset:29184
v_add_f32 v235, 1.0, v235
v_mfma_f32_16x16x32_bf16 v[160:163], v[180:183], a[172:175], v[160:163]
s_waitcnt lgkmcnt(4)
buffer_load_dwordx4 v2, s[20:23], s69 offen offset:1024 sc1 lds
v_mfma_f32_16x16x32_bf16 v[68:71], v[164:167], a[192:195], v[68:71]
ds_read_b64_tr_b16 v[180:181], v218 offset:24576
v_mul_f32 v234, s74, v126
v_mfma_f32_16x16x32_bf16 v[68:71], v[168:171], a[208:211], v[68:71]
v_rcp_f32 v235, v235
v_mfma_f32_16x16x32_bf16 v[72:75], v[168:171], a[212:215], v[72:75]
ds_read_b64_tr_b16 v[182:183], v218 offset:25088
v_mul_f32 v124, v124, v235
v_mfma_f32_16x16x32_bf16 v[72:75], v[164:167], a[196:199], v[72:75]
v_exp_f32 v233, v233
v_mfma_f32_16x16x32_bf16 v[76:79], v[164:167], a[200:203], v[76:79]
ds_read_b64_tr_b16 v[184:185], v218 offset:28672
v_add_f32 v233, 1.0, v233
v_mfma_f32_16x16x32_bf16 v[76:79], v[168:171], a[216:219], v[76:79]
v_rcp_f32 v233, v233
v_mfma_f32_16x16x32_bf16 v[80:83], v[168:171], a[220:223], v[80:83]
ds_read_b64_tr_b16 v[186:187], v218 offset:29184
v_mul_f32 v125, v125, v233
v_mfma_f32_16x16x32_bf16 v[80:83], v[164:167], a[204:207], v[80:83]
s_waitcnt lgkmcnt(4)
v_exp_f32 v234, v234
v_mfma_f32_16x16x32_bf16 v[84:87], v[172:175], a[192:195], v[84:87]
ds_read_b64_tr_b16 v[164:165], v219 offset:24576
v_add_f32 v234, 1.0, v234
v_mfma_f32_16x16x32_bf16 v[84:87], v[176:179], a[208:211], v[84:87]
PAD_5:
s_cmp_lg_u32 s73, 0
s_cbranch_scc1 PAD_9
v_rcp_f32 v234, v234
v_mfma_f32_16x16x32_bf16 v[88:91], v[176:179], a[212:215], v[88:91]
ds_read_b64_tr_b16 v[166:167], v219 offset:25088
v_mul_f32 v126, v126, v234
v_mfma_f32_16x16x32_bf16 v[88:91], v[172:175], a[196:199], v[88:91]
v_mul_f32 v235, s74, v127
v_mul_f32 v233, s74, v128
v_mfma_f32_16x16x32_bf16 v[92:95], v[172:175], a[200:203], v[92:95]
s_add_u32 s69, s69, 590848
ds_read_b64_tr_b16 v[168:169], v219 offset:28672
v_mul_f32 v234, s74, v129
v_mfma_f32_16x16x32_bf16 v[92:95], v[176:179], a[216:219], v[92:95]
buffer_load_dwordx4 v2, s[20:23], s69 offen offset:2048 sc1 lds
v_mfma_f32_16x16x32_bf16 v[96:99], v[176:179], a[220:223], v[96:99]
ds_read_b64_tr_b16 v[170:171], v219 offset:29184
v_mfma_f32_16x16x32_bf16 v[96:99], v[172:175], a[204:207], v[96:99]
s_waitcnt lgkmcnt(4)
v_exp_f32 v235, v235
v_mfma_f32_16x16x32_bf16 v[132:135], v[180:183], a[192:195], v[132:135]
ds_read_b64_tr_b16 v[172:173], v216 offset:32768
v_add_f32 v235, 1.0, v235
v_mfma_f32_16x16x32_bf16 v[132:135], v[184:187], a[208:211], v[132:135]
v_rcp_f32 v235, v235
v_mfma_f32_16x16x32_bf16 v[136:139], v[184:187], a[212:215], v[136:139]
ds_read_b64_tr_b16 v[174:175], v216 offset:33280
v_mul_f32 v127, v127, v235
v_mfma_f32_16x16x32_bf16 v[136:139], v[180:183], a[196:199], v[136:139]
v_exp_f32 v233, v233
v_mfma_f32_16x16x32_bf16 v[140:143], v[180:183], a[200:203], v[140:143]
ds_read_b64_tr_b16 v[176:177], v216 offset:36864
v_add_f32 v233, 1.0, v233
v_mfma_f32_16x16x32_bf16 v[140:143], v[184:187], a[216:219], v[140:143]
v_rcp_f32 v233, v233
v_mfma_f32_16x16x32_bf16 v[144:147], v[184:187], a[220:223], v[144:147]
ds_read_b64_tr_b16 v[178:179], v216 offset:37376
v_mul_f32 v128, v128, v233
v_mfma_f32_16x16x32_bf16 v[144:147], v[180:183], a[204:207], v[144:147]
s_waitcnt lgkmcnt(4)
v_exp_f32 v234, v234
v_mfma_f32_16x16x32_bf16 v[148:151], v[164:167], a[192:195], v[148:151]
ds_read_b64_tr_b16 v[180:181], v217 offset:32768
v_add_f32 v234, 1.0, v234
v_mfma_f32_16x16x32_bf16 v[148:151], v[168:171], a[208:211], v[148:151]
v_rcp_f32 v234, v234
v_mfma_f32_16x16x32_bf16 v[152:155], v[168:171], a[212:215], v[152:155]
s_add_u32 s69, s69, 590848
ds_read_b64_tr_b16 v[182:183], v217 offset:33280
v_mul_f32 v129, v129, v234
v_mfma_f32_16x16x32_bf16 v[152:155], v[164:167], a[196:199], v[152:155]
buffer_load_dwordx4 v2, s[20:23], s69 offen offset:3072 sc1 lds
v_mfma_f32_16x16x32_bf16 v[156:159], v[164:167], a[200:203], v[156:159]
ds_read_b64_tr_b16 v[184:185], v217 offset:36864
v_mul_f32 v235, s74, v130
v_mfma_f32_16x16x32_bf16 v[156:159], v[168:171], a[216:219], v[156:159]
v_exp_f32 v235, v235
v_mfma_f32_16x16x32_bf16 v[160:163], v[168:171], a[220:223], v[160:163]
ds_read_b64_tr_b16 v[186:187], v217 offset:37376
v_add_f32 v235, 1.0, v235
v_mfma_f32_16x16x32_bf16 v[160:163], v[164:167], a[204:207], v[160:163]
s_waitcnt lgkmcnt(4)
v_rcp_f32 v235, v235
v_mfma_f32_16x16x32_bf16 v[68:71], v[172:175], a[224:227], v[68:71]
ds_read_b64_tr_b16 v[164:165], v218 offset:32768
v_mul_f32 v130, v130, v235
v_mfma_f32_16x16x32_bf16 v[68:71], v[176:179], a[240:243], v[68:71]
v_mul_f32 v233, s74, v131
v_mul_f32 v234, s74, v100
v_mfma_f32_16x16x32_bf16 v[72:75], v[176:179], a[244:247], v[72:75]
ds_read_b64_tr_b16 v[166:167], v218 offset:33280
v_mul_f32 v235, s74, v101
v_mfma_f32_16x16x32_bf16 v[72:75], v[172:175], a[228:231], v[72:75]
v_exp_f32 v233, v233
v_mfma_f32_16x16x32_bf16 v[76:79], v[172:175], a[232:235], v[76:79]
ds_read_b64_tr_b16 v[168:169], v218 offset:36864
v_add_f32 v233, 1.0, v233
v_mfma_f32_16x16x32_bf16 v[76:79], v[176:179], a[248:251], v[76:79]
v_rcp_f32 v233, v233
v_mfma_f32_16x16x32_bf16 v[80:83], v[176:179], a[252:255], v[80:83]
ds_read_b64_tr_b16 v[170:171], v218 offset:37376
v_mul_f32 v131, v131, v233
v_mfma_f32_16x16x32_bf16 v[80:83], v[172:175], a[236:239], v[80:83]
s_waitcnt lgkmcnt(4)
v_exp_f32 v234, v234
v_mfma_f32_16x16x32_bf16 v[84:87], v[180:183], a[224:227], v[84:87]
ds_read_b64_tr_b16 v[172:173], v219 offset:32768
v_add_f32 v234, 1.0, v234
v_mfma_f32_16x16x32_bf16 v[84:87], v[184:187], a[240:243], v[84:87]
v_rcp_f32 v234, v234
v_mfma_f32_16x16x32_bf16 v[88:91], v[184:187], a[244:247], v[88:91]
ds_read_b64_tr_b16 v[174:175], v219 offset:33280
v_mul_f32 v100, v100, v234
v_mfma_f32_16x16x32_bf16 v[88:91], v[180:183], a[228:231], v[88:91]
v_exp_f32 v235, v235
v_mfma_f32_16x16x32_bf16 v[92:95], v[180:183], a[232:235], v[92:95]
ds_read_b64_tr_b16 v[176:177], v219 offset:36864
v_add_f32 v235, 1.0, v235
v_mfma_f32_16x16x32_bf16 v[92:95], v[184:187], a[248:251], v[92:95]
v_rcp_f32 v235, v235
v_mfma_f32_16x16x32_bf16 v[96:99], v[184:187], a[252:255], v[96:99]
ds_read_b64_tr_b16 v[178:179], v219 offset:37376
v_mul_f32 v101, v101, v235
v_mfma_f32_16x16x32_bf16 v[96:99], v[180:183], a[236:239], v[96:99]
s_waitcnt lgkmcnt(4)
v_mul_f32 v233, s74, v102
v_mul_f32 v234, s74, v103
v_mfma_f32_16x16x32_bf16 v[132:135], v[164:167], a[224:227], v[132:135]
ds_read_b64_tr_b16 v[180:181], v216 offset:40960
v_mul_f32 v235, s74, v104
v_mfma_f32_16x16x32_bf16 v[132:135], v[168:171], a[240:243], v[132:135]
v_exp_f32 v233, v233
v_mfma_f32_16x16x32_bf16 v[136:139], v[168:171], a[244:247], v[136:139]
ds_read_b64_tr_b16 v[182:183], v216 offset:41472
v_add_f32 v233, 1.0, v233
v_mfma_f32_16x16x32_bf16 v[136:139], v[164:167], a[228:231], v[136:139]
v_rcp_f32 v233, v233
v_mfma_f32_16x16x32_bf16 v[140:143], v[164:167], a[232:235], v[140:143]
ds_read_b64_tr_b16 v[184:185], v216 offset:45056
v_mul_f32 v102, v102, v233
v_mfma_f32_16x16x32_bf16 v[140:143], v[168:171], a[248:251], v[140:143]
v_exp_f32 v234, v234
v_mfma_f32_16x16x32_bf16 v[144:147], v[168:171], a[252:255], v[144:147]
ds_read_b64_tr_b16 v[186:187], v216 offset:45568
v_add_f32 v234, 1.0, v234
v_mfma_f32_16x16x32_bf16 v[144:147], v[164:167], a[236:239], v[144:147]
s_waitcnt lgkmcnt(4)
v_rcp_f32 v234, v234
v_mfma_f32_16x16x32_bf16 v[148:151], v[172:175], a[224:227], v[148:151]
ds_read_b64_tr_b16 v[164:165], v217 offset:40960
v_mul_f32 v103, v103, v234
v_mfma_f32_16x16x32_bf16 v[148:151], v[176:179], a[240:243], v[148:151]
v_exp_f32 v235, v235
v_mfma_f32_16x16x32_bf16 v[152:155], v[176:179], a[244:247], v[152:155]
ds_read_b64_tr_b16 v[166:167], v217 offset:41472
v_add_f32 v235, 1.0, v235
v_mfma_f32_16x16x32_bf16 v[152:155], v[172:175], a[228:231], v[152:155]
v_rcp_f32 v235, v235
v_mfma_f32_16x16x32_bf16 v[156:159], v[172:175], a[232:235], v[156:159]
ds_read_b64_tr_b16 v[168:169], v217 offset:45056
v_mul_f32 v104, v104, v235
v_mfma_f32_16x16x32_bf16 v[156:159], v[176:179], a[248:251], v[156:159]
v_mul_f32 v233, s74, v105
v_mul_f32 v234, s74, v106
v_mfma_f32_16x16x32_bf16 v[160:163], v[176:179], a[252:255], v[160:163]
ds_read_b64_tr_b16 v[170:171], v217 offset:45568
v_mul_f32 v235, s74, v107
v_mfma_f32_16x16x32_bf16 v[160:163], v[172:175], a[236:239], v[160:163]
s_waitcnt lgkmcnt(4)
v_exp_f32 v233, v233
v_mfma_f32_16x16x32_bf16 v[68:71], v[180:183], v[4:7], v[68:71]
ds_read_b64_tr_b16 v[172:173], v218 offset:40960
v_add_f32 v233, 1.0, v233
v_mfma_f32_16x16x32_bf16 v[68:71], v[184:187], v[20:23], v[68:71]
v_rcp_f32 v233, v233
v_mfma_f32_16x16x32_bf16 v[72:75], v[184:187], v[24:27], v[72:75]
ds_read_b64_tr_b16 v[174:175], v218 offset:41472
v_mul_f32 v105, v105, v233
v_mfma_f32_16x16x32_bf16 v[72:75], v[180:183], v[8:11], v[72:75]
v_exp_f32 v234, v234
v_mfma_f32_16x16x32_bf16 v[76:79], v[180:183], v[12:15], v[76:79]
ds_read_b64_tr_b16 v[176:177], v218 offset:45056
v_mul_f32 v36, v36, v68
v_mfma_f32_16x16x32_bf16 v[76:79], v[184:187], v[28:31], v[76:79]
buffer_load_dword v212, v215, s[20:23], s72 offen sc1
v_mfma_f32_16x16x32_bf16 v[80:83], v[184:187], v[32:35], v[80:83]
ds_read_b64_tr_b16 v[178:179], v218 offset:45568
v_mul_f32 v37, v37, v69
v_mfma_f32_16x16x32_bf16 v[80:83], v[180:183], v[16:19], v[80:83]
s_waitcnt lgkmcnt(4)
v_exp_f32 v235, v235
v_mfma_f32_16x16x32_bf16 v[84:87], v[164:167], v[4:7], v[84:87]
ds_read_b64_tr_b16 v[180:181], v219 offset:40960
v_mul_f32 v38, v38, v70
v_mfma_f32_16x16x32_bf16 v[84:87], v[168:171], v[20:23], v[84:87]
ds_read_b64_tr_b16 v[182:183], v219 offset:41472
v_mul_f32 v39, v39, v71
v_mfma_f32_16x16x32_bf16 v[88:91], v[168:171], v[24:27], v[88:91]
ds_read_b64_tr_b16 v[184:185], v219 offset:45056
v_cvt_pk_bf16_f32 v68, v36, v37
v_mfma_f32_16x16x32_bf16 v[88:91], v[164:167], v[8:11], v[88:91]
ds_read_b64_tr_b16 v[186:187], v219 offset:45568
v_cvt_pk_bf16_f32 v69, v38, v39
v_mfma_f32_16x16x32_bf16 v[92:95], v[164:167], v[12:15], v[92:95]
v_mul_f32 v40, v40, v72
v_mul_f32 v41, v41, v73
v_mfma_f32_16x16x32_bf16 v[92:95], v[168:171], v[28:31], v[92:95]
v_mul_f32 v42, v42, v74
v_mul_f32 v43, v43, v75
v_mfma_f32_16x16x32_bf16 v[96:99], v[168:171], v[32:35], v[96:99]
v_cvt_pk_bf16_f32 v72, v40, v41
v_cvt_pk_bf16_f32 v73, v42, v43
v_mfma_f32_16x16x32_bf16 v[96:99], v[164:167], v[16:19], v[96:99]
s_waitcnt vmcnt(5) lgkmcnt(0)
s_barrier
v_mfma_f32_16x16x32_bf16 v[132:135], v[172:175], v[4:7], v[132:135]
ds_read_b64_tr_b16 v[164:165], v220 offset:0
v_mul_f32 v44, v44, v76
v_mfma_f32_16x16x32_bf16 v[132:135], v[176:179], v[20:23], v[132:135]
v_mul_f32 v45, v45, v77
v_mul_f32 v46, v46, v78
v_mfma_f32_16x16x32_bf16 v[136:139], v[176:179], v[24:27], v[136:139]
ds_read_b64_tr_b16 v[166:167], v220 offset:256
v_mul_f32 v47, v47, v79
v_mfma_f32_16x16x32_bf16 v[136:139], v[172:175], v[8:11], v[136:139]
v_cvt_pk_bf16_f32 v76, v44, v45
v_cvt_pk_bf16_f32 v77, v46, v47
v_mfma_f32_16x16x32_bf16 v[140:143], v[172:175], v[12:15], v[140:143]
ds_read_b64_tr_b16 v[168:169], v220 offset:1024
v_mul_f32 v48, v48, v80
v_mfma_f32_16x16x32_bf16 v[140:143], v[176:179], v[28:31], v[140:143]
v_mul_f32 v49, v49, v81
v_mul_f32 v50, v50, v82
v_mfma_f32_16x16x32_bf16 v[144:147], v[176:179], v[32:35], v[144:147]
ds_read_b64_tr_b16 v[170:171], v220 offset:1280
v_mul_f32 v51, v51, v83
v_mfma_f32_16x16x32_bf16 v[144:147], v[172:175], v[16:19], v[144:147]
v_cvt_pk_bf16_f32 v80, v48, v49
v_cvt_pk_bf16_f32 v81, v50, v51
v_mfma_f32_16x16x32_bf16 v[148:151], v[180:183], v[4:7], v[148:151]
ds_read_b64_tr_b16 v[172:173], v220 offset:2048
v_mul_f32 v52, v52, v84
v_mfma_f32_16x16x32_bf16 v[148:151], v[184:187], v[20:23], v[148:151]
v_mul_f32 v53, v53, v85
v_mul_f32 v54, v54, v86
v_mfma_f32_16x16x32_bf16 v[152:155], v[184:187], v[24:27], v[152:155]
ds_read_b64_tr_b16 v[174:175], v220 offset:2304
v_mul_f32 v55, v55, v87
v_mfma_f32_16x16x32_bf16 v[152:155], v[180:183], v[8:11], v[152:155]
v_cvt_pk_bf16_f32 v70, v52, v53
v_cvt_pk_bf16_f32 v71, v54, v55
v_mfma_f32_16x16x32_bf16 v[156:159], v[180:183], v[12:15], v[156:159]
ds_read_b64_tr_b16 v[176:177], v220 offset:3072
v_mul_f32 v56, v56, v88
v_mfma_f32_16x16x32_bf16 v[156:159], v[184:187], v[28:31], v[156:159]
buffer_store_dwordx4 v[68:71], v228, s[20:23], s48 offen offset:2048 sc1
v_mfma_f32_16x16x32_bf16 v[160:163], v[184:187], v[32:35], v[160:163]
ds_read_b64_tr_b16 v[178:179], v220 offset:3328
v_mul_f32 v57, v57, v89
v_mfma_f32_16x16x32_bf16 v[160:163], v[180:183], v[16:19], v[160:163]
s_waitcnt lgkmcnt(4)
v_mul_f32 v58, v58, v90
v_mul_f32 v59, v59, v91
v_mfma_f32_16x16x32_bf16 v[36:39], v[164:167], a[0:3], 0
ds_read_b64_tr_b16 v[180:181], v220 offset:4096
v_cvt_pk_bf16_f32 v74, v56, v57
v_mfma_f32_16x16x32_bf16 v[36:39], v[168:171], a[16:19], v[36:39]
v_cvt_pk_bf16_f32 v75, v58, v59
v_mul_f32 v60, v60, v92
v_mfma_f32_16x16x32_bf16 v[40:43], v[168:171], a[20:23], 0
ds_read_b64_tr_b16 v[182:183], v220 offset:4352
v_mul_f32 v61, v61, v93
v_mfma_f32_16x16x32_bf16 v[40:43], v[164:167], a[4:7], v[40:43]
buffer_store_dwordx4 v[72:75], v228, s[20:23], s49 offen offset:2048 sc1
v_mfma_f32_16x16x32_bf16 v[44:47], v[164:167], a[8:11], 0
ds_read_b64_tr_b16 v[184:185], v220 offset:5120
v_mul_f32 v62, v62, v94
v_mfma_f32_16x16x32_bf16 v[44:47], v[168:171], a[24:27], v[44:47]
v_mul_f32 v63, v63, v95
v_cvt_pk_bf16_f32 v78, v60, v61
v_mfma_f32_16x16x32_bf16 v[48:51], v[168:171], a[28:31], 0
ds_read_b64_tr_b16 v[186:187], v220 offset:5376
v_cvt_pk_bf16_f32 v79, v62, v63
v_mfma_f32_16x16x32_bf16 v[48:51], v[164:167], a[12:15], v[48:51]
s_waitcnt lgkmcnt(4)
buffer_store_dwordx4 v[76:79], v228, s[20:23], s50 offen offset:2048 sc1
v_mfma_f32_16x16x32_bf16 v[36:39], v[172:175], a[32:35], v[36:39]
ds_read_b64_tr_b16 v[164:165], v220 offset:6144
v_mul_f32 v64, v64, v96
v_mfma_f32_16x16x32_bf16 v[36:39], v[176:179], a[48:51], v[36:39]
v_mul_f32 v65, v65, v97
v_mul_f32 v66, v66, v98
v_mfma_f32_16x16x32_bf16 v[40:43], v[176:179], a[52:55], v[40:43]
s_and_b32 s70, s3, 1
ds_read_b64_tr_b16 v[166:167], v220 offset:6400
v_mul_f32 v67, v67, v99
v_mfma_f32_16x16x32_bf16 v[40:43], v[172:175], a[36:39], v[40:43]
s_add_u32 s69, s70, 0
v_cvt_pk_bf16_f32 v82, v64, v65
v_cvt_pk_bf16_f32 v83, v66, v67
v_mfma_f32_16x16x32_bf16 v[44:47], v[172:175], a[40:43], v[44:47]
s_lshl_b32 s69, s69, 5
ds_read_b64_tr_b16 v[168:169], v220 offset:7168
v_add_f32 v234, 1.0, v234
v_mfma_f32_16x16x32_bf16 v[44:47], v[176:179], a[56:59], v[44:47]
s_xor_b32 s69, s69, s83
buffer_store_dwordx4 v[80:83], v228, s[20:23], s51 offen offset:2048 sc1
v_mfma_f32_16x16x32_bf16 v[48:51], v[176:179], a[60:63], v[48:51]
s_mul_i32 s69, s69, 1152
ds_read_b64_tr_b16 v[170:171], v220 offset:7424
v_add_f32 v235, 1.0, v235
v_mfma_f32_16x16x32_bf16 v[48:51], v[172:175], a[44:47], v[48:51]
s_waitcnt lgkmcnt(4)
v_rcp_f32 v234, v234
v_mfma_f32_16x16x32_bf16 v[36:39], v[180:183], a[64:67], v[36:39]
s_add_u32 s69, s69, s31
ds_read_b64_tr_b16 v[172:173], v220 offset:8192
v_mul_f32 v106, v106, v234
v_mfma_f32_16x16x32_bf16 v[36:39], v[184:187], a[80:83], v[36:39]
s_add_u32 m0, s35, 143360
v_rcp_f32 v235, v235
v_mfma_f32_16x16x32_bf16 v[40:43], v[184:187], a[84:87], v[40:43]
s_and_b32 s70, s3, 1
ds_read_b64_tr_b16 v[174:175], v220 offset:8448
v_mul_f32 v107, v107, v235
v_mfma_f32_16x16x32_bf16 v[40:43], v[180:183], a[68:71], v[40:43]
buffer_load_dwordx4 v239, s[16:19], s69 offen offset:0 lds
v_mfma_f32_16x16x32_bf16 v[44:47], v[180:183], a[72:75], v[44:47]
s_add_u32 s69, s70, 2
ds_read_b64_tr_b16 v[176:177], v220 offset:9216
v_mul_f32 v233, s74, v108
v_mfma_f32_16x16x32_bf16 v[44:47], v[184:187], a[88:91], v[44:47]
s_lshl_b32 s69, s69, 5
v_exp_f32 v233, v233
v_mfma_f32_16x16x32_bf16 v[48:51], v[184:187], a[92:95], v[48:51]
s_xor_b32 s69, s69, s83
ds_read_b64_tr_b16 v[178:179], v220 offset:9472
v_add_f32 v233, 1.0, v233
v_mfma_f32_16x16x32_bf16 v[48:51], v[180:183], a[76:79], v[48:51]
s_waitcnt lgkmcnt(4)
v_rcp_f32 v233, v233
v_mfma_f32_16x16x32_bf16 v[36:39], v[164:167], a[96:99], v[36:39]
s_mul_i32 s69, s69, 1152
ds_read_b64_tr_b16 v[180:181], v220 offset:10240
v_mul_f32 v108, v108, v233
v_mfma_f32_16x16x32_bf16 v[36:39], v[168:171], a[112:115], v[36:39]
s_add_u32 s69, s69, s31
v_mul_f32 v234, s74, v109
v_mul_f32 v235, s74, v110
v_mfma_f32_16x16x32_bf16 v[40:43], v[168:171], a[116:119], v[40:43]
s_add_u32 m0, s35, 145408
ds_read_b64_tr_b16 v[182:183], v220 offset:10496
v_mul_f32 v233, s74, v111
v_mfma_f32_16x16x32_bf16 v[40:43], v[164:167], a[100:103], v[40:43]
s_and_b32 s70, s3, 1
v_exp_f32 v234, v234
v_mfma_f32_16x16x32_bf16 v[44:47], v[164:167], a[104:107], v[44:47]
ds_read_b64_tr_b16 v[184:185], v220 offset:11264
v_add_f32 v234, 1.0, v234
v_mfma_f32_16x16x32_bf16 v[44:47], v[168:171], a[120:123], v[44:47]
v_rcp_f32 v234, v234
v_mfma_f32_16x16x32_bf16 v[48:51], v[168:171], a[124:127], v[48:51]
ds_read_b64_tr_b16 v[186:187], v220 offset:11520
v_mul_f32 v109, v109, v234
v_mfma_f32_16x16x32_bf16 v[48:51], v[164:167], a[108:111], v[48:51]
s_waitcnt lgkmcnt(4)
v_exp_f32 v235, v235
v_mfma_f32_16x16x32_bf16 v[36:39], v[172:175], a[128:131], v[36:39]
ds_read_b64_tr_b16 v[164:165], v220 offset:12288
v_add_f32 v235, 1.0, v235
v_mfma_f32_16x16x32_bf16 v[36:39], v[176:179], a[144:147], v[36:39]
v_rcp_f32 v235, v235
v_mfma_f32_16x16x32_bf16 v[40:43], v[176:179], a[148:151], v[40:43]
ds_read_b64_tr_b16 v[166:167], v220 offset:12544
v_mul_f32 v110, v110, v235
v_mfma_f32_16x16x32_bf16 v[40:43], v[172:175], a[132:135], v[40:43]
v_exp_f32 v233, v233
v_mfma_f32_16x16x32_bf16 v[44:47], v[172:175], a[136:139], v[44:47]
ds_read_b64_tr_b16 v[168:169], v220 offset:13312
v_add_f32 v233, 1.0, v233
v_mfma_f32_16x16x32_bf16 v[44:47], v[176:179], a[152:155], v[44:47]
v_rcp_f32 v233, v233
v_mfma_f32_16x16x32_bf16 v[48:51], v[176:179], a[156:159], v[48:51]
ds_read_b64_tr_b16 v[170:171], v220 offset:13568
v_mul_f32 v111, v111, v233
v_mfma_f32_16x16x32_bf16 v[48:51], v[172:175], a[140:143], v[48:51]
s_waitcnt lgkmcnt(4)
v_mul_f32 v234, s74, v112
v_mul_f32 v235, s74, v113
v_mfma_f32_16x16x32_bf16 v[36:39], v[180:183], a[160:163], v[36:39]
ds_read_b64_tr_b16 v[172:173], v220 offset:14336
v_mul_f32 v233, s74, v114
v_mfma_f32_16x16x32_bf16 v[36:39], v[184:187], a[176:179], v[36:39]
v_exp_f32 v234, v234
v_mfma_f32_16x16x32_bf16 v[40:43], v[184:187], a[180:183], v[40:43]
ds_read_b64_tr_b16 v[174:175], v220 offset:14592
v_add_f32 v234, 1.0, v234
v_mfma_f32_16x16x32_bf16 v[40:43], v[180:183], a[164:167], v[40:43]
buffer_load_dwordx4 v239, s[16:19], s69 offen offset:0 lds
v_mfma_f32_16x16x32_bf16 v[44:47], v[180:183], a[168:171], v[44:47]
s_add_u32 s69, s70, 4
ds_read_b64_tr_b16 v[176:177], v220 offset:15360
v_mul_f32 v116, v116, v132
v_mfma_f32_16x16x32_bf16 v[44:47], v[184:187], a[184:187], v[44:47]
s_lshl_b32 s69, s69, 5
v_rcp_f32 v234, v234
v_mfma_f32_16x16x32_bf16 v[48:51], v[184:187], a[188:191], v[48:51]
s_xor_b32 s69, s69, s83
ds_read_b64_tr_b16 v[178:179], v220 offset:15616
v_mul_f32 v112, v112, v234
v_mfma_f32_16x16x32_bf16 v[48:51], v[180:183], a[172:175], v[48:51]
s_waitcnt lgkmcnt(4)
v_exp_f32 v235, v235
v_mfma_f32_16x16x32_bf16 v[36:39], v[164:167], a[192:195], v[36:39]
s_mul_i32 s69, s69, 1152
ds_read_b64_tr_b16 v[180:181], v220 offset:16384
v_add_f32 v235, 1.0, v235
v_mfma_f32_16x16x32_bf16 v[36:39], v[168:171], a[208:211], v[36:39]
s_add_u32 s69, s69, s31
v_rcp_f32 v235, v235
v_mfma_f32_16x16x32_bf16 v[40:43], v[168:171], a[212:215], v[40:43]
s_add_u32 m0, s35, 147456
ds_read_b64_tr_b16 v[182:183], v220 offset:16640
v_mul_f32 v113, v113, v235
v_mfma_f32_16x16x32_bf16 v[40:43], v[164:167], a[196:199], v[40:43]
s_and_b32 s70, s3, 1
v_exp_f32 v233, v233
v_mfma_f32_16x16x32_bf16 v[44:47], v[164:167], a[200:203], v[44:47]
ds_read_b64_tr_b16 v[184:185], v220 offset:17408
v_add_f32 v233, 1.0, v233
v_mfma_f32_16x16x32_bf16 v[44:47], v[168:171], a[216:219], v[44:47]
v_rcp_f32 v233, v233
v_mfma_f32_16x16x32_bf16 v[48:51], v[168:171], a[220:223], v[48:51]
ds_read_b64_tr_b16 v[186:187], v220 offset:17664
v_mul_f32 v114, v114, v233
v_mfma_f32_16x16x32_bf16 v[48:51], v[164:167], a[204:207], v[48:51]
s_waitcnt lgkmcnt(4)
v_mul_f32 v234, s74, v115
v_mul_f32 v117, v117, v133
v_mfma_f32_16x16x32_bf16 v[36:39], v[172:175], a[224:227], v[36:39]
ds_read_b64_tr_b16 v[164:165], v220 offset:24576
v_mul_f32 v118, v118, v134
v_mfma_f32_16x16x32_bf16 v[36:39], v[176:179], a[240:243], v[36:39]
v_exp_f32 v234, v234
v_mfma_f32_16x16x32_bf16 v[40:43], v[176:179], a[244:247], v[40:43]
ds_read_b64_tr_b16 v[166:167], v220 offset:24832
v_add_f32 v234, 1.0, v234
v_mfma_f32_16x16x32_bf16 v[40:43], v[172:175], a[228:231], v[40:43]
v_rcp_f32 v234, v234
v_mfma_f32_16x16x32_bf16 v[44:47], v[172:175], a[232:235], v[44:47]
ds_read_b64_tr_b16 v[168:169], v220 offset:25600
v_mul_f32 v115, v115, v234
v_mfma_f32_16x16x32_bf16 v[44:47], v[176:179], a[248:251], v[44:47]
v_mul_f32 v119, v119, v135
v_cvt_pk_bf16_f32 v132, v116, v117
v_mfma_f32_16x16x32_bf16 v[48:51], v[176:179], a[252:255], v[48:51]
ds_read_b64_tr_b16 v[170:171], v220 offset:25856
v_cvt_pk_bf16_f32 v133, v118, v119
v_mfma_f32_16x16x32_bf16 v[48:51], v[172:175], a[236:239], v[48:51]
s_waitcnt lgkmcnt(4)
v_mul_f32 v120, v120, v136
v_mul_f32 v121, v121, v137
v_mfma_f32_16x16x32_bf16 v[36:39], v[180:183], v[4:7], v[36:39]
ds_read_b64_tr_b16 v[172:173], v220 offset:26624
v_mul_f32 v122, v122, v138
v_mfma_f32_16x16x32_bf16 v[36:39], v[184:187], v[20:23], v[36:39]
v_mul_f32 v123, v123, v139
v_cvt_pk_bf16_f32 v136, v120, v121
v_mfma_f32_16x16x32_bf16 v[40:43], v[184:187], v[24:27], v[40:43]
ds_read_b64_tr_b16 v[174:175], v220 offset:26880
v_cvt_pk_bf16_f32 v137, v122, v123
v_mfma_f32_16x16x32_bf16 v[40:43], v[180:183], v[8:11], v[40:43]
buffer_load_dwordx4 v239, s[16:19], s69 offen offset:0 lds
v_mfma_f32_16x16x32_bf16 v[44:47], v[180:183], v[12:15], v[44:47]
s_add_u32 s69, s70, 6
ds_read_b64_tr_b16 v[176:177], v220 offset:27648
v_mul_f32 v124, v124, v140
v_mfma_f32_16x16x32_bf16 v[44:47], v[184:187], v[28:31], v[44:47]
s_lshl_b32 s69, s69, 5
v_mul_f32 v125, v125, v141
v_mul_f32 v126, v126, v142
v_mfma_f32_16x16x32_bf16 v[48:51], v[184:187], v[32:35], v[48:51]
s_xor_b32 s69, s69, s83
ds_read_b64_tr_b16 v[178:179], v220 offset:27904
v_mul_f32 v127, v127, v143
v_mfma_f32_16x16x32_bf16 v[48:51], v[180:183], v[16:19], v[48:51]
s_waitcnt lgkmcnt(4)
v_cvt_pk_bf16_f32 v140, v124, v125
v_cvt_pk_bf16_f32 v141, v126, v127
v_mfma_f32_16x16x32_bf16 v[52:55], v[164:167], a[0:3], 0
s_mul_i32 s69, s69, 1152
ds_read_b64_tr_b16 v[180:181], v220 offset:28672
v_mul_f32 v128, v128, v144
v_mfma_f32_16x16x32_bf16 v[52:55], v[168:171], a[16:19], v[52:55]
s_add_u32 s69, s69, s31
v_mul_f32 v129, v129, v145
v_mul_f32 v130, v130, v146
v_mfma_f32_16x16x32_bf16 v[56:59], v[168:171], a[20:23], 0
s_add_u32 m0, s35, 149504
ds_read_b64_tr_b16 v[182:183], v220 offset:28928
v_mul_f32 v131, v131, v147
v_mfma_f32_16x16x32_bf16 v[56:59], v[164:167], a[4:7], v[56:59]
s_and_b32 s70, s3, 1
v_cvt_pk_bf16_f32 v144, v128, v129
v_cvt_pk_bf16_f32 v145, v130, v131
v_mfma_f32_16x16x32_bf16 v[60:63], v[164:167], a[8:11], 0
ds_read_b64_tr_b16 v[184:185], v220 offset:29696
v_mul_f32 v100, v100, v148
v_mfma_f32_16x16x32_bf16 v[60:63], v[168:171], a[24:27], v[60:63]
v_mul_f32 v101, v101, v149
v_mul_f32 v102, v102, v150
v_mfma_f32_16x16x32_bf16 v[64:67], v[168:171], a[28:31], 0
ds_read_b64_tr_b16 v[186:187], v220 offset:29952
v_mul_f32 v103, v103, v151
v_mfma_f32_16x16x32_bf16 v[64:67], v[164:167], a[12:15], v[64:67]
s_waitcnt lgkmcnt(4)
v_cvt_pk_bf16_f32 v134, v100, v101
v_cvt_pk_bf16_f32 v135, v102, v103
v_mfma_f32_16x16x32_bf16 v[52:55], v[172:175], a[32:35], v[52:55]
ds_read_b64_tr_b16 v[164:165], v220 offset:30720
v_mul_f32 v104, v104, v152
v_mfma_f32_16x16x32_bf16 v[52:55], v[176:179], a[48:51], v[52:55]
buffer_store_dwordx4 v[132:135], v228, s[20:23], s48 offen offset:3072 sc1
v_mfma_f32_16x16x32_bf16 v[56:59], v[176:179], a[52:55], v[56:59]
ds_read_b64_tr_b16 v[166:167], v220 offset:30976
v_mul_f32 v105, v105, v153
v_mfma_f32_16x16x32_bf16 v[56:59], v[172:175], a[36:39], v[56:59]
v_mul_f32 v106, v106, v154
v_mul_f32 v107, v107, v155
v_mfma_f32_16x16x32_bf16 v[60:63], v[172:175], a[40:43], v[60:63]
ds_read_b64_tr_b16 v[168:169], v220 offset:31744
v_cvt_pk_bf16_f32 v138, v104, v105
v_mfma_f32_16x16x32_bf16 v[60:63], v[176:179], a[56:59], v[60:63]
v_cvt_pk_bf16_f32 v139, v106, v107
v_mul_f32 v108, v108, v156
v_mfma_f32_16x16x32_bf16 v[64:67], v[176:179], a[60:63], v[64:67]
ds_read_b64_tr_b16 v[170:171], v220 offset:32000
v_mul_f32 v109, v109, v157
v_mfma_f32_16x16x32_bf16 v[64:67], v[172:175], a[44:47], v[64:67]
s_waitcnt lgkmcnt(4)
buffer_store_dwordx4 v[136:139], v228, s[20:23], s49 offen offset:3072 sc1
v_mfma_f32_16x16x32_bf16 v[52:55], v[180:183], a[64:67], v[52:55]
ds_read_b64_tr_b16 v[172:173], v220 offset:32768
v_mul_f32 v110, v110, v158
v_mfma_f32_16x16x32_bf16 v[52:55], v[184:187], a[80:83], v[52:55]
v_mul_f32 v111, v111, v159
v_cvt_pk_bf16_f32 v142, v108, v109
v_mfma_f32_16x16x32_bf16 v[56:59], v[184:187], a[84:87], v[56:59]
ds_read_b64_tr_b16 v[174:175], v220 offset:33024
v_cvt_pk_bf16_f32 v143, v110, v111
v_mfma_f32_16x16x32_bf16 v[56:59], v[180:183], a[68:71], v[56:59]
buffer_load_dwordx4 v239, s[16:19], s69 offen offset:0 lds
v_mfma_f32_16x16x32_bf16 v[60:63], v[180:183], a[72:75], v[60:63]
s_add_u32 s69, s70, 8
ds_read_b64_tr_b16 v[176:177], v220 offset:33792
v_mul_f32 v112, v112, v160
v_mfma_f32_16x16x32_bf16 v[60:63], v[184:187], a[88:91], v[60:63]
s_lshl_b32 s69, s69, 5
buffer_store_dwordx4 v[140:143], v228, s[20:23], s50 offen offset:3072 sc1
v_mfma_f32_16x16x32_bf16 v[64:67], v[184:187], a[92:95], v[64:67]
s_xor_b32 s69, s69, s83
ds_read_b64_tr_b16 v[178:179], v220 offset:34048
v_mul_f32 v113, v113, v161
v_mfma_f32_16x16x32_bf16 v[64:67], v[180:183], a[76:79], v[64:67]
s_waitcnt lgkmcnt(4)
v_mul_f32 v114, v114, v162
v_mul_f32 v115, v115, v163
v_mfma_f32_16x16x32_bf16 v[52:55], v[164:167], a[96:99], v[52:55]
s_mul_i32 s69, s69, 1152
ds_read_b64_tr_b16 v[180:181], v220 offset:34816
v_cvt_pk_bf16_f32 v146, v112, v113
v_mfma_f32_16x16x32_bf16 v[52:55], v[168:171], a[112:115], v[52:55]
s_add_u32 s69, s69, s31
v_cvt_pk_bf16_f32 v147, v114, v115
v_mul_f32 v254, s74, v36
v_mfma_f32_16x16x32_bf16 v[56:59], v[168:171], a[116:119], v[56:59]
s_lshl_b32 s70, s70, 28
ds_read_b64_tr_b16 v[182:183], v220 offset:35072
v_mul_f32 v252, s74, v37
v_mfma_f32_16x16x32_bf16 v[56:59], v[164:167], a[100:103], v[56:59]
s_add_u32 s69, s69, s70
buffer_store_dwordx4 v[144:147], v228, s[20:23], s51 offen offset:3072 sc1
v_mfma_f32_16x16x32_bf16 v[60:63], v[164:167], a[104:107], v[60:63]
s_add_u32 m0, s35, 151552
ds_read_b64_tr_b16 v[184:185], v220 offset:35840
v_mul_f32 v253, s74, v38
v_mfma_f32_16x16x32_bf16 v[60:63], v[168:171], a[120:123], v[60:63]
v_exp_f32 v254, v254
v_mfma_f32_16x16x32_bf16 v[64:67], v[168:171], a[124:127], v[64:67]
ds_read_b64_tr_b16 v[186:187], v220 offset:36096
v_add_f32 v254, 1.0, v254
v_mfma_f32_16x16x32_bf16 v[64:67], v[164:167], a[108:111], v[64:67]
s_waitcnt lgkmcnt(4)
v_rcp_f32 v254, v254
v_mfma_f32_16x16x32_bf16 v[52:55], v[172:175], a[128:131], v[52:55]
ds_read_b64_tr_b16 v[164:165], v220 offset:36864
v_mul_f32 v36, v36, v254
v_mfma_f32_16x16x32_bf16 v[52:55], v[176:179], a[144:147], v[52:55]
v_exp_f32 v252, v252
v_mfma_f32_16x16x32_bf16 v[56:59], v[176:179], a[148:151], v[56:59]
ds_read_b64_tr_b16 v[166:167], v220 offset:37120
v_add_f32 v252, 1.0, v252
v_mfma_f32_16x16x32_bf16 v[56:59], v[172:175], a[132:135], v[56:59]
v_rcp_f32 v252, v252
v_mfma_f32_16x16x32_bf16 v[60:63], v[172:175], a[136:139], v[60:63]
ds_read_b64_tr_b16 v[168:169], v220 offset:37888
v_mul_f32 v37, v37, v252
v_mfma_f32_16x16x32_bf16 v[60:63], v[176:179], a[152:155], v[60:63]
v_exp_f32 v253, v253
v_mfma_f32_16x16x32_bf16 v[64:67], v[176:179], a[156:159], v[64:67]
ds_read_b64_tr_b16 v[170:171], v220 offset:38144
v_add_f32 v253, 1.0, v253
v_mfma_f32_16x16x32_bf16 v[64:67], v[172:175], a[140:143], v[64:67]
s_waitcnt lgkmcnt(4)
v_rcp_f32 v253, v253
v_mfma_f32_16x16x32_bf16 v[52:55], v[180:183], a[160:163], v[52:55]
ds_read_b64_tr_b16 v[172:173], v220 offset:38912
v_mul_f32 v38, v38, v253
v_mfma_f32_16x16x32_bf16 v[52:55], v[184:187], a[176:179], v[52:55]
v_mul_f32 v254, s74, v39
v_mul_f32 v252, s74, v40
v_mfma_f32_16x16x32_bf16 v[56:59], v[184:187], a[180:183], v[56:59]
ds_read_b64_tr_b16 v[174:175], v220 offset:39168
v_mul_f32 v253, s74, v41
v_mfma_f32_16x16x32_bf16 v[56:59], v[180:183], a[164:167], v[56:59]
buffer_load_dwordx4 v239, s[16:19], s69 offen offset:0 lds
v_mfma_f32_16x16x32_bf16 v[60:63], v[180:183], a[168:171], v[60:63]
ds_read_b64_tr_b16 v[176:177], v220 offset:39936
v_mfma_f32_16x16x32_bf16 v[60:63], v[184:187], a[184:187], v[60:63]
v_exp_f32 v254, v254
v_mfma_f32_16x16x32_bf16 v[64:67], v[184:187], a[188:191], v[64:67]
ds_read_b64_tr_b16 v[178:179], v220 offset:40192
v_add_f32 v254, 1.0, v254
v_mfma_f32_16x16x32_bf16 v[64:67], v[180:183], a[172:175], v[64:67]
s_waitcnt lgkmcnt(4)
v_rcp_f32 v254, v254
v_mfma_f32_16x16x32_bf16 v[52:55], v[164:167], a[192:195], v[52:55]
ds_read_b64_tr_b16 v[180:181], v220 offset:40960
v_mul_f32 v39, v39, v254
v_mfma_f32_16x16x32_bf16 v[52:55], v[168:171], a[208:211], v[52:55]
ds_read_b64_tr_b16 v[182:183], v220 offset:41216
v_mul_f32 v254, s74, v42
v_mfma_f32_16x16x32_bf16 v[56:59], v[168:171], a[212:215], v[56:59]
ds_read_b64_tr_b16 v[184:185], v220 offset:41984
v_mfma_f32_16x16x32_bf16 v[56:59], v[164:167], a[196:199], v[56:59]
ds_read_b64_tr_b16 v[186:187], v220 offset:42240
v_mfma_f32_16x16x32_bf16 v[60:63], v[164:167], a[200:203], v[60:63]
v_exp_f32 v252, v252
v_mfma_f32_16x16x32_bf16 v[60:63], v[168:171], a[216:219], v[60:63]
v_exp_f32 v253, v253
v_mfma_f32_16x16x32_bf16 v[64:67], v[168:171], a[220:223], v[64:67]
v_exp_f32 v254, v254
v_mfma_f32_16x16x32_bf16 v[64:67], v[164:167], a[204:207], v[64:67]
s_waitcnt lgkmcnt(4)
v_add_f32 v252, 1.0, v252
v_add_f32 v253, 1.0, v253
v_mfma_f32_16x16x32_bf16 v[52:55], v[172:175], a[224:227], v[52:55]
v_rcp_f32 v252, v252
v_mfma_f32_16x16x32_bf16 v[52:55], v[176:179], a[240:243], v[52:55]
v_rcp_f32 v253, v253
v_mfma_f32_16x16x32_bf16 v[56:59], v[176:179], a[244:247], v[56:59]
PAD_6:
s_cmp_lg_u32 s73, 0
s_cbranch_scc1 PAD_10
v_mul_f32 v40, v40, v252
v_mul_f32 v41, v41, v253
v_mfma_f32_16x16x32_bf16 v[56:59], v[172:175], a[228:231], v[56:59]
v_add_f32 v254, 1.0, v254
v_mul_f32 v252, s74, v43
v_mfma_f32_16x16x32_bf16 v[60:63], v[172:175], a[232:235], v[60:63]
v_rcp_f32 v254, v254
v_mfma_f32_16x16x32_bf16 v[60:63], v[176:179], a[248:251], v[60:63]
s_waitcnt vmcnt(13)
v_exp_f32 v252, v252
v_mfma_f32_16x16x32_bf16 v[64:67], v[176:179], a[252:255], v[64:67]
v_cmp_gt_u32 vcc, 1, v212
v_mul_f32 v42, v42, v254
v_mfma_f32_16x16x32_bf16 v[64:67], v[172:175], a[236:239], v[64:67]
s_waitcnt lgkmcnt(0)
v_add_f32 v252, 1.0, v252
v_mul_f32 v253, s74, v44
v_mfma_f32_16x16x32_bf16 v[52:55], v[180:183], v[4:7], v[52:55]
s_cbranch_vccnz SLOW_hA
RET_hA:
v_rcp_f32 v252, v252
v_mfma_f32_16x16x32_bf16 v[52:55], v[184:187], v[20:23], v[52:55]
v_exp_f32 v253, v253
v_mfma_f32_16x16x32_bf16 v[56:59], v[184:187], v[24:27], v[56:59]
v_mul_f32 v43, v43, v252
v_add_f32 v253, 1.0, v253
v_mfma_f32_16x16x32_bf16 v[56:59], v[180:183], v[8:11], v[56:59]
v_rcp_f32 v253, v253
v_mfma_f32_16x16x32_bf16 v[60:63], v[180:183], v[12:15], v[60:63]
v_mul_f32 v44, v44, v253
v_mul_f32 v254, s74, v45
v_mfma_f32_16x16x32_bf16 v[60:63], v[184:187], v[28:31], v[60:63]
v_exp_f32 v254, v254
v_mfma_f32_16x16x32_bf16 v[64:67], v[184:187], v[32:35], v[64:67]
v_add_f32 v254, 1.0, v254
v_mul_f32 v252, s74, v46
v_mfma_f32_16x16x32_bf16 v[64:67], v[180:183], v[16:19], v[64:67]
v_rcp_f32 v254, v254
v_exp_f32 v252, v252
v_mul_f32 v45, v45, v254
v_add_f32 v252, 1.0, v252
v_rcp_f32 v252, v252
v_mul_f32 v253, s74, v47
v_mul_f32 v46, v46, v252
v_exp_f32 v253, v253
v_mul_f32 v254, s74, v48
v_add_f32 v253, 1.0, v253
v_rcp_f32 v253, v253
v_exp_f32 v254, v254
v_mul_f32 v47, v47, v253
v_add_f32 v254, 1.0, v254
v_rcp_f32 v254, v254
v_mul_f32 v252, s74, v49
v_mul_f32 v48, v48, v254
v_exp_f32 v252, v252
v_mul_f32 v253, s74, v50
v_add_f32 v252, 1.0, v252
v_rcp_f32 v252, v252
v_exp_f32 v253, v253
v_mul_f32 v49, v49, v252
v_add_f32 v253, 1.0, v253
v_rcp_f32 v253, v253
v_mul_f32 v254, s74, v51
v_mul_f32 v50, v50, v253
v_exp_f32 v254, v254
v_mul_f32 v36, v36, v52
v_add_f32 v254, 1.0, v254
v_rcp_f32 v254, v254
v_mul_f32 v37, v37, v53
v_mul_f32 v51, v51, v254
v_mul_f32 v38, v38, v54
v_mul_f32 v39, v39, v55
v_cvt_pk_bf16_f32 v52, v36, v37
v_cvt_pk_bf16_f32 v53, v38, v39
buffer_store_dwordx2 v[52:53], v229, s[20:23], s48 offen sc1
v_mul_f32 v40, v40, v56
v_mul_f32 v41, v41, v57
v_mul_f32 v42, v42, v58
v_mul_f32 v43, v43, v59
v_cvt_pk_bf16_f32 v56, v40, v41
v_cvt_pk_bf16_f32 v57, v42, v43
buffer_store_dwordx2 v[56:57], v229, s[20:23], s49 offen sc1
v_mul_f32 v44, v44, v60
v_mul_f32 v45, v45, v61
v_mul_f32 v46, v46, v62
v_mul_f32 v47, v47, v63
v_cvt_pk_bf16_f32 v60, v44, v45
v_cvt_pk_bf16_f32 v61, v46, v47
buffer_store_dwordx2 v[60:61], v229, s[20:23], s50 offen sc1
v_mul_f32 v48, v48, v64
v_mul_f32 v49, v49, v65
v_mul_f32 v50, v50, v66
v_mul_f32 v51, v51, v67
v_cvt_pk_bf16_f32 v64, v48, v49
v_cvt_pk_bf16_f32 v65, v50, v51
buffer_store_dwordx2 v[64:65], v229, s[20:23], s51 offen sc1
s_barrier
s_mov_b32 s24, s42
s_mov_b32 s25, s43
s_mov_b32 s26, 2359296
s_cmp_ge_u32 s2, 192
s_cbranch_scc1 KF_noconv_wg
v_lshlrev_b32 v2, 3, v1
s_cmp_eq_u32 s3, 1
s_cbranch_scc1 KF_p1
s_cmp_eq_u32 s3, 2
s_cbranch_scc1 KF_p2
s_cmp_eq_u32 s3, 3
s_cbranch_scc1 KF_p3
KF_p0:
v_cvt_pk_bf16_f32 v84, v188, -v189
v_cvt_pk_bf16_f32 v85, v190, -v191
v_add_u32_e64 v3, 0, v2
v_pk_mul_f32 v[40:41], v[188:189], v[192:193] op_sel:[0,0] op_sel_hi:[1,0]
v_pk_mul_f32 v[42:43], v[190:191], v[194:195] op_sel:[0,0] op_sel_hi:[1,0]
v_pk_fma_f32 v[40:41], v[188:189], v[192:193], v[40:41] op_sel:[1,1,0] op_sel_hi:[0,1,1] neg_lo:[1,0,0]
v_pk_fma_f32 v[42:43], v[190:191], v[194:195], v[42:43] op_sel:[1,1,0] op_sel_hi:[0,1,1] neg_lo:[1,0,0]
v_cvt_pk_bf16_f32 v86, v40, -v41
v_cvt_pk_bf16_f32 v87, v42, -v43
v_pk_mul_f32 v[44:45], v[40:41], v[192:193] op_sel:[0,0] op_sel_hi:[1,0]
v_pk_mul_f32 v[46:47], v[42:43], v[194:195] op_sel:[0,0] op_sel_hi:[1,0]
v_pk_fma_f32 v[44:45], v[40:41], v[192:193], v[44:45] op_sel:[1,1,0] op_sel_hi:[0,1,1] neg_lo:[1,0,0]
v_pk_fma_f32 v[46:47], v[42:43], v[194:195], v[46:47] op_sel:[1,1,0] op_sel_hi:[0,1,1] neg_lo:[1,0,0]
v_cvt_pk_bf16_f32 v88, v44, -v45
v_cvt_pk_bf16_f32 v89, v46, -v47
v_pk_mul_f32 v[40:41], v[44:45], v[192:193] op_sel:[0,0] op_sel_hi:[1,0]
v_pk_mul_f32 v[42:43], v[46:47], v[194:195] op_sel:[0,0] op_sel_hi:[1,0]
v_pk_fma_f32 v[40:41], v[44:45], v[192:193], v[40:41] op_sel:[1,1,0] op_sel_hi:[0,1,1] neg_lo:[1,0,0]
v_pk_fma_f32 v[42:43], v[46:47], v[194:195], v[42:43] op_sel:[1,1,0] op_sel_hi:[0,1,1] neg_lo:[1,0,0]
v_cvt_pk_bf16_f32 v90, v40, -v41
v_cvt_pk_bf16_f32 v91, v42, -v43
ds_write2_b64 v3, v[84:85], v[86:87] offset0:0 offset1:68
ds_write2_b64 v3, v[88:89], v[90:91] offset0:136 offset1:204
buffer_load_dwordx4 a[0:3], v242, s[20:23], s44 offen offset:0 sc1
buffer_load_dwordx4 a[4:7], v242, s[20:23], s45 offen offset:0 sc1
buffer_load_dwordx4 a[8:11], v242, s[20:23], s46 offen offset:0 sc1
v_pk_mul_f32 v[44:45], v[40:41], v[192:193] op_sel:[0,0] op_sel_hi:[1,0]
v_pk_mul_f32 v[46:47], v[42:43], v[194:195] op_sel:[0,0] op_sel_hi:[1,0]
v_pk_fma_f32 v[44:45], v[40:41], v[192:193], v[44:45] op_sel:[1,1,0] op_sel_hi:[0,1,1] neg_lo:[1,0,0]
v_pk_fma_f32 v[46:47], v[42:43], v[194:195], v[46:47] op_sel:[1,1,0] op_sel_hi:[0,1,1] neg_lo:[1,0,0]
v_cvt_pk_bf16_f32 v92, v44, -v45
v_cvt_pk_bf16_f32 v93, v46, -v47
v_add_u32 v3, 0x880, v2
v_pk_mul_f32 v[40:41], v[44:45], v[192:193] op_sel:[0,0] op_sel_hi:[1,0]
v_pk_mul_f32 v[42:43], v[46:47], v[194:195] op_sel:[0,0] op_sel_hi:[1,0]
v_pk_fma_f32 v[40:41], v[44:45], v[192:193], v[40:41] op_sel:[1,1,0] op_sel_hi:[0,1,1] neg_lo:[1,0,0]
v_pk_fma_f32 v[42:43], v[46:47], v[194:195], v[42:43] op_sel:[1,1,0] op_sel_hi:[0,1,1] neg_lo:[1,0,0]
v_cvt_pk_bf16_f32 v94, v40, -v41
v_cvt_pk_bf16_f32 v95, v42, -v43
v_pk_mul_f32 v[44:45], v[40:41], v[192:193] op_sel:[0,0] op_sel_hi:[1,0]
v_pk_mul_f32 v[46:47], v[42:43], v[194:195] op_sel:[0,0] op_sel_hi:[1,0]
v_pk_fma_f32 v[44:45], v[40:41], v[192:193], v[44:45] op_sel:[1,1,0] op_sel_hi:[0,1,1] neg_lo:[1,0,0]
v_pk_fma_f32 v[46:47], v[42:43], v[194:195], v[46:47] op_sel:[1,1,0] op_sel_hi:[0,1,1] neg_lo:[1,0,0]
v_cvt_pk_bf16_f32 v96, v44, -v45
v_cvt_pk_bf16_f32 v97, v46, -v47
v_pk_mul_f32 v[40:41], v[44:45], v[192:193] op_sel:[0,0] op_sel_hi:[1,0]
v_pk_mul_f32 v[42:43], v[46:47], v[194:195] op_sel:[0,0] op_sel_hi:[1,0]
v_pk_fma_f32 v[40:41], v[44:45], v[192:193], v[40:41] op_sel:[1,1,0] op_sel_hi:[0,1,1] neg_lo:[1,0,0]
v_pk_fma_f32 v[42:43], v[46:47], v[194:195], v[42:43] op_sel:[1,1,0] op_sel_hi:[0,1,1] neg_lo:[1,0,0]
v_cvt_pk_bf16_f32 v98, v40, -v41
v_cvt_pk_bf16_f32 v99, v42, -v43
ds_write2_b64 v3, v[92:93], v[94:95] offset0:0 offset1:68
ds_write2_b64 v3, v[96:97], v[98:99] offset0:136 offset1:204
buffer_load_dwordx4 a[12:15], v242, s[20:23], s47 offen offset:0 sc1
buffer_load_dwordx4 a[16:19], v242, s[20:23], s44 offen offset:1024 sc1
v_pk_mul_f32 v[44:45], v[40:41], v[192:193] op_sel:[0,0] op_sel_hi:[1,0]
v_pk_mul_f32 v[46:47], v[42:43], v[194:195] op_sel:[0,0] op_sel_hi:[1,0]
v_pk_fma_f32 v[44:45], v[40:41], v[192:193], v[44:45] op_sel:[1,1,0] op_sel_hi:[0,1,1] neg_lo:[1,0,0]
v_pk_fma_f32 v[46:47], v[42:43], v[194:195], v[46:47] op_sel:[1,1,0] op_sel_hi:[0,1,1] neg_lo:[1,0,0]
v_cvt_pk_bf16_f32 v84, v44, -v45
v_cvt_pk_bf16_f32 v85, v46, -v47
v_add_u32 v3, 0x1100, v2
v_pk_mul_f32 v[40:41], v[44:45], v[192:193] op_sel:[0,0] op_sel_hi:[1,0]
v_pk_mul_f32 v[42:43], v[46:47], v[194:195] op_sel:[0,0] op_sel_hi:[1,0]
v_pk_fma_f32 v[40:41], v[44:45], v[192:193], v[40:41] op_sel:[1,1,0] op_sel_hi:[0,1,1] neg_lo:[1,0,0]
v_pk_fma_f32 v[42:43], v[46:47], v[194:195], v[42:43] op_sel:[1,1,0] op_sel_hi:[0,1,1] neg_lo:[1,0,0]
v_cvt_pk_bf16_f32 v86, v40, -v41
v_cvt_pk_bf16_f32 v87, v42, -v43
v_pk_mul_f32 v[44:45], v[40:41], v[192:193] op_sel:[0,0] op_sel_hi:[1,0]
v_pk_mul_f32 v[46:47], v[42:43], v[194:195] op_sel:[0,0] op_sel_hi:[1,0]
v_pk_fma_f32 v[44:45], v[40:41], v[192:193], v[44:45] op_sel:[1,1,0] op_sel_hi:[0,1,1] neg_lo:[1,0,0]
v_pk_fma_f32 v[46:47], v[42:43], v[194:195], v[46:47] op_sel:[1,1,0] op_sel_hi:[0,1,1] neg_lo:[1,0,0]
v_cvt_pk_bf16_f32 v88, v44, -v45
v_cvt_pk_bf16_f32 v89, v46, -v47
v_pk_mul_f32 v[40:41], v[44:45], v[192:193] op_sel:[0,0] op_sel_hi:[1,0]
v_pk_mul_f32 v[42:43], v[46:47], v[194:195] op_sel:[0,0] op_sel_hi:[1,0]
v_pk_fma_f32 v[40:41], v[44:45], v[192:193], v[40:41] op_sel:[1,1,0] op_sel_hi:[0,1,1] neg_lo:[1,0,0]
v_pk_fma_f32 v[42:43], v[46:47], v[194:195], v[42:43] op_sel:[1,1,0] op_sel_hi:[0,1,1] neg_lo:[1,0,0]
v_cvt_pk_bf16_f32 v90, v40, -v41
v_cvt_pk_bf16_f32 v91, v42, -v43
ds_write2_b64 v3, v[84:85], v[86:87] offset0:0 offset1:68
ds_write2_b64 v3, v[88:89], v[90:91] offset0:136 offset1:204
buffer_load_dwordx4 a[20:23], v242, s[20:23], s45 offen offset:1024 sc1
buffer_load_dwordx4 a[24:27], v242, s[20:23], s46 offen offset:1024 sc1
v_pk_mul_f32 v[44:45], v[40:41], v[192:193] op_sel:[0,0] op_sel_hi:[1,0]
v_pk_mul_f32 v[46:47], v[42:43], v[194:195] op_sel:[0,0] op_sel_hi:[1,0]
v_pk_fma_f32 v[44:45], v[40:41], v[192:193], v[44:45] op_sel:[1,1,0] op_sel_hi:[0,1,1] neg_lo:[1,0,0]
v_pk_fma_f32 v[46:47], v[42:43], v[194:195], v[46:47] op_sel:[1,1,0] op_sel_hi:[0,1,1] neg_lo:[1,0,0]
v_cvt_pk_bf16_f32 v92, v44, -v45
v_cvt_pk_bf16_f32 v93, v46, -v47
v_add_u32 v3, 0x1980, v2
v_pk_mul_f32 v[40:41], v[44:45], v[192:193] op_sel:[0,0] op_sel_hi:[1,0]
v_pk_mul_f32 v[42:43], v[46:47], v[194:195] op_sel:[0,0] op_sel_hi:[1,0]
v_pk_fma_f32 v[40:41], v[44:45], v[192:193], v[40:41] op_sel:[1,1,0] op_sel_hi:[0,1,1] neg_lo:[1,0,0]
v_pk_fma_f32 v[42:43], v[46:47], v[194:195], v[42:43] op_sel:[1,1,0] op_sel_hi:[0,1,1] neg_lo:[1,0,0]
v_cvt_pk_bf16_f32 v94, v40, -v41
v_cvt_pk_bf16_f32 v95, v42, -v43
v_pk_mul_f32 v[44:45], v[40:41], v[192:193] op_sel:[0,0] op_sel_hi:[1,0]
v_pk_mul_f32 v[46:47], v[42:43], v[194:195] op_sel:[0,0] op_sel_hi:[1,0]
v_pk_fma_f32 v[44:45], v[40:41], v[192:193], v[44:45] op_sel:[1,1,0] op_sel_hi:[0,1,1] neg_lo:[1,0,0]
v_pk_fma_f32 v[46:47], v[42:43], v[194:195], v[46:47] op_sel:[1,1,0] op_sel_hi:[0,1,1] neg_lo:[1,0,0]
v_cvt_pk_bf16_f32 v96, v44, -v45
v_cvt_pk_bf16_f32 v97, v46, -v47
v_pk_mul_f32 v[40:41], v[44:45], v[192:193] op_sel:[0,0] op_sel_hi:[1,0]
v_pk_mul_f32 v[42:43], v[46:47], v[194:195] op_sel:[0,0] op_sel_hi:[1,0]
v_pk_fma_f32 v[40:41], v[44:45], v[192:193], v[40:41] op_sel:[1,1,0] op_sel_hi:[0,1,1] neg_lo:[1,0,0]
v_pk_fma_f32 v[42:43], v[46:47], v[194:195], v[42:43] op_sel:[1,1,0] op_sel_hi:[0,1,1] neg_lo:[1,0,0]
v_cvt_pk_bf16_f32 v98, v40, -v41
v_cvt_pk_bf16_f32 v99, v42, -v43
ds_write2_b64 v3, v[92:93], v[94:95] offset0:0 offset1:68
ds_write2_b64 v3, v[96:97], v[98:99] offset0:136 offset1:204
buffer_load_dwordx4 a[28:31], v242, s[20:23], s47 offen offset:1024 sc1
buffer_load_dwordx4 a[64:67], v243, s[20:23], s44 offen offset:0 sc1
v_cvt_pk_bf16_f32 v84, v196, -v197
v_cvt_pk_bf16_f32 v85, v198, -v199
v_add_u32 v3, 0x7920, v2
v_pk_mul_f32 v[40:41], v[196:197], v[200:201] op_sel:[0,0] op_sel_hi:[1,0]
v_pk_mul_f32 v[42:43], v[198:199], v[202:203] op_sel:[0,0] op_sel_hi:[1,0]
v_pk_fma_f32 v[40:41], v[196:197], v[200:201], v[40:41] op_sel:[1,1,0] op_sel_hi:[0,1,1] neg_lo:[1,0,0]
v_pk_fma_f32 v[42:43], v[198:199], v[202:203], v[42:43] op_sel:[1,1,0] op_sel_hi:[0,1,1] neg_lo:[1,0,0]
v_cvt_pk_bf16_f32 v86, v40, -v41
v_cvt_pk_bf16_f32 v87, v42, -v43
v_pk_mul_f32 v[44:45], v[40:41], v[200:201] op_sel:[0,0] op_sel_hi:[1,0]
v_pk_mul_f32 v[46:47], v[42:43], v[202:203] op_sel:[0,0] op_sel_hi:[1,0]
v_pk_fma_f32 v[44:45], v[40:41], v[200:201], v[44:45] op_sel:[1,1,0] op_sel_hi:[0,1,1] neg_lo:[1,0,0]
v_pk_fma_f32 v[46:47], v[42:43], v[202:203], v[46:47] op_sel:[1,1,0] op_sel_hi:[0,1,1] neg_lo:[1,0,0]
v_cvt_pk_bf16_f32 v88, v44, -v45
v_cvt_pk_bf16_f32 v89, v46, -v47
v_pk_mul_f32 v[40:41], v[44:45], v[200:201] op_sel:[0,0] op_sel_hi:[1,0]
v_pk_mul_f32 v[42:43], v[46:47], v[202:203] op_sel:[0,0] op_sel_hi:[1,0]
v_pk_fma_f32 v[40:41], v[44:45], v[200:201], v[40:41] op_sel:[1,1,0] op_sel_hi:[0,1,1] neg_lo:[1,0,0]
v_pk_fma_f32 v[42:43], v[46:47], v[202:203], v[42:43] op_sel:[1,1,0] op_sel_hi:[0,1,1] neg_lo:[1,0,0]
v_cvt_pk_bf16_f32 v90, v40, -v41
v_cvt_pk_bf16_f32 v91, v42, -v43
ds_write2_b64 v3, v[84:85], v[86:87] offset0:0 offset1:68
ds_write2_b64 v3, v[88:89], v[90:91] offset0:136 offset1:204
buffer_load_dwordx4 a[68:71], v243, s[20:23], s45 offen offset:0 sc1
buffer_load_dwordx4 a[72:75], v243, s[20:23], s46 offen offset:0 sc1
buffer_load_dwordx4 a[76:79], v243, s[20:23], s47 offen offset:0 sc1
v_pk_mul_f32 v[44:45], v[40:41], v[200:201] op_sel:[0,0] op_sel_hi:[1,0]
v_pk_mul_f32 v[46:47], v[42:43], v[202:203] op_sel:[0,0] op_sel_hi:[1,0]
v_pk_fma_f32 v[44:45], v[40:41], v[200:201], v[44:45] op_sel:[1,1,0] op_sel_hi:[0,1,1] neg_lo:[1,0,0]
v_pk_fma_f32 v[46:47], v[42:43], v[202:203], v[46:47] op_sel:[1,1,0] op_sel_hi:[0,1,1] neg_lo:[1,0,0]
v_cvt_pk_bf16_f32 v92, v44, -v45
v_cvt_pk_bf16_f32 v93, v46, -v47
v_add_u32 v3, 0x81a0, v2
v_pk_mul_f32 v[40:41], v[44:45], v[200:201] op_sel:[0,0] op_sel_hi:[1,0]
v_pk_mul_f32 v[42:43], v[46:47], v[202:203] op_sel:[0,0] op_sel_hi:[1,0]
v_pk_fma_f32 v[40:41], v[44:45], v[200:201], v[40:41] op_sel:[1,1,0] op_sel_hi:[0,1,1] neg_lo:[1,0,0]
v_pk_fma_f32 v[42:43], v[46:47], v[202:203], v[42:43] op_sel:[1,1,0] op_sel_hi:[0,1,1] neg_lo:[1,0,0]
v_cvt_pk_bf16_f32 v94, v40, -v41
v_cvt_pk_bf16_f32 v95, v42, -v43
v_pk_mul_f32 v[44:45], v[40:41], v[200:201] op_sel:[0,0] op_sel_hi:[1,0]
v_pk_mul_f32 v[46:47], v[42:43], v[202:203] op_sel:[0,0] op_sel_hi:[1,0]
v_pk_fma_f32 v[44:45], v[40:41], v[200:201], v[44:45] op_sel:[1,1,0] op_sel_hi:[0,1,1] neg_lo:[1,0,0]
v_pk_fma_f32 v[46:47], v[42:43], v[202:203], v[46:47] op_sel:[1,1,0] op_sel_hi:[0,1,1] neg_lo:[1,0,0]
v_cvt_pk_bf16_f32 v96, v44, -v45
v_cvt_pk_bf16_f32 v97, v46, -v47
v_pk_mul_f32 v[40:41], v[44:45], v[200:201] op_sel:[0,0] op_sel_hi:[1,0]
v_pk_mul_f32 v[42:43], v[46:47], v[202:203] op_sel:[0,0] op_sel_hi:[1,0]
v_pk_fma_f32 v[40:41], v[44:45], v[200:201], v[40:41] op_sel:[1,1,0] op_sel_hi:[0,1,1] neg_lo:[1,0,0]
v_pk_fma_f32 v[42:43], v[46:47], v[202:203], v[42:43] op_sel:[1,1,0] op_sel_hi:[0,1,1] neg_lo:[1,0,0]
v_cvt_pk_bf16_f32 v98, v40, -v41
v_cvt_pk_bf16_f32 v99, v42, -v43
ds_write2_b64 v3, v[92:93], v[94:95] offset0:0 offset1:68
ds_write2_b64 v3, v[96:97], v[98:99] offset0:136 offset1:204
buffer_load_dwordx4 a[80:83], v243, s[20:23], s44 offen offset:1024 sc1
s_waitcnt vmcnt(13)
s_nop 0
buffer_store_dword v213, v214, s[20:23], s76 offen sc1
buffer_load_dwordx4 a[84:87], v243, s[20:23], s45 offen offset:1024 sc1
v_pk_mul_f32 v[44:45], v[40:41], v[200:201] op_sel:[0,0] op_sel_hi:[1,0]
v_pk_mul_f32 v[46:47], v[42:43], v[202:203] op_sel:[0,0] op_sel_hi:[1,0]
v_pk_fma_f32 v[44:45], v[40:41], v[200:201], v[44:45] op_sel:[1,1,0] op_sel_hi:[0,1,1] neg_lo:[1,0,0]
v_pk_fma_f32 v[46:47], v[42:43], v[202:203], v[46:47] op_sel:[1,1,0] op_sel_hi:[0,1,1] neg_lo:[1,0,0]
v_cvt_pk_bf16_f32 v84, v44, -v45
v_cvt_pk_bf16_f32 v85, v46, -v47
v_add_u32 v3, 0x8a20, v2
v_pk_mul_f32 v[40:41], v[44:45], v[200:201] op_sel:[0,0] op_sel_hi:[1,0]
v_pk_mul_f32 v[42:43], v[46:47], v[202:203] op_sel:[0,0] op_sel_hi:[1,0]
v_pk_fma_f32 v[40:41], v[44:45], v[200:201], v[40:41] op_sel:[1,1,0] op_sel_hi:[0,1,1] neg_lo:[1,0,0]
v_pk_fma_f32 v[42:43], v[46:47], v[202:203], v[42:43] op_sel:[1,1,0] op_sel_hi:[0,1,1] neg_lo:[1,0,0]
v_cvt_pk_bf16_f32 v86, v40, -v41
v_cvt_pk_bf16_f32 v87, v42, -v43
v_pk_mul_f32 v[44:45], v[40:41], v[200:201] op_sel:[0,0] op_sel_hi:[1,0]
v_pk_mul_f32 v[46:47], v[42:43], v[202:203] op_sel:[0,0] op_sel_hi:[1,0]
v_pk_fma_f32 v[44:45], v[40:41], v[200:201], v[44:45] op_sel:[1,1,0] op_sel_hi:[0,1,1] neg_lo:[1,0,0]
v_pk_fma_f32 v[46:47], v[42:43], v[202:203], v[46:47] op_sel:[1,1,0] op_sel_hi:[0,1,1] neg_lo:[1,0,0]
v_cvt_pk_bf16_f32 v88, v44, -v45
v_cvt_pk_bf16_f32 v89, v46, -v47
v_pk_mul_f32 v[40:41], v[44:45], v[200:201] op_sel:[0,0] op_sel_hi:[1,0]
v_pk_mul_f32 v[42:43], v[46:47], v[202:203] op_sel:[0,0] op_sel_hi:[1,0]
v_pk_fma_f32 v[40:41], v[44:45], v[200:201], v[40:41] op_sel:[1,1,0] op_sel_hi:[0,1,1] neg_lo:[1,0,0]
v_pk_fma_f32 v[42:43], v[46:47], v[202:203], v[42:43] op_sel:[1,1,0] op_sel_hi:[0,1,1] neg_lo:[1,0,0]
v_cvt_pk_bf16_f32 v90, v40, -v41
v_cvt_pk_bf16_f32 v91, v42, -v43
ds_write2_b64 v3, v[84:85], v[86:87] offset0:0 offset1:68
ds_write2_b64 v3, v[88:89], v[90:91] offset0:136 offset1:204
buffer_load_dwordx4 a[88:91], v243, s[20:23], s46 offen offset:1024 sc1
buffer_load_dwordx4 a[92:95], v243, s[20:23], s47 offen offset:1024 sc1
v_pk_mul_f32 v[44:45], v[40:41], v[200:201] op_sel:[0,0] op_sel_hi:[1,0]
v_pk_mul_f32 v[46:47], v[42:43], v[202:203] op_sel:[0,0] op_sel_hi:[1,0]
v_pk_fma_f32 v[44:45], v[40:41], v[200:201], v[44:45] op_sel:[1,1,0] op_sel_hi:[0,1,1] neg_lo:[1,0,0]
v_pk_fma_f32 v[46:47], v[42:43], v[202:203], v[46:47] op_sel:[1,1,0] op_sel_hi:[0,1,1] neg_lo:[1,0,0]
v_cvt_pk_bf16_f32 v92, v44, -v45
v_cvt_pk_bf16_f32 v93, v46, -v47
v_add_u32 v3, 0x92a0, v2
v_pk_mul_f32 v[40:41], v[44:45], v[200:201] op_sel:[0,0] op_sel_hi:[1,0]
v_pk_mul_f32 v[42:43], v[46:47], v[202:203] op_sel:[0,0] op_sel_hi:[1,0]
v_pk_fma_f32 v[40:41], v[44:45], v[200:201], v[40:41] op_sel:[1,1,0] op_sel_hi:[0,1,1] neg_lo:[1,0,0]
v_pk_fma_f32 v[42:43], v[46:47], v[202:203], v[42:43] op_sel:[1,1,0] op_sel_hi:[0,1,1] neg_lo:[1,0,0]
v_cvt_pk_bf16_f32 v94, v40, -v41
v_cvt_pk_bf16_f32 v95, v42, -v43
v_pk_mul_f32 v[44:45], v[40:41], v[200:201] op_sel:[0,0] op_sel_hi:[1,0]
v_pk_mul_f32 v[46:47], v[42:43], v[202:203] op_sel:[0,0] op_sel_hi:[1,0]
v_pk_fma_f32 v[44:45], v[40:41], v[200:201], v[44:45] op_sel:[1,1,0] op_sel_hi:[0,1,1] neg_lo:[1,0,0]
v_pk_fma_f32 v[46:47], v[42:43], v[202:203], v[46:47] op_sel:[1,1,0] op_sel_hi:[0,1,1] neg_lo:[1,0,0]
v_cvt_pk_bf16_f32 v96, v44, -v45
v_cvt_pk_bf16_f32 v97, v46, -v47
v_pk_mul_f32 v[40:41], v[44:45], v[200:201] op_sel:[0,0] op_sel_hi:[1,0]
v_pk_mul_f32 v[42:43], v[46:47], v[202:203] op_sel:[0,0] op_sel_hi:[1,0]
v_pk_fma_f32 v[40:41], v[44:45], v[200:201], v[40:41] op_sel:[1,1,0] op_sel_hi:[0,1,1] neg_lo:[1,0,0]
v_pk_fma_f32 v[42:43], v[46:47], v[202:203], v[42:43] op_sel:[1,1,0] op_sel_hi:[0,1,1] neg_lo:[1,0,0]
v_cvt_pk_bf16_f32 v98, v40, -v41
v_cvt_pk_bf16_f32 v99, v42, -v43
ds_write2_b64 v3, v[92:93], v[94:95] offset0:0 offset1:68
ds_write2_b64 v3, v[96:97], v[98:99] offset0:136 offset1:204
buffer_load_dwordx4 a[128:131], v244, s[20:23], s44 offen offset:0 sc1
buffer_load_dwordx4 a[132:135], v244, s[20:23], s45 offen offset:0 sc1
v_cvt_pk_bf16_f32 v84, v204, -v205
v_cvt_pk_bf16_f32 v85, v206, -v207
v_add_u32 v3, 0xf240, v2
v_pk_mul_f32 v[40:41], v[204:205], v[208:209] op_sel:[0,0] op_sel_hi:[1,0]
v_pk_mul_f32 v[42:43], v[206:207], v[210:211] op_sel:[0,0] op_sel_hi:[1,0]
v_pk_fma_f32 v[40:41], v[204:205], v[208:209], v[40:41] op_sel:[1,1,0] op_sel_hi:[0,1,1] neg_lo:[1,0,0]
v_pk_fma_f32 v[42:43], v[206:207], v[210:211], v[42:43] op_sel:[1,1,0] op_sel_hi:[0,1,1] neg_lo:[1,0,0]
v_cvt_pk_bf16_f32 v86, v40, -v41
v_cvt_pk_bf16_f32 v87, v42, -v43
v_pk_mul_f32 v[44:45], v[40:41], v[208:209] op_sel:[0,0] op_sel_hi:[1,0]
v_pk_mul_f32 v[46:47], v[42:43], v[210:211] op_sel:[0,0] op_sel_hi:[1,0]
v_pk_fma_f32 v[44:45], v[40:41], v[208:209], v[44:45] op_sel:[1,1,0] op_sel_hi:[0,1,1] neg_lo:[1,0,0]
v_pk_fma_f32 v[46:47], v[42:43], v[210:211], v[46:47] op_sel:[1,1,0] op_sel_hi:[0,1,1] neg_lo:[1,0,0]
v_cvt_pk_bf16_f32 v88, v44, -v45
v_cvt_pk_bf16_f32 v89, v46, -v47
v_pk_mul_f32 v[40:41], v[44:45], v[208:209] op_sel:[0,0] op_sel_hi:[1,0]
v_pk_mul_f32 v[42:43], v[46:47], v[210:211] op_sel:[0,0] op_sel_hi:[1,0]
v_pk_fma_f32 v[40:41], v[44:45], v[208:209], v[40:41] op_sel:[1,1,0] op_sel_hi:[0,1,1] neg_lo:[1,0,0]
v_pk_fma_f32 v[42:43], v[46:47], v[210:211], v[42:43] op_sel:[1,1,0] op_sel_hi:[0,1,1] neg_lo:[1,0,0]
v_cvt_pk_bf16_f32 v90, v40, -v41
v_cvt_pk_bf16_f32 v91, v42, -v43
ds_write2_b64 v3, v[84:85], v[86:87] offset0:0 offset1:68
ds_write2_b64 v3, v[88:89], v[90:91] offset0:136 offset1:204
buffer_load_dwordx4 a[136:139], v244, s[20:23], s46 offen offset:0 sc1
buffer_load_dwordx4 a[140:143], v244, s[20:23], s47 offen offset:0 sc1
buffer_load_dwordx4 a[144:147], v244, s[20:23], s44 offen offset:1024 sc1
v_pk_mul_f32 v[44:45], v[40:41], v[208:209] op_sel:[0,0] op_sel_hi:[1,0]
v_pk_mul_f32 v[46:47], v[42:43], v[210:211] op_sel:[0,0] op_sel_hi:[1,0]
v_pk_fma_f32 v[44:45], v[40:41], v[208:209], v[44:45] op_sel:[1,1,0] op_sel_hi:[0,1,1] neg_lo:[1,0,0]
v_pk_fma_f32 v[46:47], v[42:43], v[210:211], v[46:47] op_sel:[1,1,0] op_sel_hi:[0,1,1] neg_lo:[1,0,0]
v_cvt_pk_bf16_f32 v92, v44, -v45
v_cvt_pk_bf16_f32 v93, v46, -v47
v_add_u32 v3, 0xfac0, v2
v_pk_mul_f32 v[40:41], v[44:45], v[208:209] op_sel:[0,0] op_sel_hi:[1,0]
v_pk_mul_f32 v[42:43], v[46:47], v[210:211] op_sel:[0,0] op_sel_hi:[1,0]
v_pk_fma_f32 v[40:41], v[44:45], v[208:209], v[40:41] op_sel:[1,1,0] op_sel_hi:[0,1,1] neg_lo:[1,0,0]
v_pk_fma_f32 v[42:43], v[46:47], v[210:211], v[42:43] op_sel:[1,1,0] op_sel_hi:[0,1,1] neg_lo:[1,0,0]
v_cvt_pk_bf16_f32 v94, v40, -v41
v_cvt_pk_bf16_f32 v95, v42, -v43
v_pk_mul_f32 v[44:45], v[40:41], v[208:209] op_sel:[0,0] op_sel_hi:[1,0]
v_pk_mul_f32 v[46:47], v[42:43], v[210:211] op_sel:[0,0] op_sel_hi:[1,0]
v_pk_fma_f32 v[44:45], v[40:41], v[208:209], v[44:45] op_sel:[1,1,0] op_sel_hi:[0,1,1] neg_lo:[1,0,0]
v_pk_fma_f32 v[46:47], v[42:43], v[210:211], v[46:47] op_sel:[1,1,0] op_sel_hi:[0,1,1] neg_lo:[1,0,0]
v_cvt_pk_bf16_f32 v96, v44, -v45
v_cvt_pk_bf16_f32 v97, v46, -v47
v_pk_mul_f32 v[40:41], v[44:45], v[208:209] op_sel:[0,0] op_sel_hi:[1,0]
v_pk_mul_f32 v[42:43], v[46:47], v[210:211] op_sel:[0,0] op_sel_hi:[1,0]
v_pk_fma_f32 v[40:41], v[44:45], v[208:209], v[40:41] op_sel:[1,1,0] op_sel_hi:[0,1,1] neg_lo:[1,0,0]
v_pk_fma_f32 v[42:43], v[46:47], v[210:211], v[42:43] op_sel:[1,1,0] op_sel_hi:[0,1,1] neg_lo:[1,0,0]
v_cvt_pk_bf16_f32 v98, v40, -v41
v_cvt_pk_bf16_f32 v99, v42, -v43
ds_write2_b64 v3, v[92:93], v[94:95] offset0:0 offset1:68
ds_write2_b64 v3, v[96:97], v[98:99] offset0:136 offset1:204
buffer_load_dwordx4 a[148:151], v244, s[20:23], s45 offen offset:1024 sc1
buffer_load_dwordx4 a[152:155], v244, s[20:23], s46 offen offset:1024 sc1
v_pk_mul_f32 v[44:45], v[40:41], v[208:209] op_sel:[0,0] op_sel_hi:[1,0]
v_pk_mul_f32 v[46:47], v[42:43], v[210:211] op_sel:[0,0] op_sel_hi:[1,0]
v_pk_fma_f32 v[44:45], v[40:41], v[208:209], v[44:45] op_sel:[1,1,0] op_sel_hi:[0,1,1] neg_lo:[1,0,0]
v_pk_fma_f32 v[46:47], v[42:43], v[210:211], v[46:47] op_sel:[1,1,0] op_sel_hi:[0,1,1] neg_lo:[1,0,0]
v_cvt_pk_bf16_f32 v84, v44, -v45
v_cvt_pk_bf16_f32 v85, v46, -v47
v_add_u32 v3, 0x10340, v2
v_pk_mul_f32 v[40:41], v[44:45], v[208:209] op_sel:[0,0] op_sel_hi:[1,0]
v_pk_mul_f32 v[42:43], v[46:47], v[210:211] op_sel:[0,0] op_sel_hi:[1,0]
v_pk_fma_f32 v[40:41], v[44:45], v[208:209], v[40:41] op_sel:[1,1,0] op_sel_hi:[0,1,1] neg_lo:[1,0,0]
v_pk_fma_f32 v[42:43], v[46:47], v[210:211], v[42:43] op_sel:[1,1,0] op_sel_hi:[0,1,1] neg_lo:[1,0,0]
v_cvt_pk_bf16_f32 v86, v40, -v41
v_cvt_pk_bf16_f32 v87, v42, -v43
v_pk_mul_f32 v[44:45], v[40:41], v[208:209] op_sel:[0,0] op_sel_hi:[1,0]
v_pk_mul_f32 v[46:47], v[42:43], v[210:211] op_sel:[0,0] op_sel_hi:[1,0]
v_pk_fma_f32 v[44:45], v[40:41], v[208:209], v[44:45] op_sel:[1,1,0] op_sel_hi:[0,1,1] neg_lo:[1,0,0]
v_pk_fma_f32 v[46:47], v[42:43], v[210:211], v[46:47] op_sel:[1,1,0] op_sel_hi:[0,1,1] neg_lo:[1,0,0]
v_cvt_pk_bf16_f32 v88, v44, -v45
v_cvt_pk_bf16_f32 v89, v46, -v47
v_pk_mul_f32 v[40:41], v[44:45], v[208:209] op_sel:[0,0] op_sel_hi:[1,0]
v_pk_mul_f32 v[42:43], v[46:47], v[210:211] op_sel:[0,0] op_sel_hi:[1,0]
v_pk_fma_f32 v[40:41], v[44:45], v[208:209], v[40:41] op_sel:[1,1,0] op_sel_hi:[0,1,1] neg_lo:[1,0,0]
v_pk_fma_f32 v[42:43], v[46:47], v[210:211], v[42:43] op_sel:[1,1,0] op_sel_hi:[0,1,1] neg_lo:[1,0,0]
v_cvt_pk_bf16_f32 v90, v40, -v41
v_cvt_pk_bf16_f32 v91, v42, -v43
ds_write2_b64 v3, v[84:85], v[86:87] offset0:0 offset1:68
ds_write2_b64 v3, v[88:89], v[90:91] offset0:136 offset1:204
buffer_load_dwordx4 a[156:159], v244, s[20:23], s47 offen offset:1024 sc1
buffer_load_dwordx4 a[192:195], v245, s[20:23], s44 offen offset:0 sc1
v_pk_mul_f32 v[44:45], v[40:41], v[208:209] op_sel:[0,0] op_sel_hi:[1,0]
v_pk_mul_f32 v[46:47], v[42:43], v[210:211] op_sel:[0,0] op_sel_hi:[1,0]
v_pk_fma_f32 v[44:45], v[40:41], v[208:209], v[44:45] op_sel:[1,1,0] op_sel_hi:[0,1,1] neg_lo:[1,0,0]
v_pk_fma_f32 v[46:47], v[42:43], v[210:211], v[46:47] op_sel:[1,1,0] op_sel_hi:[0,1,1] neg_lo:[1,0,0]
v_cvt_pk_bf16_f32 v92, v44, -v45
v_cvt_pk_bf16_f32 v93, v46, -v47
v_add_u32 v3, 0x10bc0, v2
v_pk_mul_f32 v[40:41], v[44:45], v[208:209] op_sel:[0,0] op_sel_hi:[1,0]
v_pk_mul_f32 v[42:43], v[46:47], v[210:211] op_sel:[0,0] op_sel_hi:[1,0]
v_pk_fma_f32 v[40:41], v[44:45], v[208:209], v[40:41] op_sel:[1,1,0] op_sel_hi:[0,1,1] neg_lo:[1,0,0]
v_pk_fma_f32 v[42:43], v[46:47], v[210:211], v[42:43] op_sel:[1,1,0] op_sel_hi:[0,1,1] neg_lo:[1,0,0]
v_cvt_pk_bf16_f32 v94, v40, -v41
v_cvt_pk_bf16_f32 v95, v42, -v43
v_pk_mul_f32 v[44:45], v[40:41], v[208:209] op_sel:[0,0] op_sel_hi:[1,0]
v_pk_mul_f32 v[46:47], v[42:43], v[210:211] op_sel:[0,0] op_sel_hi:[1,0]
v_pk_fma_f32 v[44:45], v[40:41], v[208:209], v[44:45] op_sel:[1,1,0] op_sel_hi:[0,1,1] neg_lo:[1,0,0]
v_pk_fma_f32 v[46:47], v[42:43], v[210:211], v[46:47] op_sel:[1,1,0] op_sel_hi:[0,1,1] neg_lo:[1,0,0]
v_cvt_pk_bf16_f32 v96, v44, -v45
v_cvt_pk_bf16_f32 v97, v46, -v47
v_pk_mul_f32 v[40:41], v[44:45], v[208:209] op_sel:[0,0] op_sel_hi:[1,0]
v_pk_mul_f32 v[42:43], v[46:47], v[210:211] op_sel:[0,0] op_sel_hi:[1,0]
v_pk_fma_f32 v[40:41], v[44:45], v[208:209], v[40:41] op_sel:[1,1,0] op_sel_hi:[0,1,1] neg_lo:[1,0,0]
v_pk_fma_f32 v[42:43], v[46:47], v[210:211], v[42:43] op_sel:[1,1,0] op_sel_hi:[0,1,1] neg_lo:[1,0,0]
v_cvt_pk_bf16_f32 v98, v40, -v41
v_cvt_pk_bf16_f32 v99, v42, -v43
ds_write2_b64 v3, v[92:93], v[94:95] offset0:0 offset1:68
ds_write2_b64 v3, v[96:97], v[98:99] offset0:136 offset1:204
buffer_load_dwordx4 a[196:199], v245, s[20:23], s45 offen offset:0 sc1
buffer_load_dwordx4 a[200:203], v245, s[20:23], s46 offen offset:0 sc1
s_branch KF_join
s_nop 0
KF_p1:
PAD_7:
s_cmp_lg_u32 s73, 0
s_cbranch_scc1 PAD_11
v_cvt_pk_bf16_f32 v84, v188, v189
v_cvt_pk_bf16_f32 v85, v190, v191
v_add_u32 v3, 0x2200, v2
v_cvt_pk_bf16_f32 v86, v192, v193
v_cvt_pk_bf16_f32 v87, v194, v195
v_pk_mul_f32 v[40:41], v[192:193], v[192:193] op_sel:[0,0] op_sel_hi:[1,0]
v_pk_mul_f32 v[42:43], v[194:195], v[194:195] op_sel:[0,0] op_sel_hi:[1,0]
v_pk_fma_f32 v[40:41], v[192:193], v[192:193], v[40:41] op_sel:[1,1,0] op_sel_hi:[0,1,1] neg_lo:[1,0,0]
v_pk_fma_f32 v[42:43], v[194:195], v[194:195], v[42:43] op_sel:[1,1,0] op_sel_hi:[0,1,1] neg_lo:[1,0,0]
v_cvt_pk_bf16_f32 v88, v40, v41
v_cvt_pk_bf16_f32 v89, v42, v43
v_pk_mul_f32 v[44:45], v[40:41], v[192:193] op_sel:[0,0] op_sel_hi:[1,0]
v_pk_mul_f32 v[46:47], v[42:43], v[194:195] op_sel:[0,0] op_sel_hi:[1,0]
v_pk_fma_f32 v[44:45], v[40:41], v[192:193], v[44:45] op_sel:[1,1,0] op_sel_hi:[0,1,1] neg_lo:[1,0,0]
v_pk_fma_f32 v[46:47], v[42:43], v[194:195], v[46:47] op_sel:[1,1,0] op_sel_hi:[0,1,1] neg_lo:[1,0,0]
v_cvt_pk_bf16_f32 v90, v44, v45
v_cvt_pk_bf16_f32 v91, v46, v47
ds_write2_b64 v3, v[84:85], v[86:87] offset0:0 offset1:68
ds_write2_b64 v3, v[88:89], v[90:91] offset0:136 offset1:204
buffer_load_dwordx4 a[0:3], v242, s[20:23], s44 offen offset:0 sc1
buffer_load_dwordx4 a[4:7], v242, s[20:23], s45 offen offset:0 sc1
buffer_load_dwordx4 a[8:11], v242, s[20:23], s46 offen offset:0 sc1
v_pk_mul_f32 v[40:41], v[44:45], v[192:193] op_sel:[0,0] op_sel_hi:[1,0]
v_pk_mul_f32 v[42:43], v[46:47], v[194:195] op_sel:[0,0] op_sel_hi:[1,0]
v_pk_fma_f32 v[40:41], v[44:45], v[192:193], v[40:41] op_sel:[1,1,0] op_sel_hi:[0,1,1] neg_lo:[1,0,0]
v_pk_fma_f32 v[42:43], v[46:47], v[194:195], v[42:43] op_sel:[1,1,0] op_sel_hi:[0,1,1] neg_lo:[1,0,0]
v_cvt_pk_bf16_f32 v92, v40, v41
v_cvt_pk_bf16_f32 v93, v42, v43
v_add_u32 v3, 0x2a80, v2
v_pk_mul_f32 v[44:45], v[40:41], v[192:193] op_sel:[0,0] op_sel_hi:[1,0]
v_pk_mul_f32 v[46:47], v[42:43], v[194:195] op_sel:[0,0] op_sel_hi:[1,0]
v_pk_fma_f32 v[44:45], v[40:41], v[192:193], v[44:45] op_sel:[1,1,0] op_sel_hi:[0,1,1] neg_lo:[1,0,0]
v_pk_fma_f32 v[46:47], v[42:43], v[194:195], v[46:47] op_sel:[1,1,0] op_sel_hi:[0,1,1] neg_lo:[1,0,0]
v_cvt_pk_bf16_f32 v94, v44, v45
v_cvt_pk_bf16_f32 v95, v46, v47
v_pk_mul_f32 v[40:41], v[44:45], v[192:193] op_sel:[0,0] op_sel_hi:[1,0]
v_pk_mul_f32 v[42:43], v[46:47], v[194:195] op_sel:[0,0] op_sel_hi:[1,0]
v_pk_fma_f32 v[40:41], v[44:45], v[192:193], v[40:41] op_sel:[1,1,0] op_sel_hi:[0,1,1] neg_lo:[1,0,0]
v_pk_fma_f32 v[42:43], v[46:47], v[194:195], v[42:43] op_sel:[1,1,0] op_sel_hi:[0,1,1] neg_lo:[1,0,0]
v_cvt_pk_bf16_f32 v96, v40, v41
v_cvt_pk_bf16_f32 v97, v42, v43
v_pk_mul_f32 v[44:45], v[40:41], v[192:193] op_sel:[0,0] op_sel_hi:[1,0]
v_pk_mul_f32 v[46:47], v[42:43], v[194:195] op_sel:[0,0] op_sel_hi:[1,0]
v_pk_fma_f32 v[44:45], v[40:41], v[192:193], v[44:45] op_sel:[1,1,0] op_sel_hi:[0,1,1] neg_lo:[1,0,0]
v_pk_fma_f32 v[46:47], v[42:43], v[194:195], v[46:47] op_sel:[1,1,0] op_sel_hi:[0,1,1] neg_lo:[1,0,0]
v_cvt_pk_bf16_f32 v98, v44, v45
v_cvt_pk_bf16_f32 v99, v46, v47
ds_write2_b64 v3, v[92:93], v[94:95] offset0:0 offset1:68
ds_write2_b64 v3, v[96:97], v[98:99] offset0:136 offset1:204
buffer_load_dwordx4 a[12:15], v242, s[20:23], s47 offen offset:0 sc1
buffer_load_dwordx4 a[16:19], v242, s[20:23], s44 offen offset:1024 sc1
v_pk_mul_f32 v[40:41], v[44:45], v[192:193] op_sel:[0,0] op_sel_hi:[1,0]
v_pk_mul_f32 v[42:43], v[46:47], v[194:195] op_sel:[0,0] op_sel_hi:[1,0]
v_pk_fma_f32 v[40:41], v[44:45], v[192:193], v[40:41] op_sel:[1,1,0] op_sel_hi:[0,1,1] neg_lo:[1,0,0]
v_pk_fma_f32 v[42:43], v[46:47], v[194:195], v[42:43] op_sel:[1,1,0] op_sel_hi:[0,1,1] neg_lo:[1,0,0]
v_cvt_pk_bf16_f32 v84, v40, v41
v_cvt_pk_bf16_f32 v85, v42, v43
v_add_u32 v3, 0x3300, v2
v_pk_mul_f32 v[44:45], v[40:41], v[192:193] op_sel:[0,0] op_sel_hi:[1,0]
v_pk_mul_f32 v[46:47], v[42:43], v[194:195] op_sel:[0,0] op_sel_hi:[1,0]
v_pk_fma_f32 v[44:45], v[40:41], v[192:193], v[44:45] op_sel:[1,1,0] op_sel_hi:[0,1,1] neg_lo:[1,0,0]
v_pk_fma_f32 v[46:47], v[42:43], v[194:195], v[46:47] op_sel:[1,1,0] op_sel_hi:[0,1,1] neg_lo:[1,0,0]
v_cvt_pk_bf16_f32 v86, v44, v45
v_cvt_pk_bf16_f32 v87, v46, v47
v_pk_mul_f32 v[40:41], v[44:45], v[192:193] op_sel:[0,0] op_sel_hi:[1,0]
v_pk_mul_f32 v[42:43], v[46:47], v[194:195] op_sel:[0,0] op_sel_hi:[1,0]
v_pk_fma_f32 v[40:41], v[44:45], v[192:193], v[40:41] op_sel:[1,1,0] op_sel_hi:[0,1,1] neg_lo:[1,0,0]
v_pk_fma_f32 v[42:43], v[46:47], v[194:195], v[42:43] op_sel:[1,1,0] op_sel_hi:[0,1,1] neg_lo:[1,0,0]
v_cvt_pk_bf16_f32 v88, v40, v41
v_cvt_pk_bf16_f32 v89, v42, v43
v_pk_mul_f32 v[44:45], v[40:41], v[192:193] op_sel:[0,0] op_sel_hi:[1,0]
v_pk_mul_f32 v[46:47], v[42:43], v[194:195] op_sel:[0,0] op_sel_hi:[1,0]
v_pk_fma_f32 v[44:45], v[40:41], v[192:193], v[44:45] op_sel:[1,1,0] op_sel_hi:[0,1,1] neg_lo:[1,0,0]
v_pk_fma_f32 v[46:47], v[42:43], v[194:195], v[46:47] op_sel:[1,1,0] op_sel_hi:[0,1,1] neg_lo:[1,0,0]
v_cvt_pk_bf16_f32 v90, v44, v45
v_cvt_pk_bf16_f32 v91, v46, v47
ds_write2_b64 v3, v[84:85], v[86:87] offset0:0 offset1:68
ds_write2_b64 v3, v[88:89], v[90:91] offset0:136 offset1:204
buffer_load_dwordx4 a[20:23], v242, s[20:23], s45 offen offset:1024 sc1
buffer_load_dwordx4 a[24:27], v242, s[20:23], s46 offen offset:1024 sc1
v_pk_mul_f32 v[40:41], v[44:45], v[192:193] op_sel:[0,0] op_sel_hi:[1,0]
v_pk_mul_f32 v[42:43], v[46:47], v[194:195] op_sel:[0,0] op_sel_hi:[1,0]
v_pk_fma_f32 v[40:41], v[44:45], v[192:193], v[40:41] op_sel:[1,1,0] op_sel_hi:[0,1,1] neg_lo:[1,0,0]
v_pk_fma_f32 v[42:43], v[46:47], v[194:195], v[42:43] op_sel:[1,1,0] op_sel_hi:[0,1,1] neg_lo:[1,0,0]
v_cvt_pk_bf16_f32 v92, v40, v41
v_cvt_pk_bf16_f32 v93, v42, v43
v_add_u32 v3, 0x3b80, v2
v_pk_mul_f32 v[44:45], v[40:41], v[192:193] op_sel:[0,0] op_sel_hi:[1,0]
v_pk_mul_f32 v[46:47], v[42:43], v[194:195] op_sel:[0,0] op_sel_hi:[1,0]
v_pk_fma_f32 v[44:45], v[40:41], v[192:193], v[44:45] op_sel:[1,1,0] op_sel_hi:[0,1,1] neg_lo:[1,0,0]
v_pk_fma_f32 v[46:47], v[42:43], v[194:195], v[46:47] op_sel:[1,1,0] op_sel_hi:[0,1,1] neg_lo:[1,0,0]
v_cvt_pk_bf16_f32 v94, v44, v45
v_cvt_pk_bf16_f32 v95, v46, v47
v_pk_mul_f32 v[40:41], v[44:45], v[192:193] op_sel:[0,0] op_sel_hi:[1,0]
v_pk_mul_f32 v[42:43], v[46:47], v[194:195] op_sel:[0,0] op_sel_hi:[1,0]
v_pk_fma_f32 v[40:41], v[44:45], v[192:193], v[40:41] op_sel:[1,1,0] op_sel_hi:[0,1,1] neg_lo:[1,0,0]
v_pk_fma_f32 v[42:43], v[46:47], v[194:195], v[42:43] op_sel:[1,1,0] op_sel_hi:[0,1,1] neg_lo:[1,0,0]
v_cvt_pk_bf16_f32 v96, v40, v41
v_cvt_pk_bf16_f32 v97, v42, v43
v_pk_mul_f32 v[44:45], v[40:41], v[192:193] op_sel:[0,0] op_sel_hi:[1,0]
PAD_8:
s_cmp_lg_u32 s73, 0
s_cbranch_scc1 PAD_12
v_pk_mul_f32 v[46:47], v[42:43], v[194:195] op_sel:[0,0] op_sel_hi:[1,0]
v_pk_fma_f32 v[44:45], v[40:41], v[192:193], v[44:45] op_sel:[1,1,0] op_sel_hi:[0,1,1] neg_lo:[1,0,0]
v_pk_fma_f32 v[46:47], v[42:43], v[194:195], v[46:47] op_sel:[1,1,0] op_sel_hi:[0,1,1] neg_lo:[1,0,0]
v_cvt_pk_bf16_f32 v98, v44, v45
v_cvt_pk_bf16_f32 v99, v46, v47
ds_write2_b64 v3, v[92:93], v[94:95] offset0:0 offset1:68
ds_write2_b64 v3, v[96:97], v[98:99] offset0:136 offset1:204
buffer_load_dwordx4 a[28:31], v242, s[20:23], s47 offen offset:1024 sc1
buffer_load_dwordx4 a[64:67], v243, s[20:23], s44 offen offset:0 sc1
v_cvt_pk_bf16_f32 v84, v196, v197
v_cvt_pk_bf16_f32 v85, v198, v199
v_add_u32 v3, 0x9b20, v2
v_cvt_pk_bf16_f32 v86, v200, v201
v_cvt_pk_bf16_f32 v87, v202, v203
v_pk_mul_f32 v[40:41], v[200:201], v[200:201] op_sel:[0,0] op_sel_hi:[1,0]
v_pk_mul_f32 v[42:43], v[202:203], v[202:203] op_sel:[0,0] op_sel_hi:[1,0]
v_pk_fma_f32 v[40:41], v[200:201], v[200:201], v[40:41] op_sel:[1,1,0] op_sel_hi:[0,1,1] neg_lo:[1,0,0]
v_pk_fma_f32 v[42:43], v[202:203], v[202:203], v[42:43] op_sel:[1,1,0] op_sel_hi:[0,1,1] neg_lo:[1,0,0]
v_cvt_pk_bf16_f32 v88, v40, v41
v_cvt_pk_bf16_f32 v89, v42, v43
v_pk_mul_f32 v[44:45], v[40:41], v[200:201] op_sel:[0,0] op_sel_hi:[1,0]
v_pk_mul_f32 v[46:47], v[42:43], v[202:203] op_sel:[0,0] op_sel_hi:[1,0]
v_pk_fma_f32 v[44:45], v[40:41], v[200:201], v[44:45] op_sel:[1,1,0] op_sel_hi:[0,1,1] neg_lo:[1,0,0]
v_pk_fma_f32 v[46:47], v[42:43], v[202:203], v[46:47] op_sel:[1,1,0] op_sel_hi:[0,1,1] neg_lo:[1,0,0]
v_cvt_pk_bf16_f32 v90, v44, v45
v_cvt_pk_bf16_f32 v91, v46, v47
ds_write2_b64 v3, v[84:85], v[86:87] offset0:0 offset1:68
ds_write2_b64 v3, v[88:89], v[90:91] offset0:136 offset1:204
buffer_load_dwordx4 a[68:71], v243, s[20:23], s45 offen offset:0 sc1
buffer_load_dwordx4 a[72:75], v243, s[20:23], s46 offen offset:0 sc1
buffer_load_dwordx4 a[76:79], v243, s[20:23], s47 offen offset:0 sc1
v_pk_mul_f32 v[40:41], v[44:45], v[200:201] op_sel:[0,0] op_sel_hi:[1,0]
v_pk_mul_f32 v[42:43], v[46:47], v[202:203] op_sel:[0,0] op_sel_hi:[1,0]
v_pk_fma_f32 v[40:41], v[44:45], v[200:201], v[40:41] op_sel:[1,1,0] op_sel_hi:[0,1,1] neg_lo:[1,0,0]
v_pk_fma_f32 v[42:43], v[46:47], v[202:203], v[42:43] op_sel:[1,1,0] op_sel_hi:[0,1,1] neg_lo:[1,0,0]
v_cvt_pk_bf16_f32 v92, v40, v41
v_cvt_pk_bf16_f32 v93, v42, v43
v_add_u32 v3, 0xa3a0, v2
v_pk_mul_f32 v[44:45], v[40:41], v[200:201] op_sel:[0,0] op_sel_hi:[1,0]
v_pk_mul_f32 v[46:47], v[42:43], v[202:203] op_sel:[0,0] op_sel_hi:[1,0]
v_pk_fma_f32 v[44:45], v[40:41], v[200:201], v[44:45] op_sel:[1,1,0] op_sel_hi:[0,1,1] neg_lo:[1,0,0]
v_pk_fma_f32 v[46:47], v[42:43], v[202:203], v[46:47] op_sel:[1,1,0] op_sel_hi:[0,1,1] neg_lo:[1,0,0]
v_cvt_pk_bf16_f32 v94, v44, v45
v_cvt_pk_bf16_f32 v95, v46, v47
v_pk_mul_f32 v[40:41], v[44:45], v[200:201] op_sel:[0,0] op_sel_hi:[1,0]
v_pk_mul_f32 v[42:43], v[46:47], v[202:203] op_sel:[0,0] op_sel_hi:[1,0]
v_pk_fma_f32 v[40:41], v[44:45], v[200:201], v[40:41] op_sel:[1,1,0] op_sel_hi:[0,1,1] neg_lo:[1,0,0]
v_pk_fma_f32 v[42:43], v[46:47], v[202:203], v[42:43] op_sel:[1,1,0] op_sel_hi:[0,1,1] neg_lo:[1,0,0]
v_cvt_pk_bf16_f32 v96, v40, v41
v_cvt_pk_bf16_f32 v97, v42, v43
v_pk_mul_f32 v[44:45], v[40:41], v[200:201] op_sel:[0,0] op_sel_hi:[1,0]
v_pk_mul_f32 v[46:47], v[42:43], v[202:203] op_sel:[0,0] op_sel_hi:[1,0]
v_pk_fma_f32 v[44:45], v[40:41], v[200:201], v[44:45] op_sel:[1,1,0] op_sel_hi:[0,1,1] neg_lo:[1,0,0]
v_pk_fma_f32 v[46:47], v[42:43], v[202:203], v[46:47] op_sel:[1,1,0] op_sel_hi:[0,1,1] neg_lo:[1,0,0]
v_cvt_pk_bf16_f32 v98, v44, v45
v_cvt_pk_bf16_f32 v99, v46, v47
ds_write2_b64 v3, v[92:93], v[94:95] offset0:0 offset1:68
ds_write2_b64 v3, v[96:97], v[98:99] offset0:136 offset1:204
buffer_load_dwordx4 a[80:83], v243, s[20:23], s44 offen offset:1024 sc1
s_waitcnt vmcnt(13)
s_nop 0
buffer_store_dword v213, v214, s[20:23], s76 offen sc1
buffer_load_dwordx4 a[84:87], v243, s[20:23], s45 offen offset:1024 sc1
v_pk_mul_f32 v[40:41], v[44:45], v[200:201] op_sel:[0,0] op_sel_hi:[1,0]
v_pk_mul_f32 v[42:43], v[46:47], v[202:203] op_sel:[0,0] op_sel_hi:[1,0]
v_pk_fma_f32 v[40:41], v[44:45], v[200:201], v[40:41] op_sel:[1,1,0] op_sel_hi:[0,1,1] neg_lo:[1,0,0]
v_pk_fma_f32 v[42:43], v[46:47], v[202:203], v[42:43] op_sel:[1,1,0] op_sel_hi:[0,1,1] neg_lo:[1,0,0]
v_cvt_pk_bf16_f32 v84, v40, v41
v_cvt_pk_bf16_f32 v85, v42, v43
v_add_u32 v3, 0xac20, v2
v_pk_mul_f32 v[44:45], v[40:41], v[200:201] op_sel:[0,0] op_sel_hi:[1,0]
v_pk_mul_f32 v[46:47], v[42:43], v[202:203] op_sel:[0,0] op_sel_hi:[1,0]
v_pk_fma_f32 v[44:45], v[40:41], v[200:201], v[44:45] op_sel:[1,1,0] op_sel_hi:[0,1,1] neg_lo:[1,0,0]
v_pk_fma_f32 v[46:47], v[42:43], v[202:203], v[46:47] op_sel:[1,1,0] op_sel_hi:[0,1,1] neg_lo:[1,0,0]
v_cvt_pk_bf16_f32 v86, v44, v45
v_cvt_pk_bf16_f32 v87, v46, v47
v_pk_mul_f32 v[40:41], v[44:45], v[200:201] op_sel:[0,0] op_sel_hi:[1,0]
v_pk_mul_f32 v[42:43], v[46:47], v[202:203] op_sel:[0,0] op_sel_hi:[1,0]
v_pk_fma_f32 v[40:41], v[44:45], v[200:201], v[40:41] op_sel:[1,1,0] op_sel_hi:[0,1,1] neg_lo:[1,0,0]
v_pk_fma_f32 v[42:43], v[46:47], v[202:203], v[42:43] op_sel:[1,1,0] op_sel_hi:[0,1,1] neg_lo:[1,0,0]
v_cvt_pk_bf16_f32 v88, v40, v41
v_cvt_pk_bf16_f32 v89, v42, v43
v_pk_mul_f32 v[44:45], v[40:41], v[200:201] op_sel:[0,0] op_sel_hi:[1,0]
v_pk_mul_f32 v[46:47], v[42:43], v[202:203] op_sel:[0,0] op_sel_hi:[1,0]
v_pk_fma_f32 v[44:45], v[40:41], v[200:201], v[44:45] op_sel:[1,1,0] op_sel_hi:[0,1,1] neg_lo:[1,0,0]
v_pk_fma_f32 v[46:47], v[42:43], v[202:203], v[46:47] op_sel:[1,1,0] op_sel_hi:[0,1,1] neg_lo:[1,0,0]
v_cvt_pk_bf16_f32 v90, v44, v45
v_cvt_pk_bf16_f32 v91, v46, v47
ds_write2_b64 v3, v[84:85], v[86:87] offset0:0 offset1:68
ds_write2_b64 v3, v[88:89], v[90:91] offset0:136 offset1:204
buffer_load_dwordx4 a[88:91], v243, s[20:23], s46 offen offset:1024 sc1
buffer_load_dwordx4 a[92:95], v243, s[20:23], s47 offen offset:1024 sc1
v_pk_mul_f32 v[40:41], v[44:45], v[200:201] op_sel:[0,0] op_sel_hi:[1,0]
v_pk_mul_f32 v[42:43], v[46:47], v[202:203] op_sel:[0,0] op_sel_hi:[1,0]
v_pk_fma_f32 v[40:41], v[44:45], v[200:201], v[40:41] op_sel:[1,1,0] op_sel_hi:[0,1,1] neg_lo:[1,0,0]
v_pk_fma_f32 v[42:43], v[46:47], v[202:203], v[42:43] op_sel:[1,1,0] op_sel_hi:[0,1,1] neg_lo:[1,0,0]
v_cvt_pk_bf16_f32 v92, v40, v41
v_cvt_pk_bf16_f32 v93, v42, v43
v_add_u32 v3, 0xb4a0, v2
v_pk_mul_f32 v[44:45], v[40:41], v[200:201] op_sel:[0,0] op_sel_hi:[1,0]
v_pk_mul_f32 v[46:47], v[42:43], v[202:203] op_sel:[0,0] op_sel_hi:[1,0]
v_pk_fma_f32 v[44:45], v[40:41], v[200:201], v[44:45] op_sel:[1,1,0] op_sel_hi:[0,1,1] neg_lo:[1,0,0]
v_pk_fma_f32 v[46:47], v[42:43], v[202:203], v[46:47] op_sel:[1,1,0] op_sel_hi:[0,1,1] neg_lo:[1,0,0]
v_cvt_pk_bf16_f32 v94, v44, v45
v_cvt_pk_bf16_f32 v95, v46, v47
v_pk_mul_f32 v[40:41], v[44:45], v[200:201] op_sel:[0,0] op_sel_hi:[1,0]
v_pk_mul_f32 v[42:43], v[46:47], v[202:203] op_sel:[0,0] op_sel_hi:[1,0]
v_pk_fma_f32 v[40:41], v[44:45], v[200:201], v[40:41] op_sel:[1,1,0] op_sel_hi:[0,1,1] neg_lo:[1,0,0]
v_pk_fma_f32 v[42:43], v[46:47], v[202:203], v[42:43] op_sel:[1,1,0] op_sel_hi:[0,1,1] neg_lo:[1,0,0]
v_cvt_pk_bf16_f32 v96, v40, v41
v_cvt_pk_bf16_f32 v97, v42, v43
v_pk_mul_f32 v[44:45], v[40:41], v[200:201] op_sel:[0,0] op_sel_hi:[1,0]
v_pk_mul_f32 v[46:47], v[42:43], v[202:203] op_sel:[0,0] op_sel_hi:[1,0]
v_pk_fma_f32 v[44:45], v[40:41], v[200:201], v[44:45] op_sel:[1,1,0] op_sel_hi:[0,1,1] neg_lo:[1,0,0]
v_pk_fma_f32 v[46:47], v[42:43], v[202:203], v[46:47] op_sel:[1,1,0] op_sel_hi:[0,1,1] neg_lo:[1,0,0]
v_cvt_pk_bf16_f32 v98, v44, v45
v_cvt_pk_bf16_f32 v99, v46, v47
ds_write2_b64 v3, v[92:93], v[94:95] offset0:0 offset1:68
ds_write2_b64 v3, v[96:97], v[98:99] offset0:136 offset1:204
buffer_load_dwordx4 a[128:131], v244, s[20:23], s44 offen offset:0 sc1
buffer_load_dwordx4 a[132:135], v244, s[20:23], s45 offen offset:0 sc1
v_cvt_pk_bf16_f32 v84, v204, v205
v_cvt_pk_bf16_f32 v85, v206, v207
v_add_u32 v3, 0x11440, v2
v_cvt_pk_bf16_f32 v86, v208, v209
v_cvt_pk_bf16_f32 v87, v210, v211
v_pk_mul_f32 v[40:41], v[208:209], v[208:209] op_sel:[0,0] op_sel_hi:[1,0]
v_pk_mul_f32 v[42:43], v[210:211], v[210:211] op_sel:[0,0] op_sel_hi:[1,0]
v_pk_fma_f32 v[40:41], v[208:209], v[208:209], v[40:41] op_sel:[1,1,0] op_sel_hi:[0,1,1] neg_lo:[1,0,0]
v_pk_fma_f32 v[42:43], v[210:211], v[210:211], v[42:43] op_sel:[1,1,0] op_sel_hi:[0,1,1] neg_lo:[1,0,0]
v_cvt_pk_bf16_f32 v88, v40, v41
v_cvt_pk_bf16_f32 v89, v42, v43
v_pk_mul_f32 v[44:45], v[40:41], v[208:209] op_sel:[0,0] op_sel_hi:[1,0]
v_pk_mul_f32 v[46:47], v[42:43], v[210:211] op_sel:[0,0] op_sel_hi:[1,0]
v_pk_fma_f32 v[44:45], v[40:41], v[208:209], v[44:45] op_sel:[1,1,0] op_sel_hi:[0,1,1] neg_lo:[1,0,0]
v_pk_fma_f32 v[46:47], v[42:43], v[210:211], v[46:47] op_sel:[1,1,0] op_sel_hi:[0,1,1] neg_lo:[1,0,0]
v_cvt_pk_bf16_f32 v90, v44, v45
v_cvt_pk_bf16_f32 v91, v46, v47
ds_write2_b64 v3, v[84:85], v[86:87] offset0:0 offset1:68
ds_write2_b64 v3, v[88:89], v[90:91] offset0:136 offset1:204
buffer_load_dwordx4 a[136:139], v244, s[20:23], s46 offen offset:0 sc1
buffer_load_dwordx4 a[140:143], v244, s[20:23], s47 offen offset:0 sc1
buffer_load_dwordx4 a[144:147], v244, s[20:23], s44 offen offset:1024 sc1
v_pk_mul_f32 v[40:41], v[44:45], v[208:209] op_sel:[0,0] op_sel_hi:[1,0]
v_pk_mul_f32 v[42:43], v[46:47], v[210:211] op_sel:[0,0] op_sel_hi:[1,0]
v_pk_fma_f32 v[40:41], v[44:45], v[208:209], v[40:41] op_sel:[1,1,0] op_sel_hi:[0,1,1] neg_lo:[1,0,0]
v_pk_fma_f32 v[42:43], v[46:47], v[210:211], v[42:43] op_sel:[1,1,0] op_sel_hi:[0,1,1] neg_lo:[1,0,0]
v_cvt_pk_bf16_f32 v92, v40, v41
v_cvt_pk_bf16_f32 v93, v42, v43
v_add_u32 v3, 0x11cc0, v2
v_pk_mul_f32 v[44:45], v[40:41], v[208:209] op_sel:[0,0] op_sel_hi:[1,0]
v_pk_mul_f32 v[46:47], v[42:43], v[210:211] op_sel:[0,0] op_sel_hi:[1,0]
v_pk_fma_f32 v[44:45], v[40:41], v[208:209], v[44:45] op_sel:[1,1,0] op_sel_hi:[0,1,1] neg_lo:[1,0,0]
v_pk_fma_f32 v[46:47], v[42:43], v[210:211], v[46:47] op_sel:[1,1,0] op_sel_hi:[0,1,1] neg_lo:[1,0,0]
v_cvt_pk_bf16_f32 v94, v44, v45
v_cvt_pk_bf16_f32 v95, v46, v47
v_pk_mul_f32 v[40:41], v[44:45], v[208:209] op_sel:[0,0] op_sel_hi:[1,0]
v_pk_mul_f32 v[42:43], v[46:47], v[210:211] op_sel:[0,0] op_sel_hi:[1,0]
v_pk_fma_f32 v[40:41], v[44:45], v[208:209], v[40:41] op_sel:[1,1,0] op_sel_hi:[0,1,1] neg_lo:[1,0,0]
v_pk_fma_f32 v[42:43], v[46:47], v[210:211], v[42:43] op_sel:[1,1,0] op_sel_hi:[0,1,1] neg_lo:[1,0,0]
v_cvt_pk_bf16_f32 v96, v40, v41
v_cvt_pk_bf16_f32 v97, v42, v43
v_pk_mul_f32 v[44:45], v[40:41], v[208:209] op_sel:[0,0] op_sel_hi:[1,0]
v_pk_mul_f32 v[46:47], v[42:43], v[210:211] op_sel:[0,0] op_sel_hi:[1,0]
v_pk_fma_f32 v[44:45], v[40:41], v[208:209], v[44:45] op_sel:[1,1,0] op_sel_hi:[0,1,1] neg_lo:[1,0,0]
v_pk_fma_f32 v[46:47], v[42:43], v[210:211], v[46:47] op_sel:[1,1,0] op_sel_hi:[0,1,1] neg_lo:[1,0,0]
v_cvt_pk_bf16_f32 v98, v44, v45
v_cvt_pk_bf16_f32 v99, v46, v47
ds_write2_b64 v3, v[92:93], v[94:95] offset0:0 offset1:68
ds_write2_b64 v3, v[96:97], v[98:99] offset0:136 offset1:204
buffer_load_dwordx4 a[148:151], v244, s[20:23], s45 offen offset:1024 sc1
buffer_load_dwordx4 a[152:155], v244, s[20:23], s46 offen offset:1024 sc1
v_pk_mul_f32 v[40:41], v[44:45], v[208:209] op_sel:[0,0] op_sel_hi:[1,0]
v_pk_mul_f32 v[42:43], v[46:47], v[210:211] op_sel:[0,0] op_sel_hi:[1,0]
v_pk_fma_f32 v[40:41], v[44:45], v[208:209], v[40:41] op_sel:[1,1,0] op_sel_hi:[0,1,1] neg_lo:[1,0,0]
v_pk_fma_f32 v[42:43], v[46:47], v[210:211], v[42:43] op_sel:[1,1,0] op_sel_hi:[0,1,1] neg_lo:[1,0,0]
v_cvt_pk_bf16_f32 v84, v40, v41
v_cvt_pk_bf16_f32 v85, v42, v43
v_add_u32 v3, 0x12540, v2
v_pk_mul_f32 v[44:45], v[40:41], v[208:209] op_sel:[0,0] op_sel_hi:[1,0]
v_pk_mul_f32 v[46:47], v[42:43], v[210:211] op_sel:[0,0] op_sel_hi:[1,0]
v_pk_fma_f32 v[44:45], v[40:41], v[208:209], v[44:45] op_sel:[1,1,0] op_sel_hi:[0,1,1] neg_lo:[1,0,0]
v_pk_fma_f32 v[46:47], v[42:43], v[210:211], v[46:47] op_sel:[1,1,0] op_sel_hi:[0,1,1] neg_lo:[1,0,0]
v_cvt_pk_bf16_f32 v86, v44, v45
v_cvt_pk_bf16_f32 v87, v46, v47
v_pk_mul_f32 v[40:41], v[44:45], v[208:209] op_sel:[0,0] op_sel_hi:[1,0]
v_pk_mul_f32 v[42:43], v[46:47], v[210:211] op_sel:[0,0] op_sel_hi:[1,0]
v_pk_fma_f32 v[40:41], v[44:45], v[208:209], v[40:41] op_sel:[1,1,0] op_sel_hi:[0,1,1] neg_lo:[1,0,0]
v_pk_fma_f32 v[42:43], v[46:47], v[210:211], v[42:43] op_sel:[1,1,0] op_sel_hi:[0,1,1] neg_lo:[1,0,0]
v_cvt_pk_bf16_f32 v88, v40, v41
v_cvt_pk_bf16_f32 v89, v42, v43
v_pk_mul_f32 v[44:45], v[40:41], v[208:209] op_sel:[0,0] op_sel_hi:[1,0]
v_pk_mul_f32 v[46:47], v[42:43], v[210:211] op_sel:[0,0] op_sel_hi:[1,0]
v_pk_fma_f32 v[44:45], v[40:41], v[208:209], v[44:45] op_sel:[1,1,0] op_sel_hi:[0,1,1] neg_lo:[1,0,0]
v_pk_fma_f32 v[46:47], v[42:43], v[210:211], v[46:47] op_sel:[1,1,0] op_sel_hi:[0,1,1] neg_lo:[1,0,0]
v_cvt_pk_bf16_f32 v90, v44, v45
v_cvt_pk_bf16_f32 v91, v46, v47
ds_write2_b64 v3, v[84:85], v[86:87] offset0:0 offset1:68
ds_write2_b64 v3, v[88:89], v[90:91] offset0:136 offset1:204
buffer_load_dwordx4 a[156:159], v244, s[20:23], s47 offen offset:1024 sc1
buffer_load_dwordx4 a[192:195], v245, s[20:23], s44 offen offset:0 sc1
v_pk_mul_f32 v[40:41], v[44:45], v[208:209] op_sel:[0,0] op_sel_hi:[1,0]
v_pk_mul_f32 v[42:43], v[46:47], v[210:211] op_sel:[0,0] op_sel_hi:[1,0]
v_pk_fma_f32 v[40:41], v[44:45], v[208:209], v[40:41] op_sel:[1,1,0] op_sel_hi:[0,1,1] neg_lo:[1,0,0]
v_pk_fma_f32 v[42:43], v[46:47], v[210:211], v[42:43] op_sel:[1,1,0] op_sel_hi:[0,1,1] neg_lo:[1,0,0]
v_cvt_pk_bf16_f32 v92, v40, v41
v_cvt_pk_bf16_f32 v93, v42, v43
v_add_u32 v3, 0x12dc0, v2
v_pk_mul_f32 v[44:45], v[40:41], v[208:209] op_sel:[0,0] op_sel_hi:[1,0]
v_pk_mul_f32 v[46:47], v[42:43], v[210:211] op_sel:[0,0] op_sel_hi:[1,0]
v_pk_fma_f32 v[44:45], v[40:41], v[208:209], v[44:45] op_sel:[1,1,0] op_sel_hi:[0,1,1] neg_lo:[1,0,0]
v_pk_fma_f32 v[46:47], v[42:43], v[210:211], v[46:47] op_sel:[1,1,0] op_sel_hi:[0,1,1] neg_lo:[1,0,0]
v_cvt_pk_bf16_f32 v94, v44, v45
v_cvt_pk_bf16_f32 v95, v46, v47
v_pk_mul_f32 v[40:41], v[44:45], v[208:209] op_sel:[0,0] op_sel_hi:[1,0]
v_pk_mul_f32 v[42:43], v[46:47], v[210:211] op_sel:[0,0] op_sel_hi:[1,0]
v_pk_fma_f32 v[40:41], v[44:45], v[208:209], v[40:41] op_sel:[1,1,0] op_sel_hi:[0,1,1] neg_lo:[1,0,0]
v_pk_fma_f32 v[42:43], v[46:47], v[210:211], v[42:43] op_sel:[1,1,0] op_sel_hi:[0,1,1] neg_lo:[1,0,0]
v_cvt_pk_bf16_f32 v96, v40, v41
v_cvt_pk_bf16_f32 v97, v42, v43
v_pk_mul_f32 v[44:45], v[40:41], v[208:209] op_sel:[0,0] op_sel_hi:[1,0]
v_pk_mul_f32 v[46:47], v[42:43], v[210:211] op_sel:[0,0] op_sel_hi:[1,0]
v_pk_fma_f32 v[44:45], v[40:41], v[208:209], v[44:45] op_sel:[1,1,0] op_sel_hi:[0,1,1] neg_lo:[1,0,0]
v_pk_fma_f32 v[46:47], v[42:43], v[210:211], v[46:47] op_sel:[1,1,0] op_sel_hi:[0,1,1] neg_lo:[1,0,0]
v_cvt_pk_bf16_f32 v98, v44, v45
v_cvt_pk_bf16_f32 v99, v46, v47
ds_write2_b64 v3, v[92:93], v[94:95] offset0:0 offset1:68
ds_write2_b64 v3, v[96:97], v[98:99] offset0:136 offset1:204
buffer_load_dwordx4 a[196:199], v245, s[20:23], s45 offen offset:0 sc1
buffer_load_dwordx4 a[200:203], v245, s[20:23], s46 offen offset:0 sc1
s_branch KF_join
s_nop 0
KF_p2:
PAD_9:
s_cmp_lg_u32 s73, 0
s_cbranch_scc1 PAD_13
v_cvt_pk_bf16_f32 v84, v188, v189
v_cvt_pk_bf16_f32 v85, v190, v191
v_add_u32 v3, 0x4400, v2
v_pk_mul_f32 v[40:41], v[188:189], v[192:193] op_sel:[0,0] op_sel_hi:[1,0]
v_pk_mul_f32 v[42:43], v[190:191], v[194:195] op_sel:[0,0] op_sel_hi:[1,0]
v_pk_fma_f32 v[40:41], v[188:189], v[192:193], v[40:41] op_sel:[1,1,0] op_sel_hi:[0,1,1] neg_lo:[1,0,0]
v_pk_fma_f32 v[42:43], v[190:191], v[194:195], v[42:43] op_sel:[1,1,0] op_sel_hi:[0,1,1] neg_lo:[1,0,0]
v_cvt_pk_bf16_f32 v86, v40, v41
v_cvt_pk_bf16_f32 v87, v42, v43
v_pk_mul_f32 v[44:45], v[40:41], v[192:193] op_sel:[0,0] op_sel_hi:[1,0]
v_pk_mul_f32 v[46:47], v[42:43], v[194:195] op_sel:[0,0] op_sel_hi:[1,0]
v_pk_fma_f32 v[44:45], v[40:41], v[192:193], v[44:45] op_sel:[1,1,0] op_sel_hi:[0,1,1] neg_lo:[1,0,0]
v_pk_fma_f32 v[46:47], v[42:43], v[194:195], v[46:47] op_sel:[1,1,0] op_sel_hi:[0,1,1] neg_lo:[1,0,0]
v_cvt_pk_bf16_f32 v88, v44, v45
v_cvt_pk_bf16_f32 v89, v46, v47
v_pk_mul_f32 v[40:41], v[44:45], v[192:193] op_sel:[0,0] op_sel_hi:[1,0]
v_pk_mul_f32 v[42:43], v[46:47], v[194:195] op_sel:[0,0] op_sel_hi:[1,0]
v_pk_fma_f32 v[40:41], v[44:45], v[192:193], v[40:41] op_sel:[1,1,0] op_sel_hi:[0,1,1] neg_lo:[1,0,0]
v_pk_fma_f32 v[42:43], v[46:47], v[194:195], v[42:43] op_sel:[1,1,0] op_sel_hi:[0,1,1] neg_lo:[1,0,0]
v_cvt_pk_bf16_f32 v90, v40, v41
v_cvt_pk_bf16_f32 v91, v42, v43
ds_write2_b64 v3, v[84:85], v[86:87] offset0:0 offset1:68
ds_write2_b64 v3, v[88:89], v[90:91] offset0:136 offset1:204
buffer_load_dwordx4 a[0:3], v242, s[20:23], s44 offen offset:0 sc1
buffer_load_dwordx4 a[4:7], v242, s[20:23], s45 offen offset:0 sc1
buffer_load_dwordx4 a[8:11], v242, s[20:23], s46 offen offset:0 sc1
v_pk_mul_f32 v[44:45], v[40:41], v[192:193] op_sel:[0,0] op_sel_hi:[1,0]
v_pk_mul_f32 v[46:47], v[42:43], v[194:195] op_sel:[0,0] op_sel_hi:[1,0]
v_pk_fma_f32 v[44:45], v[40:41], v[192:193], v[44:45] op_sel:[1,1,0] op_sel_hi:[0,1,1] neg_lo:[1,0,0]
v_pk_fma_f32 v[46:47], v[42:43], v[194:195], v[46:47] op_sel:[1,1,0] op_sel_hi:[0,1,1] neg_lo:[1,0,0]
v_cvt_pk_bf16_f32 v92, v44, v45
v_cvt_pk_bf16_f32 v93, v46, v47
v_add_u32 v3, 0x4c80, v2
v_pk_mul_f32 v[40:41], v[44:45], v[192:193] op_sel:[0,0] op_sel_hi:[1,0]
v_pk_mul_f32 v[42:43], v[46:47], v[194:195] op_sel:[0,0] op_sel_hi:[1,0]
v_pk_fma_f32 v[40:41], v[44:45], v[192:193], v[40:41] op_sel:[1,1,0] op_sel_hi:[0,1,1] neg_lo:[1,0,0]
v_pk_fma_f32 v[42:43], v[46:47], v[194:195], v[42:43] op_sel:[1,1,0] op_sel_hi:[0,1,1] neg_lo:[1,0,0]
v_cvt_pk_bf16_f32 v94, v40, v41
v_cvt_pk_bf16_f32 v95, v42, v43
v_pk_mul_f32 v[44:45], v[40:41], v[192:193] op_sel:[0,0] op_sel_hi:[1,0]
v_pk_mul_f32 v[46:47], v[42:43], v[194:195] op_sel:[0,0] op_sel_hi:[1,0]
v_pk_fma_f32 v[44:45], v[40:41], v[192:193], v[44:45] op_sel:[1,1,0] op_sel_hi:[0,1,1] neg_lo:[1,0,0]
v_pk_fma_f32 v[46:47], v[42:43], v[194:195], v[46:47] op_sel:[1,1,0] op_sel_hi:[0,1,1] neg_lo:[1,0,0]
v_cvt_pk_bf16_f32 v96, v44, v45
v_cvt_pk_bf16_f32 v97, v46, v47
v_pk_mul_f32 v[40:41], v[44:45], v[192:193] op_sel:[0,0] op_sel_hi:[1,0]
v_pk_mul_f32 v[42:43], v[46:47], v[194:195] op_sel:[0,0] op_sel_hi:[1,0]
v_pk_fma_f32 v[40:41], v[44:45], v[192:193], v[40:41] op_sel:[1,1,0] op_sel_hi:[0,1,1] neg_lo:[1,0,0]
v_pk_fma_f32 v[42:43], v[46:47], v[194:195], v[42:43] op_sel:[1,1,0] op_sel_hi:[0,1,1] neg_lo:[1,0,0]
v_cvt_pk_bf16_f32 v98, v40, v41
v_cvt_pk_bf16_f32 v99, v42, v43
ds_write2_b64 v3, v[92:93], v[94:95] offset0:0 offset1:68
ds_write2_b64 v3, v[96:97], v[98:99] offset0:136 offset1:204
buffer_load_dwordx4 a[12:15], v242, s[20:23], s47 offen offset:0 sc1
buffer_load_dwordx4 a[16:19], v242, s[20:23], s44 offen offset:1024 sc1
buffer_load_dwordx4 a[20:23], v242, s[20:23], s45 offen offset:1024 sc1
v_pk_mul_f32 v[52:53], v[192:193], v[192:193] op_sel:[0,0] op_sel_hi:[1,0]
v_pk_mul_f32 v[54:55], v[194:195], v[194:195] op_sel:[0,0] op_sel_hi:[1,0]
v_pk_fma_f32 v[52:53], v[192:193], v[192:193], v[52:53] op_sel:[1,1,0] op_sel_hi:[0,1,1] neg_lo:[1,0,0]
v_pk_fma_f32 v[54:55], v[194:195], v[194:195], v[54:55] op_sel:[1,1,0] op_sel_hi:[0,1,1] neg_lo:[1,0,0]
v_pk_mul_f32 v[56:57], v[188:189], v[188:189] op_sel:[0,0] op_sel_hi:[1,0]
v_pk_mul_f32 v[58:59], v[190:191], v[190:191] op_sel:[0,0] op_sel_hi:[1,0]
v_pk_fma_f32 v[56:57], v[188:189], v[188:189], v[56:57] op_sel:[1,1,0] op_sel_hi:[0,1,1] neg_lo:[1,0,0]
v_pk_fma_f32 v[58:59], v[190:191], v[190:191], v[58:59] op_sel:[1,1,0] op_sel_hi:[0,1,1] neg_lo:[1,0,0]
v_cvt_pk_bf16_f32 v84, v56, v57
v_cvt_pk_bf16_f32 v85, v58, v59
v_add_u32 v3, 0x5500, v2
v_pk_mul_f32 v[40:41], v[56:57], v[52:53] op_sel:[0,0] op_sel_hi:[1,0]
v_pk_mul_f32 v[42:43], v[58:59], v[54:55] op_sel:[0,0] op_sel_hi:[1,0]
v_pk_fma_f32 v[40:41], v[56:57], v[52:53], v[40:41] op_sel:[1,1,0] op_sel_hi:[0,1,1] neg_lo:[1,0,0]
v_pk_fma_f32 v[42:43], v[58:59], v[54:55], v[42:43] op_sel:[1,1,0] op_sel_hi:[0,1,1] neg_lo:[1,0,0]
v_cvt_pk_bf16_f32 v86, v40, v41
v_cvt_pk_bf16_f32 v87, v42, v43
v_pk_mul_f32 v[44:45], v[40:41], v[52:53] op_sel:[0,0] op_sel_hi:[1,0]
v_pk_mul_f32 v[46:47], v[42:43], v[54:55] op_sel:[0,0] op_sel_hi:[1,0]
v_pk_fma_f32 v[44:45], v[40:41], v[52:53], v[44:45] op_sel:[1,1,0] op_sel_hi:[0,1,1] neg_lo:[1,0,0]
v_pk_fma_f32 v[46:47], v[42:43], v[54:55], v[46:47] op_sel:[1,1,0] op_sel_hi:[0,1,1] neg_lo:[1,0,0]
v_cvt_pk_bf16_f32 v88, v44, v45
v_cvt_pk_bf16_f32 v89, v46, v47
v_pk_mul_f32 v[40:41], v[44:45], v[52:53] op_sel:[0,0] op_sel_hi:[1,0]
v_pk_mul_f32 v[42:43], v[46:47], v[54:55] op_sel:[0,0] op_sel_hi:[1,0]
v_pk_fma_f32 v[40:41], v[44:45], v[52:53], v[40:41] op_sel:[1,1,0] op_sel_hi:[0,1,1] neg_lo:[1,0,0]
v_pk_fma_f32 v[42:43], v[46:47], v[54:55], v[42:43] op_sel:[1,1,0] op_sel_hi:[0,1,1] neg_lo:[1,0,0]
v_cvt_pk_bf16_f32 v90, v40, v41
v_cvt_pk_bf16_f32 v91, v42, v43
ds_write2_b64 v3, v[84:85], v[86:87] offset0:0 offset1:68
ds_write2_b64 v3, v[88:89], v[90:91] offset0:136 offset1:204
buffer_load_dwordx4 a[24:27], v242, s[20:23], s46 offen offset:1024 sc1
buffer_load_dwordx4 a[28:31], v242, s[20:23], s47 offen offset:1024 sc1
buffer_load_dwordx4 a[64:67], v243, s[20:23], s44 offen offset:0 sc1
v_cvt_pk_bf16_f32 v92, v196, v197
v_cvt_pk_bf16_f32 v93, v198, v199
v_add_u32 v3, 0xbd20, v2
v_pk_mul_f32 v[40:41], v[196:197], v[200:201] op_sel:[0,0] op_sel_hi:[1,0]
v_pk_mul_f32 v[42:43], v[198:199], v[202:203] op_sel:[0,0] op_sel_hi:[1,0]
v_pk_fma_f32 v[40:41], v[196:197], v[200:201], v[40:41] op_sel:[1,1,0] op_sel_hi:[0,1,1] neg_lo:[1,0,0]
v_pk_fma_f32 v[42:43], v[198:199], v[202:203], v[42:43] op_sel:[1,1,0] op_sel_hi:[0,1,1] neg_lo:[1,0,0]
v_cvt_pk_bf16_f32 v94, v40, v41
v_cvt_pk_bf16_f32 v95, v42, v43
v_pk_mul_f32 v[44:45], v[40:41], v[200:201] op_sel:[0,0] op_sel_hi:[1,0]
v_pk_mul_f32 v[46:47], v[42:43], v[202:203] op_sel:[0,0] op_sel_hi:[1,0]
v_pk_fma_f32 v[44:45], v[40:41], v[200:201], v[44:45] op_sel:[1,1,0] op_sel_hi:[0,1,1] neg_lo:[1,0,0]
v_pk_fma_f32 v[46:47], v[42:43], v[202:203], v[46:47] op_sel:[1,1,0] op_sel_hi:[0,1,1] neg_lo:[1,0,0]
v_cvt_pk_bf16_f32 v96, v44, v45
v_cvt_pk_bf16_f32 v97, v46, v47
v_pk_mul_f32 v[40:41], v[44:45], v[200:201] op_sel:[0,0] op_sel_hi:[1,0]
v_pk_mul_f32 v[42:43], v[46:47], v[202:203] op_sel:[0,0] op_sel_hi:[1,0]
v_pk_fma_f32 v[40:41], v[44:45], v[200:201], v[40:41] op_sel:[1,1,0] op_sel_hi:[0,1,1] neg_lo:[1,0,0]
v_pk_fma_f32 v[42:43], v[46:47], v[202:203], v[42:43] op_sel:[1,1,0] op_sel_hi:[0,1,1] neg_lo:[1,0,0]
v_cvt_pk_bf16_f32 v98, v40, v41
v_cvt_pk_bf16_f32 v99, v42, v43
ds_write2_b64 v3, v[92:93], v[94:95] offset0:0 offset1:68
ds_write2_b64 v3, v[96:97], v[98:99] offset0:136 offset1:204
buffer_load_dwordx4 a[68:71], v243, s[20:23], s45 offen offset:0 sc1
buffer_load_dwordx4 a[72:75], v243, s[20:23], s46 offen offset:0 sc1
buffer_load_dwordx4 a[76:79], v243, s[20:23], s47 offen offset:0 sc1
v_pk_mul_f32 v[44:45], v[40:41], v[200:201] op_sel:[0,0] op_sel_hi:[1,0]
v_pk_mul_f32 v[46:47], v[42:43], v[202:203] op_sel:[0,0] op_sel_hi:[1,0]
v_pk_fma_f32 v[44:45], v[40:41], v[200:201], v[44:45] op_sel:[1,1,0] op_sel_hi:[0,1,1] neg_lo:[1,0,0]
v_pk_fma_f32 v[46:47], v[42:43], v[202:203], v[46:47] op_sel:[1,1,0] op_sel_hi:[0,1,1] neg_lo:[1,0,0]
v_cvt_pk_bf16_f32 v84, v44, v45
v_cvt_pk_bf16_f32 v85, v46, v47
v_add_u32 v3, 0xc5a0, v2
v_pk_mul_f32 v[40:41], v[44:45], v[200:201] op_sel:[0,0] op_sel_hi:[1,0]
v_pk_mul_f32 v[42:43], v[46:47], v[202:203] op_sel:[0,0] op_sel_hi:[1,0]
v_pk_fma_f32 v[40:41], v[44:45], v[200:201], v[40:41] op_sel:[1,1,0] op_sel_hi:[0,1,1] neg_lo:[1,0,0]
v_pk_fma_f32 v[42:43], v[46:47], v[202:203], v[42:43] op_sel:[1,1,0] op_sel_hi:[0,1,1] neg_lo:[1,0,0]
v_cvt_pk_bf16_f32 v86, v40, v41
v_cvt_pk_bf16_f32 v87, v42, v43
v_pk_mul_f32 v[44:45], v[40:41], v[200:201] op_sel:[0,0] op_sel_hi:[1,0]
v_pk_mul_f32 v[46:47], v[42:43], v[202:203] op_sel:[0,0] op_sel_hi:[1,0]
v_pk_fma_f32 v[44:45], v[40:41], v[200:201], v[44:45] op_sel:[1,1,0] op_sel_hi:[0,1,1] neg_lo:[1,0,0]
v_pk_fma_f32 v[46:47], v[42:43], v[202:203], v[46:47] op_sel:[1,1,0] op_sel_hi:[0,1,1] neg_lo:[1,0,0]
v_cvt_pk_bf16_f32 v88, v44, v45
v_cvt_pk_bf16_f32 v89, v46, v47
v_pk_mul_f32 v[40:41], v[44:45], v[200:201] op_sel:[0,0] op_sel_hi:[1,0]
v_pk_mul_f32 v[42:43], v[46:47], v[202:203] op_sel:[0,0] op_sel_hi:[1,0]
v_pk_fma_f32 v[40:41], v[44:45], v[200:201], v[40:41] op_sel:[1,1,0] op_sel_hi:[0,1,1] neg_lo:[1,0,0]
v_pk_fma_f32 v[42:43], v[46:47], v[202:203], v[42:43] op_sel:[1,1,0] op_sel_hi:[0,1,1] neg_lo:[1,0,0]
v_cvt_pk_bf16_f32 v90, v40, v41
v_cvt_pk_bf16_f32 v91, v42, v43
ds_write2_b64 v3, v[84:85], v[86:87] offset0:0 offset1:68
ds_write2_b64 v3, v[88:89], v[90:91] offset0:136 offset1:204
buffer_load_dwordx4 a[80:83], v243, s[20:23], s44 offen offset:1024 sc1
s_waitcnt vmcnt(13)
s_nop 0
buffer_store_dword v213, v214, s[20:23], s76 offen sc1
buffer_load_dwordx4 a[84:87], v243, s[20:23], s45 offen offset:1024 sc1
buffer_load_dwordx4 a[88:91], v243, s[20:23], s46 offen offset:1024 sc1
v_pk_mul_f32 v[52:53], v[200:201], v[200:201] op_sel:[0,0] op_sel_hi:[1,0]
v_pk_mul_f32 v[54:55], v[202:203], v[202:203] op_sel:[0,0] op_sel_hi:[1,0]
v_pk_fma_f32 v[52:53], v[200:201], v[200:201], v[52:53] op_sel:[1,1,0] op_sel_hi:[0,1,1] neg_lo:[1,0,0]
v_pk_fma_f32 v[54:55], v[202:203], v[202:203], v[54:55] op_sel:[1,1,0] op_sel_hi:[0,1,1] neg_lo:[1,0,0]
v_pk_mul_f32 v[56:57], v[196:197], v[196:197] op_sel:[0,0] op_sel_hi:[1,0]
v_pk_mul_f32 v[58:59], v[198:199], v[198:199] op_sel:[0,0] op_sel_hi:[1,0]
v_pk_fma_f32 v[56:57], v[196:197], v[196:197], v[56:57] op_sel:[1,1,0] op_sel_hi:[0,1,1] neg_lo:[1,0,0]
v_pk_fma_f32 v[58:59], v[198:199], v[198:199], v[58:59] op_sel:[1,1,0] op_sel_hi:[0,1,1] neg_lo:[1,0,0]
v_cvt_pk_bf16_f32 v92, v56, v57
v_cvt_pk_bf16_f32 v93, v58, v59
v_add_u32 v3, 0xce20, v2
v_pk_mul_f32 v[40:41], v[56:57], v[52:53] op_sel:[0,0] op_sel_hi:[1,0]
v_pk_mul_f32 v[42:43], v[58:59], v[54:55] op_sel:[0,0] op_sel_hi:[1,0]
v_pk_fma_f32 v[40:41], v[56:57], v[52:53], v[40:41] op_sel:[1,1,0] op_sel_hi:[0,1,1] neg_lo:[1,0,0]
v_pk_fma_f32 v[42:43], v[58:59], v[54:55], v[42:43] op_sel:[1,1,0] op_sel_hi:[0,1,1] neg_lo:[1,0,0]
v_cvt_pk_bf16_f32 v94, v40, v41
v_cvt_pk_bf16_f32 v95, v42, v43
v_pk_mul_f32 v[44:45], v[40:41], v[52:53] op_sel:[0,0] op_sel_hi:[1,0]
v_pk_mul_f32 v[46:47], v[42:43], v[54:55] op_sel:[0,0] op_sel_hi:[1,0]
v_pk_fma_f32 v[44:45], v[40:41], v[52:53], v[44:45] op_sel:[1,1,0] op_sel_hi:[0,1,1] neg_lo:[1,0,0]
v_pk_fma_f32 v[46:47], v[42:43], v[54:55], v[46:47] op_sel:[1,1,0] op_sel_hi:[0,1,1] neg_lo:[1,0,0]
v_cvt_pk_bf16_f32 v96, v44, v45
v_cvt_pk_bf16_f32 v97, v46, v47
v_pk_mul_f32 v[40:41], v[44:45], v[52:53] op_sel:[0,0] op_sel_hi:[1,0]
v_pk_mul_f32 v[42:43], v[46:47], v[54:55] op_sel:[0,0] op_sel_hi:[1,0]
v_pk_fma_f32 v[40:41], v[44:45], v[52:53], v[40:41] op_sel:[1,1,0] op_sel_hi:[0,1,1] neg_lo:[1,0,0]
v_pk_fma_f32 v[42:43], v[46:47], v[54:55], v[42:43] op_sel:[1,1,0] op_sel_hi:[0,1,1] neg_lo:[1,0,0]
v_cvt_pk_bf16_f32 v98, v40, v41
v_cvt_pk_bf16_f32 v99, v42, v43
ds_write2_b64 v3, v[92:93], v[94:95] offset0:0 offset1:68
ds_write2_b64 v3, v[96:97], v[98:99] offset0:136 offset1:204
buffer_load_dwordx4 a[92:95], v243, s[20:23], s47 offen offset:1024 sc1
buffer_load_dwordx4 a[128:131], v244, s[20:23], s44 offen offset:0 sc1
buffer_load_dwordx4 a[132:135], v244, s[20:23], s45 offen offset:0 sc1
v_cvt_pk_bf16_f32 v84, v204, v205
v_cvt_pk_bf16_f32 v85, v206, v207
v_add_u32 v3, 0x13640, v2
v_pk_mul_f32 v[40:41], v[204:205], v[208:209] op_sel:[0,0] op_sel_hi:[1,0]
v_pk_mul_f32 v[42:43], v[206:207], v[210:211] op_sel:[0,0] op_sel_hi:[1,0]
v_pk_fma_f32 v[40:41], v[204:205], v[208:209], v[40:41] op_sel:[1,1,0] op_sel_hi:[0,1,1] neg_lo:[1,0,0]
v_pk_fma_f32 v[42:43], v[206:207], v[210:211], v[42:43] op_sel:[1,1,0] op_sel_hi:[0,1,1] neg_lo:[1,0,0]
v_cvt_pk_bf16_f32 v86, v40, v41
v_cvt_pk_bf16_f32 v87, v42, v43
v_pk_mul_f32 v[44:45], v[40:41], v[208:209] op_sel:[0,0] op_sel_hi:[1,0]
v_pk_mul_f32 v[46:47], v[42:43], v[210:211] op_sel:[0,0] op_sel_hi:[1,0]
v_pk_fma_f32 v[44:45], v[40:41], v[208:209], v[44:45] op_sel:[1,1,0] op_sel_hi:[0,1,1] neg_lo:[1,0,0]
v_pk_fma_f32 v[46:47], v[42:43], v[210:211], v[46:47] op_sel:[1,1,0] op_sel_hi:[0,1,1] neg_lo:[1,0,0]
v_cvt_pk_bf16_f32 v88, v44, v45
v_cvt_pk_bf16_f32 v89, v46, v47
v_pk_mul_f32 v[40:41], v[44:45], v[208:209] op_sel:[0,0] op_sel_hi:[1,0]
v_pk_mul_f32 v[42:43], v[46:47], v[210:211] op_sel:[0,0] op_sel_hi:[1,0]
v_pk_fma_f32 v[40:41], v[44:45], v[208:209], v[40:41] op_sel:[1,1,0] op_sel_hi:[0,1,1] neg_lo:[1,0,0]
v_pk_fma_f32 v[42:43], v[46:47], v[210:211], v[42:43] op_sel:[1,1,0] op_sel_hi:[0,1,1] neg_lo:[1,0,0]
v_cvt_pk_bf16_f32 v90, v40, v41
v_cvt_pk_bf16_f32 v91, v42, v43
ds_write2_b64 v3, v[84:85], v[86:87] offset0:0 offset1:68
ds_write2_b64 v3, v[88:89], v[90:91] offset0:136 offset1:204
buffer_load_dwordx4 a[136:139], v244, s[20:23], s46 offen offset:0 sc1
buffer_load_dwordx4 a[140:143], v244, s[20:23], s47 offen offset:0 sc1
buffer_load_dwordx4 a[144:147], v244, s[20:23], s44 offen offset:1024 sc1
v_pk_mul_f32 v[44:45], v[40:41], v[208:209] op_sel:[0,0] op_sel_hi:[1,0]
v_pk_mul_f32 v[46:47], v[42:43], v[210:211] op_sel:[0,0] op_sel_hi:[1,0]
v_pk_fma_f32 v[44:45], v[40:41], v[208:209], v[44:45] op_sel:[1,1,0] op_sel_hi:[0,1,1] neg_lo:[1,0,0]
v_pk_fma_f32 v[46:47], v[42:43], v[210:211], v[46:47] op_sel:[1,1,0] op_sel_hi:[0,1,1] neg_lo:[1,0,0]
v_cvt_pk_bf16_f32 v92, v44, v45
v_cvt_pk_bf16_f32 v93, v46, v47
v_add_u32 v3, 0x13ec0, v2
v_pk_mul_f32 v[40:41], v[44:45], v[208:209] op_sel:[0,0] op_sel_hi:[1,0]
v_pk_mul_f32 v[42:43], v[46:47], v[210:211] op_sel:[0,0] op_sel_hi:[1,0]
v_pk_fma_f32 v[40:41], v[44:45], v[208:209], v[40:41] op_sel:[1,1,0] op_sel_hi:[0,1,1] neg_lo:[1,0,0]
v_pk_fma_f32 v[42:43], v[46:47], v[210:211], v[42:43] op_sel:[1,1,0] op_sel_hi:[0,1,1] neg_lo:[1,0,0]
v_cvt_pk_bf16_f32 v94, v40, v41
v_cvt_pk_bf16_f32 v95, v42, v43
v_pk_mul_f32 v[44:45], v[40:41], v[208:209] op_sel:[0,0] op_sel_hi:[1,0]
v_pk_mul_f32 v[46:47], v[42:43], v[210:211] op_sel:[0,0] op_sel_hi:[1,0]
v_pk_fma_f32 v[44:45], v[40:41], v[208:209], v[44:45] op_sel:[1,1,0] op_sel_hi:[0,1,1] neg_lo:[1,0,0]
v_pk_fma_f32 v[46:47], v[42:43], v[210:211], v[46:47] op_sel:[1,1,0] op_sel_hi:[0,1,1] neg_lo:[1,0,0]
v_cvt_pk_bf16_f32 v96, v44, v45
v_cvt_pk_bf16_f32 v97, v46, v47
v_pk_mul_f32 v[40:41], v[44:45], v[208:209] op_sel:[0,0] op_sel_hi:[1,0]
v_pk_mul_f32 v[42:43], v[46:47], v[210:211] op_sel:[0,0] op_sel_hi:[1,0]
v_pk_fma_f32 v[40:41], v[44:45], v[208:209], v[40:41] op_sel:[1,1,0] op_sel_hi:[0,1,1] neg_lo:[1,0,0]
v_pk_fma_f32 v[42:43], v[46:47], v[210:211], v[42:43] op_sel:[1,1,0] op_sel_hi:[0,1,1] neg_lo:[1,0,0]
v_cvt_pk_bf16_f32 v98, v40, v41
v_cvt_pk_bf16_f32 v99, v42, v43
ds_write2_b64 v3, v[92:93], v[94:95] offset0:0 offset1:68
ds_write2_b64 v3, v[96:97], v[98:99] offset0:136 offset1:204
buffer_load_dwordx4 a[148:151], v244, s[20:23], s45 offen offset:1024 sc1
buffer_load_dwordx4 a[152:155], v244, s[20:23], s46 offen offset:1024 sc1
buffer_load_dwordx4 a[156:159], v244, s[20:23], s47 offen offset:1024 sc1
v_pk_mul_f32 v[52:53], v[208:209], v[208:209] op_sel:[0,0] op_sel_hi:[1,0]
v_pk_mul_f32 v[54:55], v[210:211], v[210:211] op_sel:[0,0] op_sel_hi:[1,0]
v_pk_fma_f32 v[52:53], v[208:209], v[208:209], v[52:53] op_sel:[1,1,0] op_sel_hi:[0,1,1] neg_lo:[1,0,0]
v_pk_fma_f32 v[54:55], v[210:211], v[210:211], v[54:55] op_sel:[1,1,0] op_sel_hi:[0,1,1] neg_lo:[1,0,0]
v_pk_mul_f32 v[56:57], v[204:205], v[204:205] op_sel:[0,0] op_sel_hi:[1,0]
v_pk_mul_f32 v[58:59], v[206:207], v[206:207] op_sel:[0,0] op_sel_hi:[1,0]
v_pk_fma_f32 v[56:57], v[204:205], v[204:205], v[56:57] op_sel:[1,1,0] op_sel_hi:[0,1,1] neg_lo:[1,0,0]
v_pk_fma_f32 v[58:59], v[206:207], v[206:207], v[58:59] op_sel:[1,1,0] op_sel_hi:[0,1,1] neg_lo:[1,0,0]
v_cvt_pk_bf16_f32 v84, v56, v57
v_cvt_pk_bf16_f32 v85, v58, v59
v_add_u32 v3, 0x14740, v2
v_pk_mul_f32 v[40:41], v[56:57], v[52:53] op_sel:[0,0] op_sel_hi:[1,0]
v_pk_mul_f32 v[42:43], v[58:59], v[54:55] op_sel:[0,0] op_sel_hi:[1,0]
v_pk_fma_f32 v[40:41], v[56:57], v[52:53], v[40:41] op_sel:[1,1,0] op_sel_hi:[0,1,1] neg_lo:[1,0,0]
v_pk_fma_f32 v[42:43], v[58:59], v[54:55], v[42:43] op_sel:[1,1,0] op_sel_hi:[0,1,1] neg_lo:[1,0,0]
v_cvt_pk_bf16_f32 v86, v40, v41
v_cvt_pk_bf16_f32 v87, v42, v43
v_pk_mul_f32 v[44:45], v[40:41], v[52:53] op_sel:[0,0] op_sel_hi:[1,0]
v_pk_mul_f32 v[46:47], v[42:43], v[54:55] op_sel:[0,0] op_sel_hi:[1,0]
v_pk_fma_f32 v[44:45], v[40:41], v[52:53], v[44:45] op_sel:[1,1,0] op_sel_hi:[0,1,1] neg_lo:[1,0,0]
v_pk_fma_f32 v[46:47], v[42:43], v[54:55], v[46:47] op_sel:[1,1,0] op_sel_hi:[0,1,1] neg_lo:[1,0,0]
v_cvt_pk_bf16_f32 v88, v44, v45
v_cvt_pk_bf16_f32 v89, v46, v47
v_pk_mul_f32 v[40:41], v[44:45], v[52:53] op_sel:[0,0] op_sel_hi:[1,0]
v_pk_mul_f32 v[42:43], v[46:47], v[54:55] op_sel:[0,0] op_sel_hi:[1,0]
v_pk_fma_f32 v[40:41], v[44:45], v[52:53], v[40:41] op_sel:[1,1,0] op_sel_hi:[0,1,1] neg_lo:[1,0,0]
v_pk_fma_f32 v[42:43], v[46:47], v[54:55], v[42:43] op_sel:[1,1,0] op_sel_hi:[0,1,1] neg_lo:[1,0,0]
v_cvt_pk_bf16_f32 v90, v40, v41
v_cvt_pk_bf16_f32 v91, v42, v43
ds_write2_b64 v3, v[84:85], v[86:87] offset0:0 offset1:68
ds_write2_b64 v3, v[88:89], v[90:91] offset0:136 offset1:204
buffer_load_dwordx4 a[192:195], v245, s[20:23], s44 offen offset:0 sc1
buffer_load_dwordx4 a[196:199], v245, s[20:23], s45 offen offset:0 sc1
buffer_load_dwordx4 a[200:203], v245, s[20:23], s46 offen offset:0 sc1
s_branch KF_join
s_nop 0
KF_p3:
PAD_10:
s_cmp_lg_u32 s73, 0
s_cbranch_scc1 PAD_14
v_pk_mul_f32 v[52:53], v[192:193], v[192:193] op_sel:[0,0] op_sel_hi:[1,0]
v_pk_mul_f32 v[54:55], v[194:195], v[194:195] op_sel:[0,0] op_sel_hi:[1,0]
v_pk_fma_f32 v[52:53], v[192:193], v[192:193], v[52:53] op_sel:[1,1,0] op_sel_hi:[0,1,1] neg_lo:[1,0,0]
v_pk_fma_f32 v[54:55], v[194:195], v[194:195], v[54:55] op_sel:[1,1,0] op_sel_hi:[0,1,1] neg_lo:[1,0,0]
v_pk_mul_f32 v[56:57], v[188:189], v[188:189] op_sel:[0,0] op_sel_hi:[1,0]
v_pk_mul_f32 v[58:59], v[190:191], v[190:191] op_sel:[0,0] op_sel_hi:[1,0]
PAD_11:
s_cmp_lg_u32 s73, 0
s_cbranch_scc1 PAD_15
v_pk_fma_f32 v[56:57], v[188:189], v[188:189], v[56:57] op_sel:[1,1,0] op_sel_hi:[0,1,1] neg_lo:[1,0,0]
v_pk_fma_f32 v[58:59], v[190:191], v[190:191], v[58:59] op_sel:[1,1,0] op_sel_hi:[0,1,1] neg_lo:[1,0,0]
v_pk_mul_f32 v[60:61], v[56:57], v[188:189] op_sel:[0,0] op_sel_hi:[1,0]
v_pk_mul_f32 v[62:63], v[58:59], v[190:191] op_sel:[0,0] op_sel_hi:[1,0]
v_pk_fma_f32 v[60:61], v[56:57], v[188:189], v[60:61] op_sel:[1,1,0] op_sel_hi:[0,1,1] neg_lo:[1,0,0]
v_pk_fma_f32 v[62:63], v[58:59], v[190:191], v[62:63] op_sel:[1,1,0] op_sel_hi:[0,1,1] neg_lo:[1,0,0]
v_cvt_pk_bf16_f32 v92, v60, v61
v_cvt_pk_bf16_f32 v93, v62, v63
v_add_u32 v3, 0x5d80, v2
v_pk_mul_f32 v[40:41], v[60:61], v[192:193] op_sel:[0,0] op_sel_hi:[1,0]
v_pk_mul_f32 v[42:43], v[62:63], v[194:195] op_sel:[0,0] op_sel_hi:[1,0]
v_pk_fma_f32 v[40:41], v[60:61], v[192:193], v[40:41] op_sel:[1,1,0] op_sel_hi:[0,1,1] neg_lo:[1,0,0]
v_pk_fma_f32 v[42:43], v[62:63], v[194:195], v[42:43] op_sel:[1,1,0] op_sel_hi:[0,1,1] neg_lo:[1,0,0]
v_cvt_pk_bf16_f32 v94, v40, v41
v_cvt_pk_bf16_f32 v95, v42, v43
v_pk_mul_f32 v[44:45], v[40:41], v[192:193] op_sel:[0,0] op_sel_hi:[1,0]
v_pk_mul_f32 v[46:47], v[42:43], v[194:195] op_sel:[0,0] op_sel_hi:[1,0]
v_pk_fma_f32 v[44:45], v[40:41], v[192:193], v[44:45] op_sel:[1,1,0] op_sel_hi:[0,1,1] neg_lo:[1,0,0]
v_pk_fma_f32 v[46:47], v[42:43], v[194:195], v[46:47] op_sel:[1,1,0] op_sel_hi:[0,1,1] neg_lo:[1,0,0]
v_cvt_pk_bf16_f32 v96, v44, v45
v_cvt_pk_bf16_f32 v97, v46, v47
v_pk_mul_f32 v[40:41], v[44:45], v[192:193] op_sel:[0,0] op_sel_hi:[1,0]
v_pk_mul_f32 v[42:43], v[46:47], v[194:195] op_sel:[0,0] op_sel_hi:[1,0]
v_pk_fma_f32 v[40:41], v[44:45], v[192:193], v[40:41] op_sel:[1,1,0] op_sel_hi:[0,1,1] neg_lo:[1,0,0]
v_pk_fma_f32 v[42:43], v[46:47], v[194:195], v[42:43] op_sel:[1,1,0] op_sel_hi:[0,1,1] neg_lo:[1,0,0]
v_cvt_pk_bf16_f32 v98, v40, v41
v_cvt_pk_bf16_f32 v99, v42, v43
ds_write2_b64 v3, v[92:93], v[94:95] offset0:0 offset1:68
ds_write2_b64 v3, v[96:97], v[98:99] offset0:136 offset1:204
buffer_load_dwordx4 a[0:3], v242, s[20:23], s44 offen offset:0 sc1
buffer_load_dwordx4 a[4:7], v242, s[20:23], s45 offen offset:0 sc1
buffer_load_dwordx4 a[8:11], v242, s[20:23], s46 offen offset:0 sc1
v_pk_mul_f32 v[64:65], v[60:61], v[188:189] op_sel:[0,0] op_sel_hi:[1,0]
v_pk_mul_f32 v[66:67], v[62:63], v[190:191] op_sel:[0,0] op_sel_hi:[1,0]
v_pk_fma_f32 v[64:65], v[60:61], v[188:189], v[64:65] op_sel:[1,1,0] op_sel_hi:[0,1,1] neg_lo:[1,0,0]
v_pk_fma_f32 v[66:67], v[62:63], v[190:191], v[66:67] op_sel:[1,1,0] op_sel_hi:[0,1,1] neg_lo:[1,0,0]
v_cvt_pk_bf16_f32 v84, v64, v65
v_cvt_pk_bf16_f32 v85, v66, v67
v_add_u32 v3, 0x6600, v2
v_pk_mul_f32 v[40:41], v[64:65], v[52:53] op_sel:[0,0] op_sel_hi:[1,0]
v_pk_mul_f32 v[42:43], v[66:67], v[54:55] op_sel:[0,0] op_sel_hi:[1,0]
v_pk_fma_f32 v[40:41], v[64:65], v[52:53], v[40:41] op_sel:[1,1,0] op_sel_hi:[0,1,1] neg_lo:[1,0,0]
v_pk_fma_f32 v[42:43], v[66:67], v[54:55], v[42:43] op_sel:[1,1,0] op_sel_hi:[0,1,1] neg_lo:[1,0,0]
v_cvt_pk_bf16_f32 v86, v40, v41
v_cvt_pk_bf16_f32 v87, v42, v43
v_pk_mul_f32 v[68:69], v[64:65], v[188:189] op_sel:[0,0] op_sel_hi:[1,0]
v_pk_mul_f32 v[70:71], v[66:67], v[190:191] op_sel:[0,0] op_sel_hi:[1,0]
v_pk_fma_f32 v[68:69], v[64:65], v[188:189], v[68:69] op_sel:[1,1,0] op_sel_hi:[0,1,1] neg_lo:[1,0,0]
v_pk_fma_f32 v[70:71], v[66:67], v[190:191], v[70:71] op_sel:[1,1,0] op_sel_hi:[0,1,1] neg_lo:[1,0,0]
v_cvt_pk_bf16_f32 v88, v68, v69
v_cvt_pk_bf16_f32 v89, v70, v71
v_pk_mul_f32 v[40:41], v[68:69], v[52:53] op_sel:[0,0] op_sel_hi:[1,0]
v_pk_mul_f32 v[42:43], v[70:71], v[54:55] op_sel:[0,0] op_sel_hi:[1,0]
v_pk_fma_f32 v[40:41], v[68:69], v[52:53], v[40:41] op_sel:[1,1,0] op_sel_hi:[0,1,1] neg_lo:[1,0,0]
v_pk_fma_f32 v[42:43], v[70:71], v[54:55], v[42:43] op_sel:[1,1,0] op_sel_hi:[0,1,1] neg_lo:[1,0,0]
v_cvt_pk_bf16_f32 v90, v40, v41
v_cvt_pk_bf16_f32 v91, v42, v43
ds_write2_b64 v3, v[84:85], v[86:87] offset0:0 offset1:68
ds_write2_b64 v3, v[88:89], v[90:91] offset0:136 offset1:204
buffer_load_dwordx4 a[12:15], v242, s[20:23], s47 offen offset:0 sc1
buffer_load_dwordx4 a[16:19], v242, s[20:23], s44 offen offset:1024 sc1
v_pk_mul_f32 v[64:65], v[68:69], v[188:189] op_sel:[0,0] op_sel_hi:[1,0]
v_pk_mul_f32 v[66:67], v[70:71], v[190:191] op_sel:[0,0] op_sel_hi:[1,0]
v_pk_fma_f32 v[64:65], v[68:69], v[188:189], v[64:65] op_sel:[1,1,0] op_sel_hi:[0,1,1] neg_lo:[1,0,0]
v_pk_fma_f32 v[66:67], v[70:71], v[190:191], v[66:67] op_sel:[1,1,0] op_sel_hi:[0,1,1] neg_lo:[1,0,0]
v_cvt_pk_bf16_f32 v92, v64, v65
v_cvt_pk_bf16_f32 v93, v66, v67
v_add_u32 v3, 0x6e80, v2
v_pk_mul_f32 v[40:41], v[64:65], v[52:53] op_sel:[0,0] op_sel_hi:[1,0]
v_pk_mul_f32 v[42:43], v[66:67], v[54:55] op_sel:[0,0] op_sel_hi:[1,0]
v_pk_fma_f32 v[40:41], v[64:65], v[52:53], v[40:41] op_sel:[1,1,0] op_sel_hi:[0,1,1] neg_lo:[1,0,0]
v_pk_fma_f32 v[42:43], v[66:67], v[54:55], v[42:43] op_sel:[1,1,0] op_sel_hi:[0,1,1] neg_lo:[1,0,0]
v_cvt_pk_bf16_f32 v94, v40, v41
v_cvt_pk_bf16_f32 v95, v42, v43
v_pk_mul_f32 v[68:69], v[64:65], v[188:189] op_sel:[0,0] op_sel_hi:[1,0]
v_pk_mul_f32 v[70:71], v[66:67], v[190:191] op_sel:[0,0] op_sel_hi:[1,0]
v_pk_fma_f32 v[68:69], v[64:65], v[188:189], v[68:69] op_sel:[1,1,0] op_sel_hi:[0,1,1] neg_lo:[1,0,0]
v_pk_fma_f32 v[70:71], v[66:67], v[190:191], v[70:71] op_sel:[1,1,0] op_sel_hi:[0,1,1] neg_lo:[1,0,0]
v_cvt_pk_bf16_f32 v96, v68, v69
v_cvt_pk_bf16_f32 v97, v70, v71
v_pk_mul_f32 v[40:41], v[68:69], v[52:53] op_sel:[0,0] op_sel_hi:[1,0]
v_pk_mul_f32 v[42:43], v[70:71], v[54:55] op_sel:[0,0] op_sel_hi:[1,0]
v_pk_fma_f32 v[40:41], v[68:69], v[52:53], v[40:41] op_sel:[1,1,0] op_sel_hi:[0,1,1] neg_lo:[1,0,0]
v_pk_fma_f32 v[42:43], v[70:71], v[54:55], v[42:43] op_sel:[1,1,0] op_sel_hi:[0,1,1] neg_lo:[1,0,0]
v_cvt_pk_bf16_f32 v98, v40, v41
v_cvt_pk_bf16_f32 v99, v42, v43
ds_write2_b64 v3, v[92:93], v[94:95] offset0:0 offset1:68
ds_write2_b64 v3, v[96:97], v[98:99] offset0:136 offset1:204
buffer_load_dwordx4 a[20:23], v242, s[20:23], s45 offen offset:1024 sc1
buffer_load_dwordx4 a[24:27], v242, s[20:23], s46 offen offset:1024 sc1
v_pk_mul_f32 v[64:65], v[68:69], v[188:189] op_sel:[0,0] op_sel_hi:[1,0]
v_pk_mul_f32 v[66:67], v[70:71], v[190:191] op_sel:[0,0] op_sel_hi:[1,0]
v_pk_fma_f32 v[64:65], v[68:69], v[188:189], v[64:65] op_sel:[1,1,0] op_sel_hi:[0,1,1] neg_lo:[1,0,0]
v_pk_fma_f32 v[66:67], v[70:71], v[190:191], v[66:67] op_sel:[1,1,0] op_sel_hi:[0,1,1] neg_lo:[1,0,0]
v_cvt_pk_bf16_f32 v84, v64, v65
v_cvt_pk_bf16_f32 v85, v66, v67
v_add_u32 v3, 0x7700, v2
ds_write_b64 v3, v[84:85] offset:0
buffer_load_dwordx4 a[28:31], v242, s[20:23], s47 offen offset:1024 sc1
buffer_load_dwordx4 a[64:67], v243, s[20:23], s44 offen offset:0 sc1
v_pk_mul_f32 v[52:53], v[200:201], v[200:201] op_sel:[0,0] op_sel_hi:[1,0]
v_pk_mul_f32 v[54:55], v[202:203], v[202:203] op_sel:[0,0] op_sel_hi:[1,0]
v_pk_fma_f32 v[52:53], v[200:201], v[200:201], v[52:53] op_sel:[1,1,0] op_sel_hi:[0,1,1] neg_lo:[1,0,0]
v_pk_fma_f32 v[54:55], v[202:203], v[202:203], v[54:55] op_sel:[1,1,0] op_sel_hi:[0,1,1] neg_lo:[1,0,0]
v_pk_mul_f32 v[56:57], v[196:197], v[196:197] op_sel:[0,0] op_sel_hi:[1,0]
v_pk_mul_f32 v[58:59], v[198:199], v[198:199] op_sel:[0,0] op_sel_hi:[1,0]
v_pk_fma_f32 v[56:57], v[196:197], v[196:197], v[56:57] op_sel:[1,1,0] op_sel_hi:[0,1,1] neg_lo:[1,0,0]
v_pk_fma_f32 v[58:59], v[198:199], v[198:199], v[58:59] op_sel:[1,1,0] op_sel_hi:[0,1,1] neg_lo:[1,0,0]
v_pk_mul_f32 v[60:61], v[56:57], v[196:197] op_sel:[0,0] op_sel_hi:[1,0]
v_pk_mul_f32 v[62:63], v[58:59], v[198:199] op_sel:[0,0] op_sel_hi:[1,0]
v_pk_fma_f32 v[60:61], v[56:57], v[196:197], v[60:61] op_sel:[1,1,0] op_sel_hi:[0,1,1] neg_lo:[1,0,0]
v_pk_fma_f32 v[62:63], v[58:59], v[198:199], v[62:63] op_sel:[1,1,0] op_sel_hi:[0,1,1] neg_lo:[1,0,0]
v_cvt_pk_bf16_f32 v86, v60, v61
v_cvt_pk_bf16_f32 v87, v62, v63
v_add_u32 v3, 0xd6a0, v2
v_pk_mul_f32 v[40:41], v[60:61], v[200:201] op_sel:[0,0] op_sel_hi:[1,0]
v_pk_mul_f32 v[42:43], v[62:63], v[202:203] op_sel:[0,0] op_sel_hi:[1,0]
v_pk_fma_f32 v[40:41], v[60:61], v[200:201], v[40:41] op_sel:[1,1,0] op_sel_hi:[0,1,1] neg_lo:[1,0,0]
v_pk_fma_f32 v[42:43], v[62:63], v[202:203], v[42:43] op_sel:[1,1,0] op_sel_hi:[0,1,1] neg_lo:[1,0,0]
v_cvt_pk_bf16_f32 v88, v40, v41
v_cvt_pk_bf16_f32 v89, v42, v43
v_pk_mul_f32 v[44:45], v[40:41], v[200:201] op_sel:[0,0] op_sel_hi:[1,0]
v_pk_mul_f32 v[46:47], v[42:43], v[202:203] op_sel:[0,0] op_sel_hi:[1,0]
v_pk_fma_f32 v[44:45], v[40:41], v[200:201], v[44:45] op_sel:[1,1,0] op_sel_hi:[0,1,1] neg_lo:[1,0,0]
v_pk_fma_f32 v[46:47], v[42:43], v[202:203], v[46:47] op_sel:[1,1,0] op_sel_hi:[0,1,1] neg_lo:[1,0,0]
v_cvt_pk_bf16_f32 v90, v44, v45
v_cvt_pk_bf16_f32 v91, v46, v47
v_pk_mul_f32 v[40:41], v[44:45], v[200:201] op_sel:[0,0] op_sel_hi:[1,0]
v_pk_mul_f32 v[42:43], v[46:47], v[202:203] op_sel:[0,0] op_sel_hi:[1,0]
v_pk_fma_f32 v[40:41], v[44:45], v[200:201], v[40:41] op_sel:[1,1,0] op_sel_hi:[0,1,1] neg_lo:[1,0,0]
v_pk_fma_f32 v[42:43], v[46:47], v[202:203], v[42:43] op_sel:[1,1,0] op_sel_hi:[0,1,1] neg_lo:[1,0,0]
v_cvt_pk_bf16_f32 v92, v40, v41
v_cvt_pk_bf16_f32 v93, v42, v43
ds_write2_b64 v3, v[86:87], v[88:89] offset0:0 offset1:68
ds_write2_b64 v3, v[90:91], v[92:93] offset0:136 offset1:204
buffer_load_dwordx4 a[68:71], v243, s[20:23], s45 offen offset:0 sc1
buffer_load_dwordx4 a[72:75], v243, s[20:23], s46 offen offset:0 sc1
buffer_load_dwordx4 a[76:79], v243, s[20:23], s47 offen offset:0 sc1
v_pk_mul_f32 v[64:65], v[60:61], v[196:197] op_sel:[0,0] op_sel_hi:[1,0]
v_pk_mul_f32 v[66:67], v[62:63], v[198:199] op_sel:[0,0] op_sel_hi:[1,0]
v_pk_fma_f32 v[64:65], v[60:61], v[196:197], v[64:65] op_sel:[1,1,0] op_sel_hi:[0,1,1] neg_lo:[1,0,0]
v_pk_fma_f32 v[66:67], v[62:63], v[198:199], v[66:67] op_sel:[1,1,0] op_sel_hi:[0,1,1] neg_lo:[1,0,0]
v_cvt_pk_bf16_f32 v94, v64, v65
v_cvt_pk_bf16_f32 v95, v66, v67
v_add_u32 v3, 0xdf20, v2
v_pk_mul_f32 v[40:41], v[64:65], v[52:53] op_sel:[0,0] op_sel_hi:[1,0]
v_pk_mul_f32 v[42:43], v[66:67], v[54:55] op_sel:[0,0] op_sel_hi:[1,0]
v_pk_fma_f32 v[40:41], v[64:65], v[52:53], v[40:41] op_sel:[1,1,0] op_sel_hi:[0,1,1] neg_lo:[1,0,0]
v_pk_fma_f32 v[42:43], v[66:67], v[54:55], v[42:43] op_sel:[1,1,0] op_sel_hi:[0,1,1] neg_lo:[1,0,0]
v_cvt_pk_bf16_f32 v96, v40, v41
v_cvt_pk_bf16_f32 v97, v42, v43
v_pk_mul_f32 v[68:69], v[64:65], v[196:197] op_sel:[0,0] op_sel_hi:[1,0]
v_pk_mul_f32 v[70:71], v[66:67], v[198:199] op_sel:[0,0] op_sel_hi:[1,0]
v_pk_fma_f32 v[68:69], v[64:65], v[196:197], v[68:69] op_sel:[1,1,0] op_sel_hi:[0,1,1] neg_lo:[1,0,0]
v_pk_fma_f32 v[70:71], v[66:67], v[198:199], v[70:71] op_sel:[1,1,0] op_sel_hi:[0,1,1] neg_lo:[1,0,0]
v_cvt_pk_bf16_f32 v98, v68, v69
v_cvt_pk_bf16_f32 v99, v70, v71
v_pk_mul_f32 v[40:41], v[68:69], v[52:53] op_sel:[0,0] op_sel_hi:[1,0]
v_pk_mul_f32 v[42:43], v[70:71], v[54:55] op_sel:[0,0] op_sel_hi:[1,0]
v_pk_fma_f32 v[40:41], v[68:69], v[52:53], v[40:41] op_sel:[1,1,0] op_sel_hi:[0,1,1] neg_lo:[1,0,0]
v_pk_fma_f32 v[42:43], v[70:71], v[54:55], v[42:43] op_sel:[1,1,0] op_sel_hi:[0,1,1] neg_lo:[1,0,0]
v_cvt_pk_bf16_f32 v84, v40, v41
v_cvt_pk_bf16_f32 v85, v42, v43
ds_write2_b64 v3, v[94:95], v[96:97] offset0:0 offset1:68
ds_write2_b64 v3, v[98:99], v[84:85] offset0:136 offset1:204
buffer_load_dwordx4 a[80:83], v243, s[20:23], s44 offen offset:1024 sc1
s_waitcnt vmcnt(13)
s_nop 0
buffer_store_dword v213, v214, s[20:23], s76 offen sc1
buffer_load_dwordx4 a[84:87], v243, s[20:23], s45 offen offset:1024 sc1
v_pk_mul_f32 v[64:65], v[68:69], v[196:197] op_sel:[0,0] op_sel_hi:[1,0]
v_pk_mul_f32 v[66:67], v[70:71], v[198:199] op_sel:[0,0] op_sel_hi:[1,0]
v_pk_fma_f32 v[64:65], v[68:69], v[196:197], v[64:65] op_sel:[1,1,0] op_sel_hi:[0,1,1] neg_lo:[1,0,0]
v_pk_fma_f32 v[66:67], v[70:71], v[198:199], v[66:67] op_sel:[1,1,0] op_sel_hi:[0,1,1] neg_lo:[1,0,0]
v_cvt_pk_bf16_f32 v86, v64, v65
v_cvt_pk_bf16_f32 v87, v66, v67
v_add_u32 v3, 0xe7a0, v2
v_pk_mul_f32 v[40:41], v[64:65], v[52:53] op_sel:[0,0] op_sel_hi:[1,0]
v_pk_mul_f32 v[42:43], v[66:67], v[54:55] op_sel:[0,0] op_sel_hi:[1,0]
v_pk_fma_f32 v[40:41], v[64:65], v[52:53], v[40:41] op_sel:[1,1,0] op_sel_hi:[0,1,1] neg_lo:[1,0,0]
v_pk_fma_f32 v[42:43], v[66:67], v[54:55], v[42:43] op_sel:[1,1,0] op_sel_hi:[0,1,1] neg_lo:[1,0,0]
v_cvt_pk_bf16_f32 v88, v40, v41
v_cvt_pk_bf16_f32 v89, v42, v43
v_pk_mul_f32 v[68:69], v[64:65], v[196:197] op_sel:[0,0] op_sel_hi:[1,0]
v_pk_mul_f32 v[70:71], v[66:67], v[198:199] op_sel:[0,0] op_sel_hi:[1,0]
v_pk_fma_f32 v[68:69], v[64:65], v[196:197], v[68:69] op_sel:[1,1,0] op_sel_hi:[0,1,1] neg_lo:[1,0,0]
v_pk_fma_f32 v[70:71], v[66:67], v[198:199], v[70:71] op_sel:[1,1,0] op_sel_hi:[0,1,1] neg_lo:[1,0,0]
v_cvt_pk_bf16_f32 v90, v68, v69
v_cvt_pk_bf16_f32 v91, v70, v71
v_pk_mul_f32 v[40:41], v[68:69], v[52:53] op_sel:[0,0] op_sel_hi:[1,0]
v_pk_mul_f32 v[42:43], v[70:71], v[54:55] op_sel:[0,0] op_sel_hi:[1,0]
v_pk_fma_f32 v[40:41], v[68:69], v[52:53], v[40:41] op_sel:[1,1,0] op_sel_hi:[0,1,1] neg_lo:[1,0,0]
v_pk_fma_f32 v[42:43], v[70:71], v[54:55], v[42:43] op_sel:[1,1,0] op_sel_hi:[0,1,1] neg_lo:[1,0,0]
v_cvt_pk_bf16_f32 v92, v40, v41
v_cvt_pk_bf16_f32 v93, v42, v43
ds_write2_b64 v3, v[86:87], v[88:89] offset0:0 offset1:68
ds_write2_b64 v3, v[90:91], v[92:93] offset0:136 offset1:204
buffer_load_dwordx4 a[88:91], v243, s[20:23], s46 offen offset:1024 sc1
buffer_load_dwordx4 a[92:95], v243, s[20:23], s47 offen offset:1024 sc1
v_pk_mul_f32 v[64:65], v[68:69], v[196:197] op_sel:[0,0] op_sel_hi:[1,0]
v_pk_mul_f32 v[66:67], v[70:71], v[198:199] op_sel:[0,0] op_sel_hi:[1,0]
v_pk_fma_f32 v[64:65], v[68:69], v[196:197], v[64:65] op_sel:[1,1,0] op_sel_hi:[0,1,1] neg_lo:[1,0,0]
v_pk_fma_f32 v[66:67], v[70:71], v[198:199], v[66:67] op_sel:[1,1,0] op_sel_hi:[0,1,1] neg_lo:[1,0,0]
v_cvt_pk_bf16_f32 v94, v64, v65
v_cvt_pk_bf16_f32 v95, v66, v67
v_add_u32 v3, 0xf020, v2
ds_write_b64 v3, v[94:95] offset:0
buffer_load_dwordx4 a[128:131], v244, s[20:23], s44 offen offset:0 sc1
buffer_load_dwordx4 a[132:135], v244, s[20:23], s45 offen offset:0 sc1
v_pk_mul_f32 v[52:53], v[208:209], v[208:209] op_sel:[0,0] op_sel_hi:[1,0]
v_pk_mul_f32 v[54:55], v[210:211], v[210:211] op_sel:[0,0] op_sel_hi:[1,0]
v_pk_fma_f32 v[52:53], v[208:209], v[208:209], v[52:53] op_sel:[1,1,0] op_sel_hi:[0,1,1] neg_lo:[1,0,0]
v_pk_fma_f32 v[54:55], v[210:211], v[210:211], v[54:55] op_sel:[1,1,0] op_sel_hi:[0,1,1] neg_lo:[1,0,0]
v_pk_mul_f32 v[56:57], v[204:205], v[204:205] op_sel:[0,0] op_sel_hi:[1,0]
v_pk_mul_f32 v[58:59], v[206:207], v[206:207] op_sel:[0,0] op_sel_hi:[1,0]
v_pk_fma_f32 v[56:57], v[204:205], v[204:205], v[56:57] op_sel:[1,1,0] op_sel_hi:[0,1,1] neg_lo:[1,0,0]
v_pk_fma_f32 v[58:59], v[206:207], v[206:207], v[58:59] op_sel:[1,1,0] op_sel_hi:[0,1,1] neg_lo:[1,0,0]
v_pk_mul_f32 v[60:61], v[56:57], v[204:205] op_sel:[0,0] op_sel_hi:[1,0]
v_pk_mul_f32 v[62:63], v[58:59], v[206:207] op_sel:[0,0] op_sel_hi:[1,0]
v_pk_fma_f32 v[60:61], v[56:57], v[204:205], v[60:61] op_sel:[1,1,0] op_sel_hi:[0,1,1] neg_lo:[1,0,0]
v_pk_fma_f32 v[62:63], v[58:59], v[206:207], v[62:63] op_sel:[1,1,0] op_sel_hi:[0,1,1] neg_lo:[1,0,0]
v_cvt_pk_bf16_f32 v96, v60, v61
v_cvt_pk_bf16_f32 v97, v62, v63
v_add_u32 v3, 0x14fc0, v2
v_pk_mul_f32 v[40:41], v[60:61], v[208:209] op_sel:[0,0] op_sel_hi:[1,0]
v_pk_mul_f32 v[42:43], v[62:63], v[210:211] op_sel:[0,0] op_sel_hi:[1,0]
v_pk_fma_f32 v[40:41], v[60:61], v[208:209], v[40:41] op_sel:[1,1,0] op_sel_hi:[0,1,1] neg_lo:[1,0,0]
v_pk_fma_f32 v[42:43], v[62:63], v[210:211], v[42:43] op_sel:[1,1,0] op_sel_hi:[0,1,1] neg_lo:[1,0,0]
v_cvt_pk_bf16_f32 v98, v40, v41
v_cvt_pk_bf16_f32 v99, v42, v43
v_pk_mul_f32 v[44:45], v[40:41], v[208:209] op_sel:[0,0] op_sel_hi:[1,0]
v_pk_mul_f32 v[46:47], v[42:43], v[210:211] op_sel:[0,0] op_sel_hi:[1,0]
v_pk_fma_f32 v[44:45], v[40:41], v[208:209], v[44:45] op_sel:[1,1,0] op_sel_hi:[0,1,1] neg_lo:[1,0,0]
v_pk_fma_f32 v[46:47], v[42:43], v[210:211], v[46:47] op_sel:[1,1,0] op_sel_hi:[0,1,1] neg_lo:[1,0,0]
v_cvt_pk_bf16_f32 v84, v44, v45
v_cvt_pk_bf16_f32 v85, v46, v47
v_pk_mul_f32 v[40:41], v[44:45], v[208:209] op_sel:[0,0] op_sel_hi:[1,0]
v_pk_mul_f32 v[42:43], v[46:47], v[210:211] op_sel:[0,0] op_sel_hi:[1,0]
v_pk_fma_f32 v[40:41], v[44:45], v[208:209], v[40:41] op_sel:[1,1,0] op_sel_hi:[0,1,1] neg_lo:[1,0,0]
v_pk_fma_f32 v[42:43], v[46:47], v[210:211], v[42:43] op_sel:[1,1,0] op_sel_hi:[0,1,1] neg_lo:[1,0,0]
v_cvt_pk_bf16_f32 v86, v40, v41
v_cvt_pk_bf16_f32 v87, v42, v43
ds_write2_b64 v3, v[96:97], v[98:99] offset0:0 offset1:68
ds_write2_b64 v3, v[84:85], v[86:87] offset0:136 offset1:204
buffer_load_dwordx4 a[136:139], v244, s[20:23], s46 offen offset:0 sc1
buffer_load_dwordx4 a[140:143], v244, s[20:23], s47 offen offset:0 sc1
buffer_load_dwordx4 a[144:147], v244, s[20:23], s44 offen offset:1024 sc1
v_pk_mul_f32 v[64:65], v[60:61], v[204:205] op_sel:[0,0] op_sel_hi:[1,0]
v_pk_mul_f32 v[66:67], v[62:63], v[206:207] op_sel:[0,0] op_sel_hi:[1,0]
v_pk_fma_f32 v[64:65], v[60:61], v[204:205], v[64:65] op_sel:[1,1,0] op_sel_hi:[0,1,1] neg_lo:[1,0,0]
v_pk_fma_f32 v[66:67], v[62:63], v[206:207], v[66:67] op_sel:[1,1,0] op_sel_hi:[0,1,1] neg_lo:[1,0,0]
v_cvt_pk_bf16_f32 v88, v64, v65
v_cvt_pk_bf16_f32 v89, v66, v67
v_add_u32 v3, 0x15840, v2
v_pk_mul_f32 v[40:41], v[64:65], v[52:53] op_sel:[0,0] op_sel_hi:[1,0]
v_pk_mul_f32 v[42:43], v[66:67], v[54:55] op_sel:[0,0] op_sel_hi:[1,0]
v_pk_fma_f32 v[40:41], v[64:65], v[52:53], v[40:41] op_sel:[1,1,0] op_sel_hi:[0,1,1] neg_lo:[1,0,0]
v_pk_fma_f32 v[42:43], v[66:67], v[54:55], v[42:43] op_sel:[1,1,0] op_sel_hi:[0,1,1] neg_lo:[1,0,0]
v_cvt_pk_bf16_f32 v90, v40, v41
v_cvt_pk_bf16_f32 v91, v42, v43
v_pk_mul_f32 v[68:69], v[64:65], v[204:205] op_sel:[0,0] op_sel_hi:[1,0]
v_pk_mul_f32 v[70:71], v[66:67], v[206:207] op_sel:[0,0] op_sel_hi:[1,0]
v_pk_fma_f32 v[68:69], v[64:65], v[204:205], v[68:69] op_sel:[1,1,0] op_sel_hi:[0,1,1] neg_lo:[1,0,0]
v_pk_fma_f32 v[70:71], v[66:67], v[206:207], v[70:71] op_sel:[1,1,0] op_sel_hi:[0,1,1] neg_lo:[1,0,0]
v_cvt_pk_bf16_f32 v92, v68, v69
v_cvt_pk_bf16_f32 v93, v70, v71
v_pk_mul_f32 v[40:41], v[68:69], v[52:53] op_sel:[0,0] op_sel_hi:[1,0]
v_pk_mul_f32 v[42:43], v[70:71], v[54:55] op_sel:[0,0] op_sel_hi:[1,0]
v_pk_fma_f32 v[40:41], v[68:69], v[52:53], v[40:41] op_sel:[1,1,0] op_sel_hi:[0,1,1] neg_lo:[1,0,0]
v_pk_fma_f32 v[42:43], v[70:71], v[54:55], v[42:43] op_sel:[1,1,0] op_sel_hi:[0,1,1] neg_lo:[1,0,0]
v_cvt_pk_bf16_f32 v94, v40, v41
v_cvt_pk_bf16_f32 v95, v42, v43
ds_write2_b64 v3, v[88:89], v[90:91] offset0:0 offset1:68
ds_write2_b64 v3, v[92:93], v[94:95] offset0:136 offset1:204
buffer_load_dwordx4 a[148:151], v244, s[20:23], s45 offen offset:1024 sc1
buffer_load_dwordx4 a[152:155], v244, s[20:23], s46 offen offset:1024 sc1
v_pk_mul_f32 v[64:65], v[68:69], v[204:205] op_sel:[0,0] op_sel_hi:[1,0]
v_pk_mul_f32 v[66:67], v[70:71], v[206:207] op_sel:[0,0] op_sel_hi:[1,0]
v_pk_fma_f32 v[64:65], v[68:69], v[204:205], v[64:65] op_sel:[1,1,0] op_sel_hi:[0,1,1] neg_lo:[1,0,0]
v_pk_fma_f32 v[66:67], v[70:71], v[206:207], v[66:67] op_sel:[1,1,0] op_sel_hi:[0,1,1] neg_lo:[1,0,0]
v_cvt_pk_bf16_f32 v96, v64, v65
v_cvt_pk_bf16_f32 v97, v66, v67
v_add_u32 v3, 0x160c0, v2
v_pk_mul_f32 v[40:41], v[64:65], v[52:53] op_sel:[0,0] op_sel_hi:[1,0]
v_pk_mul_f32 v[42:43], v[66:67], v[54:55] op_sel:[0,0] op_sel_hi:[1,0]
v_pk_fma_f32 v[40:41], v[64:65], v[52:53], v[40:41] op_sel:[1,1,0] op_sel_hi:[0,1,1] neg_lo:[1,0,0]
v_pk_fma_f32 v[42:43], v[66:67], v[54:55], v[42:43] op_sel:[1,1,0] op_sel_hi:[0,1,1] neg_lo:[1,0,0]
v_cvt_pk_bf16_f32 v98, v40, v41
v_cvt_pk_bf16_f32 v99, v42, v43
v_pk_mul_f32 v[68:69], v[64:65], v[204:205] op_sel:[0,0] op_sel_hi:[1,0]
v_pk_mul_f32 v[70:71], v[66:67], v[206:207] op_sel:[0,0] op_sel_hi:[1,0]
v_pk_fma_f32 v[68:69], v[64:65], v[204:205], v[68:69] op_sel:[1,1,0] op_sel_hi:[0,1,1] neg_lo:[1,0,0]
v_pk_fma_f32 v[70:71], v[66:67], v[206:207], v[70:71] op_sel:[1,1,0] op_sel_hi:[0,1,1] neg_lo:[1,0,0]
v_cvt_pk_bf16_f32 v84, v68, v69
v_cvt_pk_bf16_f32 v85, v70, v71
v_pk_mul_f32 v[40:41], v[68:69], v[52:53] op_sel:[0,0] op_sel_hi:[1,0]
v_pk_mul_f32 v[42:43], v[70:71], v[54:55] op_sel:[0,0] op_sel_hi:[1,0]
v_pk_fma_f32 v[40:41], v[68:69], v[52:53], v[40:41] op_sel:[1,1,0] op_sel_hi:[0,1,1] neg_lo:[1,0,0]
v_pk_fma_f32 v[42:43], v[70:71], v[54:55], v[42:43] op_sel:[1,1,0] op_sel_hi:[0,1,1] neg_lo:[1,0,0]
v_cvt_pk_bf16_f32 v86, v40, v41
v_cvt_pk_bf16_f32 v87, v42, v43
ds_write2_b64 v3, v[96:97], v[98:99] offset0:0 offset1:68
ds_write2_b64 v3, v[84:85], v[86:87] offset0:136 offset1:204
buffer_load_dwordx4 a[156:159], v244, s[20:23], s47 offen offset:1024 sc1
buffer_load_dwordx4 a[192:195], v245, s[20:23], s44 offen offset:0 sc1
v_pk_mul_f32 v[64:65], v[68:69], v[204:205] op_sel:[0,0] op_sel_hi:[1,0]
v_pk_mul_f32 v[66:67], v[70:71], v[206:207] op_sel:[0,0] op_sel_hi:[1,0]
v_pk_fma_f32 v[64:65], v[68:69], v[204:205], v[64:65] op_sel:[1,1,0] op_sel_hi:[0,1,1] neg_lo:[1,0,0]
v_pk_fma_f32 v[66:67], v[70:71], v[206:207], v[66:67] op_sel:[1,1,0] op_sel_hi:[0,1,1] neg_lo:[1,0,0]
v_cvt_pk_bf16_f32 v88, v64, v65
v_cvt_pk_bf16_f32 v89, v66, v67
v_add_u32 v3, 0x16940, v2
ds_write_b64 v3, v[88:89] offset:0
buffer_load_dwordx4 a[196:199], v245, s[20:23], s45 offen offset:0 sc1
buffer_load_dwordx4 a[200:203], v245, s[20:23], s46 offen offset:0 sc1
KF_join:
PAD_12:
s_cmp_lg_u32 s73, 0
s_cbranch_scc1 PAD_16
s_waitcnt lgkmcnt(0)
s_barrier
s_cmp_eq_u32 s3, 3
s_cbranch_scc1 KF_noconv_wave
v_and_b32 v2, 15, v1
v_mul_u32_u24 v3, 544, v2
v_and_b32 v221, 48, v1
s_mul_i32 s56, s3, 31008
v_add3_u32 v3, v3, v221, s56
ds_read_b128 v[68:71], v3 offset:0
ds_read_b128 v[72:75], v3 offset:8704
ds_read_b128 v[76:79], v3 offset:17408
ds_read_b128 v[80:83], v3 offset:26112
ds_read_b128 v[84:87], v3 offset:64
ds_read_b128 v[88:91], v3 offset:8768
ds_read_b128 v[92:95], v3 offset:17472
ds_read_b128 v[96:99], v3 offset:26176
ds_read_b128 v[100:103], v3 offset:128
ds_read_b128 v[104:107], v3 offset:8832
ds_read_b128 v[108:111], v3 offset:17536
ds_read_b128 v[112:115], v3 offset:26240
ds_read_b128 v[116:119], v3 offset:192
ds_read_b128 v[120:123], v3 offset:8896
v_mov_b64 v[196:197], 0
v_mov_b64 v[198:199], 0
s_mul_i32 s56, s3, 12352
s_add_u32 s56, s56, 98304
v_min_u32 v233, 51, v1
v_lshl_add_u32 v229, v233, 4, s56
v_lshrrev_b32 v234, 5, v233
v_add_u32 v233, 20, v233
v_lshrrev_b32 v233, 6, v233
v_add_u32 v233, v233, v234
v_lshl_add_u32 v229, v233, 11, v229
v_sub_u32 v219, 15, v2
v_lshl_add_u32 v219, v219, 5, v221
v_add_u32 v219, s56, v219
s_waitcnt lgkmcnt(10)
v_mfma_f32_16x16x32_bf16 v[36:39], v[72:75], v[68:71], 0
ds_read_b128 v[124:127], v3 offset:17600
v_lshl_add_u32 v226, v2, 6, v221
v_mfma_f32_16x16x32_bf16 v[40:43], v[76:79], v[68:71], 0
ds_read_b128 v[128:131], v3 offset:26304
v_add_u32 v226, s56, v226
v_mfma_f32_16x16x32_bf16 v[44:47], v[80:83], v[68:71], 0
s_waitcnt lgkmcnt(8)
ds_read_b128 v[132:135], v3 offset:256
v_lshl_add_u32 v227, v2, 5, v221
v_mfma_f32_16x16x32_bf16 v[36:39], v[88:91], v[84:87], v[36:39]
ds_read_b128 v[136:139], v3 offset:8960
v_lshlrev_b32 v233, 4, v221
v_mfma_f32_16x16x32_bf16 v[40:43], v[92:95], v[84:87], v[40:43]
ds_read_b128 v[140:143], v3 offset:17664
v_cmp_gt_u32 vcc, 32, v1
v_mfma_f32_16x16x32_bf16 v[44:47], v[96:99], v[84:87], v[44:47]
s_waitcnt lgkmcnt(7)
ds_read_b128 v[144:147], v3 offset:26368
v_lshl_add_u32 v228, v2, 4, v233
v_mfma_f32_16x16x32_bf16 v[36:39], v[104:107], v[100:103], v[36:39]
ds_read_b128 v[148:151], v3 offset:320
v_cndmask_b32 v227, v228, v227, vcc
v_mfma_f32_16x16x32_bf16 v[40:43], v[108:111], v[100:103], v[40:43]
ds_read_b128 v[152:155], v3 offset:9024
v_add_u32 v227, s56, v227
v_mfma_f32_16x16x32_bf16 v[44:47], v[112:115], v[100:103], v[44:47]
s_waitcnt lgkmcnt(6)
ds_read_b128 v[156:159], v3 offset:17728
v_lshl_add_u32 v228, v2, 3, v233
v_mfma_f32_16x16x32_bf16 v[36:39], v[120:123], v[116:119], v[36:39]
s_add_u32 s57, s56, 4576
ds_read_b128 v[160:163], v3 offset:26432
v_add_u32 v228, s56, v228
v_mfma_f32_16x16x32_bf16 v[40:43], v[124:127], v[116:119], v[40:43]
ds_read_b128 v[164:167], v3 offset:384
v_lshl_add_u32 v223, v1, 4, s56
v_mfma_f32_16x16x32_bf16 v[44:47], v[128:131], v[116:119], v[44:47]
s_waitcnt lgkmcnt(5)
ds_read_b128 v[168:171], v3 offset:9088
v_lshl_add_u32 v224, v1, 3, s56
v_mfma_f32_16x16x32_bf16 v[36:39], v[136:139], v[132:135], v[36:39]
ds_read_b128 v[172:175], v3 offset:17792
v_mov_b32 v232, s56
v_mfma_f32_16x16x32_bf16 v[40:43], v[140:143], v[132:135], v[40:43]
ds_read_b128 v[176:179], v3 offset:26496
v_mov_b32 v222, s38
v_mfma_f32_16x16x32_bf16 v[44:47], v[144:147], v[132:135], v[44:47]
s_waitcnt lgkmcnt(4)
ds_read_b128 v[180:183], v3 offset:448
v_cmp_eq_u32 s[52:53], 0, v1
v_mfma_f32_16x16x32_bf16 v[36:39], v[152:155], v[148:151], v[36:39]
ds_read_b128 v[184:187], v3 offset:9152
v_min_u32 v233, 5, v1
v_mfma_f32_16x16x32_bf16 v[40:43], v[156:159], v[148:151], v[40:43]
ds_read_b128 v[188:191], v3 offset:17856
v_lshrrev_b32 v234, 2, v233
v_mfma_f32_16x16x32_bf16 v[44:47], v[160:163], v[148:151], v[44:47]
s_waitcnt lgkmcnt(3)
ds_read_b128 v[192:195], v3 offset:26560
v_cndmask_b32 v222, 0, v222, s[52:53]
v_mfma_f32_16x16x32_bf16 v[36:39], v[168:171], v[164:167], v[36:39]
v_mul_u32_u24 v234, 557, v234
v_add_u32 v233, v233, v234
v_mfma_f32_16x16x32_bf16 v[40:43], v[172:175], v[164:167], v[40:43]
v_cndmask_b32 v233, v233, 48, s[52:53]
v_lshl_add_u32 v230, v233, 2, s56
v_mfma_f32_16x16x32_bf16 v[44:47], v[176:179], v[164:167], v[44:47]
s_waitcnt lgkmcnt(0)
s_barrier
v_cmp_eq_u32 vcc, 3, v1
v_mfma_f32_16x16x32_bf16 v[36:39], v[184:187], v[180:183], v[36:39]
v_mov_b32 v233, 0xffff
v_cndmask_b32 v231, -1, v233, vcc
v_mfma_f32_16x16x32_bf16 v[40:43], v[188:191], v[180:183], v[40:43]
v_and_b32 v233, 1, v1
v_xor_b32 v233, 1, v233
v_mfma_f32_16x16x32_bf16 v[44:47], v[192:195], v[180:183], v[44:47]
v_mul_u32_u24 v233, 2240, v233
v_add_u32 v216, 1, v2
v_lshrrev_b32 v216, 1, v216
v_lshl_add_u32 v216, v216, 2, v221
v_add3_u32 v216, v216, v233, s57
ds_write_b128 v229, v[196:199] offset:4096
buffer_load_dwordx4 a[204:207], v245, s[20:23], s47 offen offset:0 sc1
buffer_load_dwordx4 a[208:211], v245, s[20:23], s44 offen offset:1024 sc1
v_add_f32 v36, v36, v222
ds_write_b128 v227, v[40:43] offset:10304
ds_write_b128 v226, v[36:39] offset:9280
ds_write_b64 v228, v[44:45] offset:11328
ds_write_b64 v228, v[46:47] offset:11456
ds_read_b128 v[116:119], v223 offset:9280
ds_read_b32 v120, v223 offset:9296
ds_read_b32 v121, v232 offset:11328
ds_read_b64 v[124:125], v224 offset:10304
ds_read_b32 v126, v224 offset:10312
ds_read_b64 v[128:129], v224 offset:10816
ds_read_b32 v130, v224 offset:10824
ds_read_b64 v[132:133], v224 offset:11328
ds_read_b32 v134, v224 offset:11336
ds_read_b128 v[84:87], v219 offset:3584
ds_read_b128 v[88:91], v219 offset:3072
ds_read_b128 v[92:95], v219 offset:2560
ds_read_b128 v[96:99], v219 offset:2048
ds_read_b128 v[100:103], v219 offset:1536
ds_read_b128 v[104:107], v219 offset:1024
ds_read_b128 v[108:111], v219 offset:512
ds_read_b128 v[112:115], v219 offset:0
buffer_load_dwordx4 a[212:215], v245, s[20:23], s45 offen offset:1024 sc1
buffer_load_dwordx4 a[216:219], v245, s[20:23], s46 offen offset:1024 sc1
buffer_load_dwordx4 a[220:223], v245, s[20:23], s47 offen offset:1024 sc1
s_waitcnt lgkmcnt(12)
v_cvt_pk_bf16_f32 v140, v116, v117
v_cvt_pk_bf16_f32 v141, v118, v119
v_cvt_pk_bf16_f32 v142, v117, v118
v_cvt_pk_bf16_f32 v143, v119, v120
v_cvt_pk_bf16_f32 v144, v124, v124
v_cvt_pk_bf16_f32 v145, v125, v126
v_cvt_pk_bf16_f32 v146, v124, v125
v_cvt_pk_bf16_f32 v147, v126, v126
v_cvt_pk_bf16_f32 v233, v121, v121
v_cvt_pk_bf16_f32 v234, 0, v116
v_and_b32 v233, v233, v231
v_cndmask_b32 v233, v233, v234, s[52:53]
ds_write_b64 v224, v[140:141] offset:4608
ds_write_b64 v224, v[142:143] offset:6848
ds_write_b32 v230, v233 offset:6652
ds_read2_b32 v[68:69], v216 offset0:0 offset1:1
ds_read2_b32 v[70:71], v216 offset0:2 offset1:3
ds_write_b64 v224, v[144:145] offset:5120
ds_write_b64 v224, v[146:147] offset:7360
ds_read2_b32 v[72:73], v216 offset0:128 offset1:129
ds_read2_b32 v[74:75], v216 offset0:130 offset1:131
s_waitcnt lgkmcnt(4)
v_mfma_f32_16x16x32_bf16 v[36:39], v[68:71], v[84:87], 0
v_add_u32 v217, 1024, v216
v_add_u32 v218, 2048, v216
v_mfma_f32_16x16x32_bf16 v[40:43], v[68:71], v[88:91], 0
v_cvt_pk_bf16_f32 v148, v128, v128
v_cvt_pk_bf16_f32 v149, v128, v129
v_mfma_f32_16x16x32_bf16 v[44:47], v[68:71], v[92:95], 0
v_cvt_pk_bf16_f32 v150, v129, v129
v_cvt_pk_bf16_f32 v151, v130, v130
v_mfma_f32_16x16x32_bf16 v[48:51], v[68:71], v[96:99], 0
ds_write_b128 v223, v[148:151] offset:5632
v_mfma_f32_16x16x32_bf16 v[52:55], v[68:71], v[100:103], 0
s_mov_b32 s57, 0x3f800000
v_cvt_pk_bf16_f32 v152, v128, v128
v_cvt_pk_bf16_f32 v153, v129, v129
v_mfma_f32_16x16x32_bf16 v[56:59], v[68:71], v[104:107], 0
v_cvt_pk_bf16_f32 v154, v129, v130
v_cvt_pk_bf16_f32 v155, v130, v130
v_mfma_f32_16x16x32_bf16 v[60:63], v[68:71], v[108:111], 0
ds_write_b128 v223, v[152:155] offset:7872
v_mfma_f32_16x16x32_bf16 v[64:67], v[68:71], v[112:115], 0
s_waitcnt lgkmcnt(2)
ds_read2_b32 v[76:77], v217 offset0:0 offset1:1
v_cvt_pk_bf16_f32 v233, v133, v134
v_mfma_f32_16x16x32_bf16 v[40:43], v[72:75], v[84:87], v[40:43]
s_add_u32 m0, s34, 0
ds_read2_b32 v[78:79], v217 offset0:2 offset1:3
v_lshl_add_u32 v225, v1, 2, v232
v_mfma_f32_16x16x32_bf16 v[44:47], v[72:75], v[88:91], v[44:47]
s_add_u32 s69, s30, 0
buffer_load_dwordx4 v237, s[16:19], s69 offen offset:0 lds
v_mfma_f32_16x16x32_bf16 v[48:51], v[72:75], v[92:95], v[48:51]
ds_read2_b32 v[80:81], v217 offset0:128 offset1:129
v_lshl_add_u32 v220, v2, 2, v232
v_mfma_f32_16x16x32_bf16 v[52:55], v[72:75], v[96:99], v[52:55]
ds_read2_b32 v[82:83], v217 offset0:130 offset1:131
v_sub_u32 v220, v220, v221
v_mfma_f32_16x16x32_bf16 v[56:59], v[72:75], v[100:103], v[56:59]
ds_read2_b32 v[204:205], v218 offset0:0 offset1:1
v_add_u32 v220, 9012, v220
v_mfma_f32_16x16x32_bf16 v[60:63], v[72:75], v[104:107], v[60:63]
s_add_u32 s69, s30, 16384
buffer_load_dwordx4 v237, s[16:19], s69 offen offset:2048 lds
v_mfma_f32_16x16x32_bf16 v[64:67], v[72:75], v[108:111], v[64:67]
s_waitcnt lgkmcnt(3)
ds_read2_b32 v[206:207], v218 offset0:2 offset1:3
v_lshrrev_b32 v226, 1, v221
v_mfma_f32_16x16x32_bf16 v[44:47], v[76:79], v[84:87], v[44:47]
ds_write_b32 v225, v233 offset:9024
v_mfma_f32_16x16x32_bf16 v[48:51], v[76:79], v[88:91], v[48:51]
PAD_13:
s_cmp_lg_u32 s73, 0
s_cbranch_scc1 PAD_17
ds_read2_b32 v[116:117], v216 offset0:16 offset1:17
v_add_u32 v226, v226, v2
v_mfma_f32_16x16x32_bf16 v[52:55], v[76:79], v[92:95], v[52:55]
ds_read2_b32 v[118:119], v216 offset0:18 offset1:19
v_sub_u32 v227, 44, v226
v_mfma_f32_16x16x32_bf16 v[56:59], v[76:79], v[96:99], v[56:59]
s_add_u32 m0, s34, 4096
ds_read_b128 v[132:135], v219 offset:3648
v_mov_b32 v234, 127
v_mfma_f32_16x16x32_bf16 v[60:63], v[76:79], v[100:103], v[60:63]
s_add_u32 s69, s30, 36864
buffer_load_dwordx4 v237, s[16:19], s69 offen offset:0 lds
v_mfma_f32_16x16x32_bf16 v[64:67], v[76:79], v[104:107], v[64:67]
s_waitcnt lgkmcnt(6)
ds_read2_b32 v[120:121], v216 offset0:144 offset1:145
v_mov_b32 v235, 0
v_mfma_f32_16x16x32_bf16 v[48:51], v[80:83], v[84:87], v[48:51]
s_add_u32 s69, s30, 53248
buffer_load_dwordx4 v237, s[16:19], s69 offen offset:2048 lds
v_mfma_f32_16x16x32_bf16 v[52:55], v[80:83], v[88:91], v[52:55]
s_add_u32 m0, s34, 8192
ds_read2_b32 v[122:123], v216 offset0:146 offset1:147
v_lshlrev_b64 v[234:235], v227, v[234:235]
v_mfma_f32_16x16x32_bf16 v[56:59], v[80:83], v[92:95], v[56:59]
s_add_u32 s69, s30, 73728
buffer_load_dwordx4 v238, s[16:19], s69 offen offset:0 lds
v_mfma_f32_16x16x32_bf16 v[60:63], v[80:83], v[96:99], v[60:63]
ds_read_b128 v[136:139], v219 offset:3136
v_bfe_i32 v227, v234, 24, 1
v_mfma_f32_16x16x32_bf16 v[64:67], v[80:83], v[100:103], v[64:67]
s_waitcnt lgkmcnt(7)
ds_read2_b32 v[124:125], v217 offset0:16 offset1:17
v_bfe_i32 v228, v234, 25, 1
v_mfma_f32_16x16x32_bf16 v[52:55], v[204:207], v[84:87], v[52:55]
s_add_u32 s69, s30, 90112
buffer_load_dwordx4 v238, s[16:19], s69 offen offset:2048 lds
v_mfma_f32_16x16x32_bf16 v[56:59], v[204:207], v[88:91], v[56:59]
ds_read2_b32 v[126:127], v217 offset0:18 offset1:19
v_and_b32 v227, 0x3f80, v227
v_mfma_f32_16x16x32_bf16 v[60:63], v[204:207], v[92:95], v[60:63]
ds_read_b128 v[140:143], v219 offset:2624
v_and_or_b32 v164, v228, s57, v227
v_mfma_f32_16x16x32_bf16 v[64:67], v[204:207], v[96:99], v[64:67]
s_waitcnt lgkmcnt(6)
ds_read2_b32 v[128:129], v217 offset0:144 offset1:145
v_bfe_i32 v227, v234, 26, 1
v_mfma_f32_16x16x32_bf16 v[36:39], v[116:119], v[132:135], v[36:39]
s_waitcnt lgkmcnt(4)
ds_read2_b32 v[130:131], v217 offset0:146 offset1:147
v_bfe_i32 v228, v234, 27, 1
v_mfma_f32_16x16x32_bf16 v[40:43], v[116:119], v[136:139], v[40:43]
s_add_u32 m0, s34, 24576
ds_read_b128 v[144:147], v219 offset:2112
v_and_b32 v227, 0x3f80, v227
v_mfma_f32_16x16x32_bf16 v[40:43], v[120:123], v[132:135], v[40:43]
s_waitcnt lgkmcnt(3)
ds_read_b128 v[148:151], v219 offset:1600
v_and_or_b32 v165, v228, s57, v227
v_mfma_f32_16x16x32_bf16 v[44:47], v[116:119], v[140:143], v[44:47]
s_add_u32 s69, s30, 110592
buffer_load_dwordx4 v238, s[16:19], s69 offen offset:0 lds
v_mfma_f32_16x16x32_bf16 v[44:47], v[120:123], v[136:139], v[44:47]
ds_read_b128 v[152:155], v219 offset:1088
v_bfe_i32 v227, v234, 28, 1
v_mfma_f32_16x16x32_bf16 v[44:47], v[124:127], v[132:135], v[44:47]
s_waitcnt lgkmcnt(2)
ds_read_b128 v[156:159], v219 offset:576
v_bfe_i32 v228, v234, 29, 1
v_mfma_f32_16x16x32_bf16 v[48:51], v[116:119], v[144:147], v[48:51]
s_add_u32 s69, s30, 126976
buffer_load_dwordx4 v238, s[16:19], s69 offen offset:2048 lds
v_mfma_f32_16x16x32_bf16 v[48:51], v[120:123], v[140:143], v[48:51]
ds_read_b128 v[160:163], v219 offset:64
v_and_b32 v227, 0x3f80, v227
v_mfma_f32_16x16x32_bf16 v[48:51], v[124:127], v[136:139], v[48:51]
ds_read2_b32 v[68:69], v216 offset0:32 offset1:33
v_and_or_b32 v166, v228, s57, v227
v_mfma_f32_16x16x32_bf16 v[48:51], v[128:131], v[132:135], v[48:51]
s_waitcnt lgkmcnt(4)
ds_read2_b32 v[70:71], v216 offset0:34 offset1:35
v_bfe_i32 v227, v234, 30, 1
v_mfma_f32_16x16x32_bf16 v[52:55], v[116:119], v[148:151], v[52:55]
s_add_u32 m0, s34, 28672
ds_read_b128 v[84:87], v219 offset:3712
v_bfe_i32 v228, v234, 31, 1
v_mfma_f32_16x16x32_bf16 v[52:55], v[120:123], v[144:147], v[52:55]
s_add_u32 s69, s30, 147456
buffer_load_dwordx4 v237, s[16:19], s69 offen offset:0 lds
v_mfma_f32_16x16x32_bf16 v[52:55], v[124:127], v[140:143], v[52:55]
s_mul_i32 s56, s60, 3
ds_read2_b32 v[72:73], v216 offset0:160 offset1:161
v_and_b32 v227, 0x3f80, v227
v_mfma_f32_16x16x32_bf16 v[52:55], v[128:131], v[136:139], v[52:55]
s_waitcnt lgkmcnt(6)
ds_read2_b32 v[74:75], v216 offset0:162 offset1:163
v_and_or_b32 v167, v228, s57, v227
v_mfma_f32_16x16x32_bf16 v[56:59], v[116:119], v[152:155], v[56:59]
s_add_u32 s56, s56, s3
ds_read_b128 v[88:91], v219 offset:3200
v_sub_u32 v227, 43, v226
v_mfma_f32_16x16x32_bf16 v[56:59], v[120:123], v[148:151], v[56:59]
s_add_u32 s69, s30, 163840
buffer_load_dwordx4 v237, s[16:19], s69 offen offset:2048 lds
v_mfma_f32_16x16x32_bf16 v[56:59], v[124:127], v[144:147], v[56:59]
s_mul_i32 s56, s56, 4224
ds_read2_b32 v[76:77], v217 offset0:32 offset1:33
v_mov_b32 v234, 511
v_mfma_f32_16x16x32_bf16 v[56:59], v[128:131], v[140:143], v[56:59]
s_waitcnt lgkmcnt(8)
ds_read2_b32 v[78:79], v217 offset0:34 offset1:35
v_mov_b32 v235, 0
v_mfma_f32_16x16x32_bf16 v[60:63], v[116:119], v[156:159], v[60:63]
s_add_u32 s56, s56, 41943040
ds_read_b128 v[92:95], v219 offset:2688
v_lshlrev_b64 v[234:235], v227, v[234:235]
v_mfma_f32_16x16x32_bf16 v[60:63], v[120:123], v[152:155], v[60:63]
ds_read2_b32 v[80:81], v217 offset0:160 offset1:161
v_bfe_i32 v227, v234, 24, 1
v_mfma_f32_16x16x32_bf16 v[60:63], v[124:127], v[148:151], v[60:63]
s_add_u32 m0, s34, 32768
ds_read2_b32 v[82:83], v217 offset0:162 offset1:163
v_bfe_i32 v228, v234, 25, 1
v_mfma_f32_16x16x32_bf16 v[60:63], v[128:131], v[144:147], v[60:63]
s_waitcnt lgkmcnt(11)
ds_read_b128 v[96:99], v219 offset:2176
v_and_b32 v227, 0x3f80, v227
v_mfma_f32_16x16x32_bf16 v[64:67], v[116:119], v[160:163], v[64:67]
s_add_u32 s69, s30, 184320
buffer_load_dwordx4 v237, s[16:19], s69 offen offset:0 lds
v_mfma_f32_16x16x32_bf16 v[64:67], v[120:123], v[156:159], v[64:67]
ds_read_b128 v[100:103], v219 offset:1664
v_and_or_b32 v168, v228, s57, v227
v_mfma_f32_16x16x32_bf16 v[64:67], v[124:127], v[152:155], v[64:67]
ds_read_b128 v[104:107], v219 offset:1152
v_bfe_i32 v227, v234, 26, 1
v_mfma_f32_16x16x32_bf16 v[64:67], v[128:131], v[148:151], v[64:67]
s_waitcnt lgkmcnt(11)
ds_read_b128 v[108:111], v219 offset:640
v_bfe_i32 v228, v234, 27, 1
v_mfma_f32_16x16x32_bf16 v[36:39], v[68:71], v[84:87], v[36:39]
s_waitcnt lgkmcnt(9)
ds_read_b128 v[112:115], v219 offset:128
v_and_b32 v227, 0x3f80, v227
v_mfma_f32_16x16x32_bf16 v[40:43], v[68:71], v[88:91], v[40:43]
s_add_u32 s69, s30, 200704
buffer_load_dwordx4 v237, s[16:19], s69 offen offset:2048 lds
v_mfma_f32_16x16x32_bf16 v[40:43], v[72:75], v[84:87], v[40:43]
s_waitcnt lgkmcnt(7)
ds_read_b128 v[172:175], v219 offset:3584
v_and_or_b32 v169, v228, s57, v227
v_mfma_f32_16x16x32_bf16 v[44:47], v[68:71], v[92:95], v[44:47]
ds_read_b128 v[176:179], v219 offset:3600
v_bfe_i32 v227, v234, 28, 1
v_mfma_f32_16x16x32_bf16 v[44:47], v[72:75], v[88:91], v[44:47]
buffer_load_dword v212, v215, s[20:23], s72 offen sc1
v_mfma_f32_16x16x32_bf16 v[44:47], v[76:79], v[84:87], v[44:47]
s_waitcnt lgkmcnt(6)
ds_read2_b32 v[116:117], v216 offset0:48 offset1:49
v_bfe_i32 v228, v234, 29, 1
v_mfma_f32_16x16x32_bf16 v[48:51], v[68:71], v[96:99], v[48:51]
ds_read2_b32 v[118:119], v216 offset0:50 offset1:51
v_and_b32 v227, 0x3f80, v227
v_mfma_f32_16x16x32_bf16 v[48:51], v[72:75], v[92:95], v[48:51]
ds_read_b128 v[132:135], v219 offset:3776
v_and_or_b32 v170, v228, s57, v227
v_mfma_f32_16x16x32_bf16 v[48:51], v[76:79], v[88:91], v[48:51]
ds_read2_b32 v[120:121], v216 offset0:176 offset1:177
v_bfe_i32 v227, v234, 30, 1
v_mfma_f32_16x16x32_bf16 v[48:51], v[80:83], v[84:87], v[48:51]
s_waitcnt lgkmcnt(9)
ds_read2_b32 v[122:123], v216 offset0:178 offset1:179
v_bfe_i32 v228, v234, 31, 1
v_mfma_f32_16x16x32_bf16 v[52:55], v[68:71], v[100:103], v[52:55]
s_add_u32 m0, s34, 49152
ds_read_b128 v[136:139], v219 offset:3264
v_and_b32 v227, 0x3f80, v227
v_mfma_f32_16x16x32_bf16 v[52:55], v[72:75], v[96:99], v[52:55]
s_add_u32 s69, s30, 221184
buffer_load_dwordx4 v238, s[16:19], s69 offen offset:0 lds
v_mfma_f32_16x16x32_bf16 v[52:55], v[76:79], v[92:95], v[52:55]
ds_read2_b32 v[124:125], v217 offset0:48 offset1:49
v_and_or_b32 v171, v228, s57, v227
v_mfma_f32_16x16x32_bf16 v[52:55], v[80:83], v[88:91], v[52:55]
s_waitcnt lgkmcnt(11)
ds_read2_b32 v[126:127], v217 offset0:50 offset1:51
v_bfe_u32 v3, v1, 4, 1
v_mfma_f32_16x16x32_bf16 v[56:59], v[68:71], v[104:107], v[56:59]
s_add_u32 s69, s30, 237568
buffer_load_dwordx4 v238, s[16:19], s69 offen offset:2048 lds
v_mfma_f32_16x16x32_bf16 v[56:59], v[72:75], v[100:103], v[56:59]
ds_read_b128 v[140:143], v219 offset:2752
v_lshlrev_b32 v3, 9, v3
v_mfma_f32_16x16x32_bf16 v[56:59], v[76:79], v[96:99], v[56:59]
ds_read2_b32 v[128:129], v217 offset0:176 offset1:177
v_lshl_add_u32 v3, v2, 5, v3
v_mfma_f32_16x16x32_bf16 v[56:59], v[80:83], v[92:95], v[56:59]
s_waitcnt lgkmcnt(13)
ds_read2_b32 v[130:131], v217 offset0:178 offset1:179
v_lshrrev_b32 v226, 5, v1
v_mfma_f32_16x16x32_bf16 v[60:63], v[68:71], v[108:111], v[60:63]
ds_read_b128 v[144:147], v219 offset:2240
v_lshl_add_u32 v3, v226, 4, v3
v_mfma_f32_16x16x32_bf16 v[60:63], v[72:75], v[104:107], v[60:63]
s_add_u32 m0, s34, 53248
ds_read_b128 v[148:151], v219 offset:1728
s_add_u32 s69, s30, 258048
v_mfma_f32_16x16x32_bf16 v[60:63], v[76:79], v[100:103], v[60:63]
buffer_load_dwordx4 v238, s[16:19], s69 offen offset:0 lds
v_mfma_f32_16x16x32_bf16 v[60:63], v[80:83], v[96:99], v[60:63]
s_waitcnt lgkmcnt(15)
ds_read_b128 v[152:155], v219 offset:1216
v_mfma_f32_16x16x32_bf16 v[64:67], v[68:71], v[112:115], v[64:67]
ds_read_b128 v[156:159], v219 offset:704
v_mfma_f32_16x16x32_bf16 v[64:67], v[72:75], v[108:111], v[64:67]
ds_read_b128 v[160:163], v219 offset:192
v_mfma_f32_16x16x32_bf16 v[64:67], v[76:79], v[104:107], v[64:67]
s_add_u32 s69, s30, 274432
buffer_load_dwordx4 v238, s[16:19], s69 offen offset:2048 lds
v_mfma_f32_16x16x32_bf16 v[64:67], v[80:83], v[100:103], v[64:67]
s_waitcnt lgkmcnt(15)
v_mfma_f32_16x16x32_bf16 v[180:183], v[172:175], v[164:167], 0
ds_read_b128 v[172:175], v219 offset:3072
v_mfma_f32_16x16x32_bf16 v[184:187], v[176:179], v[168:171], 0
s_waitcnt lgkmcnt(14)
ds_read_b128 v[176:179], v219 offset:3088
v_mfma_f32_16x16x32_bf16 v[36:39], v[116:119], v[132:135], v[36:39]
s_waitcnt lgkmcnt(12)
ds_read2_b32 v[68:69], v216 offset0:64 offset1:65
v_mfma_f32_16x16x32_bf16 v[40:43], v[116:119], v[136:139], v[40:43]
s_add_u32 m0, s34, 57344
ds_read2_b32 v[70:71], v216 offset0:66 offset1:67
v_cvt_pk_bf16_f32 v188, v180, v184
v_mfma_f32_16x16x32_bf16 v[40:43], v[120:123], v[132:135], v[40:43]
s_waitcnt lgkmcnt(11)
ds_read_b128 v[84:87], v219 offset:3840
v_cvt_pk_bf16_f32 v189, v181, v185
v_mfma_f32_16x16x32_bf16 v[44:47], v[116:119], v[140:143], v[44:47]
s_add_u32 s69, s30, 294912
buffer_load_dwordx4 v237, s[16:19], s69 offen offset:0 lds
v_mfma_f32_16x16x32_bf16 v[44:47], v[120:123], v[136:139], v[44:47]
ds_read2_b32 v[72:73], v216 offset0:192 offset1:193
v_cvt_pk_bf16_f32 v190, v182, v186
v_mfma_f32_16x16x32_bf16 v[44:47], v[124:127], v[132:135], v[44:47]
s_waitcnt lgkmcnt(10)
ds_read2_b32 v[74:75], v216 offset0:194 offset1:195
v_cvt_pk_bf16_f32 v191, v183, v187
v_mfma_f32_16x16x32_bf16 v[48:51], v[116:119], v[144:147], v[48:51]
s_add_u32 s69, s30, 311296
buffer_load_dwordx4 v237, s[16:19], s69 offen offset:2048 lds
v_mfma_f32_16x16x32_bf16 v[48:51], v[120:123], v[140:143], v[48:51]
ds_read_b128 v[88:91], v219 offset:3328
v_mfma_f32_16x16x32_bf16 v[48:51], v[124:127], v[136:139], v[48:51]
ds_read2_b32 v[76:77], v217 offset0:64 offset1:65
v_mfma_f32_16x16x32_bf16 v[48:51], v[128:131], v[132:135], v[48:51]
s_waitcnt lgkmcnt(12)
ds_read2_b32 v[78:79], v217 offset0:66 offset1:67
v_mfma_f32_16x16x32_bf16 v[52:55], v[116:119], v[148:151], v[52:55]
ds_read_b128 v[92:95], v219 offset:2816
v_mfma_f32_16x16x32_bf16 v[52:55], v[120:123], v[144:147], v[52:55]
s_add_u32 m0, s34, 73728
ds_read2_b32 v[80:81], v217 offset0:192 offset1:193
s_add_u32 s69, s30, 331776
v_mfma_f32_16x16x32_bf16 v[52:55], v[124:127], v[140:143], v[52:55]
buffer_load_dwordx4 v237, s[16:19], s69 offen offset:0 lds
v_mfma_f32_16x16x32_bf16 v[52:55], v[128:131], v[136:139], v[52:55]
s_waitcnt lgkmcnt(14)
ds_read2_b32 v[82:83], v217 offset0:194 offset1:195
v_mfma_f32_16x16x32_bf16 v[56:59], v[116:119], v[152:155], v[56:59]
ds_read_b128 v[96:99], v219 offset:2304
v_mfma_f32_16x16x32_bf16 v[56:59], v[120:123], v[148:151], v[56:59]
ds_read_b128 v[100:103], v219 offset:1792
v_mfma_f32_16x16x32_bf16 v[56:59], v[124:127], v[144:147], v[56:59]
s_add_u32 s69, s30, 348160
buffer_load_dwordx4 v237, s[16:19], s69 offen offset:2048 lds
v_mfma_f32_16x16x32_bf16 v[56:59], v[128:131], v[140:143], v[56:59]
s_waitcnt lgkmcnt(15)
ds_read_b128 v[104:107], v219 offset:1280
v_mfma_f32_16x16x32_bf16 v[60:63], v[116:119], v[156:159], v[60:63]
ds_read_b128 v[108:111], v219 offset:768
v_mfma_f32_16x16x32_bf16 v[60:63], v[120:123], v[152:155], v[60:63]
ds_read_b128 v[112:115], v219 offset:256
v_mfma_f32_16x16x32_bf16 v[60:63], v[124:127], v[148:151], v[60:63]
v_mfma_f32_16x16x32_bf16 v[60:63], v[128:131], v[144:147], v[60:63]
s_add_u32 m0, s34, 77824
s_add_u32 s69, s30, 368640
v_mfma_f32_16x16x32_bf16 v[64:67], v[116:119], v[160:163], v[64:67]
buffer_load_dwordx4 v238, s[16:19], s69 offen offset:0 lds
v_mfma_f32_16x16x32_bf16 v[64:67], v[120:123], v[156:159], v[64:67]
v_mfma_f32_16x16x32_bf16 v[64:67], v[124:127], v[152:155], v[64:67]
v_mfma_f32_16x16x32_bf16 v[64:67], v[128:131], v[148:151], v[64:67]
s_waitcnt lgkmcnt(15)
v_mfma_f32_16x16x32_bf16 v[180:183], v[172:175], v[164:167], 0
s_add_u32 s69, s30, 385024
buffer_load_dwordx4 v238, s[16:19], s69 offen offset:2048 lds
v_mfma_f32_16x16x32_bf16 v[184:187], v[176:179], v[168:171], 0
s_waitcnt lgkmcnt(13)
ds_read_b128 v[172:175], v219 offset:2560
v_mfma_f32_16x16x32_bf16 v[36:39], v[68:71], v[84:87], v[36:39]
s_waitcnt lgkmcnt(11)
ds_read_b128 v[176:179], v219 offset:2576
v_mfma_f32_16x16x32_bf16 v[40:43], v[68:71], v[88:91], v[40:43]
ds_read2_b32 v[116:117], v216 offset0:80 offset1:81
v_mfma_f32_16x16x32_bf16 v[40:43], v[72:75], v[84:87], v[40:43]
s_waitcnt lgkmcnt(10)
ds_read2_b32 v[118:119], v216 offset0:82 offset1:83
v_cvt_pk_bf16_f32 v192, v180, v184
v_mfma_f32_16x16x32_bf16 v[44:47], v[68:71], v[92:95], v[44:47]
s_add_u32 m0, s34, 81920
ds_read_b128 v[132:135], v219 offset:3904
v_cvt_pk_bf16_f32 v193, v181, v185
v_mfma_f32_16x16x32_bf16 v[44:47], v[72:75], v[88:91], v[44:47]
s_add_u32 s69, s30, 405504
buffer_load_dwordx4 v238, s[16:19], s69 offen offset:0 lds
v_mfma_f32_16x16x32_bf16 v[44:47], v[76:79], v[84:87], v[44:47]
s_waitcnt lgkmcnt(9)
ds_read2_b32 v[120:121], v216 offset0:208 offset1:209
v_cvt_pk_bf16_f32 v194, v182, v186
v_mfma_f32_16x16x32_bf16 v[48:51], v[68:71], v[96:99], v[48:51]
ds_read2_b32 v[122:123], v216 offset0:210 offset1:211
v_cvt_pk_bf16_f32 v195, v183, v187
v_mfma_f32_16x16x32_bf16 v[48:51], v[72:75], v[92:95], v[48:51]
ds_read_b128 v[136:139], v219 offset:3392
v_mfma_f32_16x16x32_bf16 v[48:51], v[76:79], v[88:91], v[48:51]
s_add_u32 s69, s30, 421888
buffer_load_dwordx4 v238, s[16:19], s69 offen offset:2048 lds
v_mfma_f32_16x16x32_bf16 v[48:51], v[80:83], v[84:87], v[48:51]
s_waitcnt lgkmcnt(11)
ds_read2_b32 v[124:125], v217 offset0:80 offset1:81
v_mfma_f32_16x16x32_bf16 v[52:55], v[68:71], v[100:103], v[52:55]
ds_read2_b32 v[126:127], v217 offset0:82 offset1:83
v_mfma_f32_16x16x32_bf16 v[52:55], v[72:75], v[96:99], v[52:55]
ds_read_b128 v[140:143], v219 offset:2880
v_mfma_f32_16x16x32_bf16 v[52:55], v[76:79], v[92:95], v[52:55]
ds_read2_b32 v[128:129], v217 offset0:208 offset1:209
v_mfma_f32_16x16x32_bf16 v[52:55], v[80:83], v[88:91], v[52:55]
s_waitcnt lgkmcnt(14)
ds_read2_b32 v[130:131], v217 offset0:210 offset1:211
s_waitcnt vmcnt(12)
v_mfma_f32_16x16x32_bf16 v[56:59], v[68:71], v[104:107], v[56:59]
ds_read_b128 v[144:147], v219 offset:2368
v_cmp_gt_u32 vcc, 2, v212
v_mfma_f32_16x16x32_bf16 v[56:59], v[72:75], v[100:103], v[56:59]
ds_read_b128 v[148:151], v219 offset:1856
s_cbranch_vccnz SLOW_h1
RET_h1:
v_mfma_f32_16x16x32_bf16 v[56:59], v[76:79], v[96:99], v[56:59]
buffer_load_dwordx4 a[32:35], v242, s[20:23], s44 offen offset:2048 sc1
v_mfma_f32_16x16x32_bf16 v[56:59], v[80:83], v[92:95], v[56:59]
s_waitcnt lgkmcnt(15)
ds_read_b128 v[152:155], v219 offset:1344
v_mfma_f32_16x16x32_bf16 v[60:63], v[68:71], v[108:111], v[60:63]
buffer_load_dwordx4 a[36:39], v242, s[20:23], s45 offen offset:2048 sc1
v_mfma_f32_16x16x32_bf16 v[60:63], v[72:75], v[104:107], v[60:63]
ds_read_b128 v[156:159], v219 offset:832
v_mfma_f32_16x16x32_bf16 v[60:63], v[76:79], v[100:103], v[60:63]
ds_read_b128 v[160:163], v219 offset:320
v_mfma_f32_16x16x32_bf16 v[60:63], v[80:83], v[96:99], v[60:63]
v_mfma_f32_16x16x32_bf16 v[64:67], v[68:71], v[112:115], v[64:67]
v_mfma_f32_16x16x32_bf16 v[64:67], v[72:75], v[108:111], v[64:67]
buffer_load_dwordx4 a[40:43], v242, s[20:23], s46 offen offset:2048 sc1
v_mfma_f32_16x16x32_bf16 v[64:67], v[76:79], v[104:107], v[64:67]
v_mfma_f32_16x16x32_bf16 v[64:67], v[80:83], v[100:103], v[64:67]
s_waitcnt lgkmcnt(15)
v_mfma_f32_16x16x32_bf16 v[180:183], v[172:175], v[164:167], 0
ds_read_b128 v[172:175], v219 offset:2048
v_mfma_f32_16x16x32_bf16 v[184:187], v[176:179], v[168:171], 0
s_waitcnt lgkmcnt(14)
ds_read_b128 v[176:179], v219 offset:2064
v_mfma_f32_16x16x32_bf16 v[36:39], v[116:119], v[132:135], v[36:39]
s_waitcnt lgkmcnt(12)
buffer_load_dwordx4 a[44:47], v242, s[20:23], s47 offen offset:2048 sc1
v_mfma_f32_16x16x32_bf16 v[40:43], v[116:119], v[136:139], v[40:43]
ds_read2_b32 v[68:69], v216 offset0:96 offset1:97
v_mfma_f32_16x16x32_bf16 v[40:43], v[120:123], v[132:135], v[40:43]
s_waitcnt lgkmcnt(10)
ds_read2_b32 v[70:71], v216 offset0:98 offset1:99
v_cvt_pk_bf16_f32 v196, v180, v184
v_mfma_f32_16x16x32_bf16 v[44:47], v[116:119], v[140:143], v[44:47]
ds_read_b128 v[84:87], v219 offset:3968
v_cvt_pk_bf16_f32 v197, v181, v185
v_mfma_f32_16x16x32_bf16 v[44:47], v[120:123], v[136:139], v[44:47]
ds_read2_b32 v[72:73], v216 offset0:224 offset1:225
v_cvt_pk_bf16_f32 v198, v182, v186
v_mfma_f32_16x16x32_bf16 v[44:47], v[124:127], v[132:135], v[44:47]
s_waitcnt lgkmcnt(10)
buffer_load_dwordx4 a[48:51], v242, s[20:23], s44 offen offset:3072 sc1
v_mfma_f32_16x16x32_bf16 v[48:51], v[116:119], v[144:147], v[48:51]
ds_read2_b32 v[74:75], v216 offset0:226 offset1:227
v_cvt_pk_bf16_f32 v199, v183, v187
v_mfma_f32_16x16x32_bf16 v[48:51], v[120:123], v[140:143], v[48:51]
ds_read_b128 v[88:91], v219 offset:3456
v_mfma_f32_16x16x32_bf16 v[48:51], v[124:127], v[136:139], v[48:51]
ds_read2_b32 v[76:77], v217 offset0:96 offset1:97
v_mfma_f32_16x16x32_bf16 v[48:51], v[128:131], v[132:135], v[48:51]
s_waitcnt lgkmcnt(12)
ds_read2_b32 v[78:79], v217 offset0:98 offset1:99
v_mfma_f32_16x16x32_bf16 v[52:55], v[116:119], v[148:151], v[52:55]
buffer_load_dwordx4 a[52:55], v242, s[20:23], s45 offen offset:3072 sc1
v_mfma_f32_16x16x32_bf16 v[52:55], v[120:123], v[144:147], v[52:55]
ds_read_b128 v[92:95], v219 offset:2944
v_mfma_f32_16x16x32_bf16 v[52:55], v[124:127], v[140:143], v[52:55]
ds_read2_b32 v[80:81], v217 offset0:224 offset1:225
v_mfma_f32_16x16x32_bf16 v[52:55], v[128:131], v[136:139], v[52:55]
s_waitcnt lgkmcnt(14)
ds_read2_b32 v[82:83], v217 offset0:226 offset1:227
v_mfma_f32_16x16x32_bf16 v[56:59], v[116:119], v[152:155], v[56:59]
ds_read_b128 v[96:99], v219 offset:2432
v_mfma_f32_16x16x32_bf16 v[56:59], v[120:123], v[148:151], v[56:59]
buffer_load_dwordx4 a[56:59], v242, s[20:23], s46 offen offset:3072 sc1
v_mfma_f32_16x16x32_bf16 v[56:59], v[124:127], v[144:147], v[56:59]
ds_read_b128 v[100:103], v219 offset:1920
v_mfma_f32_16x16x32_bf16 v[56:59], v[128:131], v[140:143], v[56:59]
s_waitcnt lgkmcnt(15)
ds_read_b128 v[104:107], v219 offset:1408
v_mfma_f32_16x16x32_bf16 v[60:63], v[116:119], v[156:159], v[60:63]
ds_read_b128 v[108:111], v219 offset:896
v_mfma_f32_16x16x32_bf16 v[60:63], v[120:123], v[152:155], v[60:63]
ds_read_b128 v[112:115], v219 offset:384
v_mfma_f32_16x16x32_bf16 v[60:63], v[124:127], v[148:151], v[60:63]
buffer_load_dwordx4 a[60:63], v242, s[20:23], s47 offen offset:3072 sc1
v_mfma_f32_16x16x32_bf16 v[60:63], v[128:131], v[144:147], v[60:63]
v_mfma_f32_16x16x32_bf16 v[64:67], v[116:119], v[160:163], v[64:67]
v_mfma_f32_16x16x32_bf16 v[64:67], v[120:123], v[156:159], v[64:67]
v_mfma_f32_16x16x32_bf16 v[64:67], v[124:127], v[152:155], v[64:67]
v_mfma_f32_16x16x32_bf16 v[64:67], v[128:131], v[148:151], v[64:67]
s_waitcnt lgkmcnt(15)
buffer_load_dwordx4 a[96:99], v243, s[20:23], s44 offen offset:2048 sc1
v_mfma_f32_16x16x32_bf16 v[180:183], v[172:175], v[164:167], 0
v_mfma_f32_16x16x32_bf16 v[184:187], v[176:179], v[168:171], 0
s_waitcnt lgkmcnt(13)
ds_read2_b32 v[164:165], v220 offset0:3 offset1:2
v_mfma_f32_16x16x32_bf16 v[36:39], v[68:71], v[84:87], v[36:39]
s_waitcnt lgkmcnt(11)
ds_read2_b32 v[166:167], v220 offset0:1 offset1:0
v_mfma_f32_16x16x32_bf16 v[40:43], v[68:71], v[88:91], v[40:43]
ds_read2_b32 v[168:169], v220 offset0:19 offset1:18
v_mfma_f32_16x16x32_bf16 v[40:43], v[72:75], v[84:87], v[40:43]
s_waitcnt lgkmcnt(10)
buffer_load_dwordx4 a[100:103], v243, s[20:23], s45 offen offset:2048 sc1
v_mfma_f32_16x16x32_bf16 v[44:47], v[68:71], v[92:95], v[44:47]
ds_read2_b32 v[170:171], v220 offset0:17 offset1:16
v_cvt_pk_bf16_f32 v200, v180, v184
v_mfma_f32_16x16x32_bf16 v[44:47], v[72:75], v[88:91], v[44:47]
ds_read2_b32 v[172:173], v220 offset0:35 offset1:34
v_cvt_pk_bf16_f32 v201, v181, v185
v_mfma_f32_16x16x32_bf16 v[44:47], v[76:79], v[84:87], v[44:47]
s_waitcnt lgkmcnt(9)
ds_read2_b32 v[174:175], v220 offset0:33 offset1:32
v_cvt_pk_bf16_f32 v202, v182, v186
v_mfma_f32_16x16x32_bf16 v[48:51], v[68:71], v[96:99], v[48:51]
ds_read2_b32 v[176:177], v220 offset0:51 offset1:50
v_cvt_pk_bf16_f32 v203, v183, v187
v_mfma_f32_16x16x32_bf16 v[48:51], v[72:75], v[92:95], v[48:51]
buffer_load_dwordx4 a[104:107], v243, s[20:23], s46 offen offset:2048 sc1
v_mfma_f32_16x16x32_bf16 v[48:51], v[76:79], v[88:91], v[48:51]
ds_read2_b32 v[178:179], v220 offset0:49 offset1:48
v_mfma_f32_16x16x32_bf16 v[48:51], v[80:83], v[84:87], v[48:51]
s_waitcnt lgkmcnt(11)
ds_read2_b32 v[116:117], v216 offset0:112 offset1:113
v_mfma_f32_16x16x32_bf16 v[52:55], v[68:71], v[100:103], v[52:55]
ds_read2_b32 v[118:119], v216 offset0:114 offset1:115
v_mfma_f32_16x16x32_bf16 v[52:55], v[72:75], v[96:99], v[52:55]
ds_read_b128 v[132:135], v219 offset:4032
v_mfma_f32_16x16x32_bf16 v[52:55], v[76:79], v[92:95], v[52:55]
buffer_load_dwordx4 a[108:111], v243, s[20:23], s47 offen offset:2048 sc1
v_mfma_f32_16x16x32_bf16 v[52:55], v[80:83], v[88:91], v[52:55]
s_waitcnt lgkmcnt(13)
ds_read2_b32 v[120:121], v216 offset0:240 offset1:241
v_mfma_f32_16x16x32_bf16 v[56:59], v[68:71], v[104:107], v[56:59]
ds_read2_b32 v[122:123], v216 offset0:242 offset1:243
v_mfma_f32_16x16x32_bf16 v[56:59], v[72:75], v[100:103], v[56:59]
ds_read_b128 v[136:139], v219 offset:3520
v_mfma_f32_16x16x32_bf16 v[56:59], v[76:79], v[96:99], v[56:59]
ds_read2_b32 v[124:125], v217 offset0:112 offset1:113
v_mfma_f32_16x16x32_bf16 v[56:59], v[80:83], v[92:95], v[56:59]
s_waitcnt lgkmcnt(15)
buffer_load_dwordx4 a[112:115], v243, s[20:23], s44 offen offset:3072 sc1
v_mfma_f32_16x16x32_bf16 v[60:63], v[68:71], v[108:111], v[60:63]
ds_read2_b32 v[126:127], v217 offset0:114 offset1:115
v_mfma_f32_16x16x32_bf16 v[60:63], v[72:75], v[104:107], v[60:63]
ds_read_b128 v[140:143], v219 offset:3008
v_mfma_f32_16x16x32_bf16 v[60:63], v[76:79], v[100:103], v[60:63]
ds_read2_b32 v[128:129], v217 offset0:240 offset1:241
v_mfma_f32_16x16x32_bf16 v[60:63], v[80:83], v[96:99], v[60:63]
ds_read2_b32 v[130:131], v217 offset0:242 offset1:243
v_mfma_f32_16x16x32_bf16 v[64:67], v[68:71], v[112:115], v[64:67]
buffer_load_dwordx4 a[116:119], v243, s[20:23], s45 offen offset:3072 sc1
v_mfma_f32_16x16x32_bf16 v[64:67], v[72:75], v[108:111], v[64:67]
ds_read_b128 v[144:147], v219 offset:2496
v_mfma_f32_16x16x32_bf16 v[64:67], v[76:79], v[104:107], v[64:67]
ds_read_b128 v[148:151], v219 offset:1984
v_mfma_f32_16x16x32_bf16 v[64:67], v[80:83], v[100:103], v[64:67]
s_waitcnt lgkmcnt(10)
ds_read_b128 v[152:155], v219 offset:1472
v_mfma_f32_16x16x32_bf16 v[36:39], v[116:119], v[132:135], v[36:39]
s_waitcnt lgkmcnt(8)
ds_read_b128 v[156:159], v219 offset:960
v_mfma_f32_16x16x32_bf16 v[40:43], v[116:119], v[136:139], v[40:43]
buffer_load_dwordx4 a[120:123], v243, s[20:23], s46 offen offset:3072 sc1
v_mfma_f32_16x16x32_bf16 v[40:43], v[120:123], v[132:135], v[40:43]
s_waitcnt lgkmcnt(6)
ds_read_b128 v[160:163], v219 offset:448
v_mfma_f32_16x16x32_bf16 v[44:47], v[116:119], v[140:143], v[44:47]
v_mfma_f32_16x16x32_bf16 v[44:47], v[120:123], v[136:139], v[44:47]
v_mfma_f32_16x16x32_bf16 v[44:47], v[124:127], v[132:135], v[44:47]
s_waitcnt lgkmcnt(4)
v_mfma_f32_16x16x32_bf16 v[48:51], v[116:119], v[144:147], v[48:51]
buffer_load_dwordx4 a[124:127], v243, s[20:23], s47 offen offset:3072 sc1
v_mfma_f32_16x16x32_bf16 v[48:51], v[120:123], v[140:143], v[48:51]
v_cvt_pk_bf16_f32 v68, v36, v37
v_cvt_pk_bf16_f32 v69, v38, v39
v_mfma_f32_16x16x32_bf16 v[48:51], v[124:127], v[136:139], v[48:51]
v_cvt_pk_bf16_f32 v70, v40, v41
v_cvt_pk_bf16_f32 v71, v42, v43
v_mfma_f32_16x16x32_bf16 v[48:51], v[128:131], v[132:135], v[48:51]
s_waitcnt lgkmcnt(3)
v_permlane16_swap_b32 v68, v70
v_permlane16_swap_b32 v69, v71
v_mfma_f32_16x16x32_bf16 v[52:55], v[116:119], v[148:151], v[52:55]
buffer_store_dwordx4 v[68:71], v3, s[20:23], s56 offen offset:0 sc1
v_mfma_f32_16x16x32_bf16 v[52:55], v[120:123], v[144:147], v[52:55]
buffer_load_dwordx4 a[160:163], v244, s[20:23], s44 offen offset:2048 sc1
v_mfma_f32_16x16x32_bf16 v[52:55], v[124:127], v[140:143], v[52:55]
v_cvt_pk_bf16_f32 v72, v44, v45
v_cvt_pk_bf16_f32 v73, v46, v47
v_mfma_f32_16x16x32_bf16 v[52:55], v[128:131], v[136:139], v[52:55]
v_cvt_pk_bf16_f32 v74, v48, v49
v_cvt_pk_bf16_f32 v75, v50, v51
v_mfma_f32_16x16x32_bf16 v[52:55], v[188:191], v[164:167], v[52:55]
s_waitcnt lgkmcnt(2)
v_permlane16_swap_b32 v72, v74
v_permlane16_swap_b32 v73, v75
v_mfma_f32_16x16x32_bf16 v[56:59], v[116:119], v[152:155], v[56:59]
buffer_store_dwordx4 v[72:75], v3, s[20:23], s56 offen offset:1024 sc1
v_mfma_f32_16x16x32_bf16 v[56:59], v[120:123], v[148:151], v[56:59]
buffer_load_dwordx4 a[164:167], v244, s[20:23], s45 offen offset:2048 sc1
v_mfma_f32_16x16x32_bf16 v[56:59], v[124:127], v[144:147], v[56:59]
v_mfma_f32_16x16x32_bf16 v[56:59], v[128:131], v[140:143], v[56:59]
v_mfma_f32_16x16x32_bf16 v[56:59], v[188:191], v[168:171], v[56:59]
v_mfma_f32_16x16x32_bf16 v[56:59], v[192:195], v[164:167], v[56:59]
s_waitcnt lgkmcnt(1)
v_mfma_f32_16x16x32_bf16 v[60:63], v[116:119], v[156:159], v[60:63]
buffer_load_dwordx4 a[168:171], v244, s[20:23], s46 offen offset:2048 sc1
v_mfma_f32_16x16x32_bf16 v[60:63], v[120:123], v[152:155], v[60:63]
v_mfma_f32_16x16x32_bf16 v[60:63], v[124:127], v[148:151], v[60:63]
v_mfma_f32_16x16x32_bf16 v[60:63], v[128:131], v[144:147], v[60:63]
v_mfma_f32_16x16x32_bf16 v[60:63], v[188:191], v[172:175], v[60:63]
v_mfma_f32_16x16x32_bf16 v[60:63], v[192:195], v[168:171], v[60:63]
buffer_load_dwordx4 a[172:175], v244, s[20:23], s47 offen offset:2048 sc1
v_mfma_f32_16x16x32_bf16 v[60:63], v[196:199], v[164:167], v[60:63]
PAD_14:
s_cmp_lg_u32 s73, 0
s_cbranch_scc1 PAD_18
s_waitcnt lgkmcnt(0)
v_cvt_pk_bf16_f32 v76, v52, v53
v_cvt_pk_bf16_f32 v77, v54, v55
v_mfma_f32_16x16x32_bf16 v[64:67], v[116:119], v[160:163], v[64:67]
v_cvt_pk_bf16_f32 v78, v56, v57
v_cvt_pk_bf16_f32 v79, v58, v59
v_mfma_f32_16x16x32_bf16 v[64:67], v[120:123], v[156:159], v[64:67]
v_permlane16_swap_b32 v76, v78
v_permlane16_swap_b32 v77, v79
v_mfma_f32_16x16x32_bf16 v[64:67], v[124:127], v[152:155], v[64:67]
buffer_store_dwordx4 v[76:79], v3, s[20:23], s56 offen offset:2048 sc1
v_mfma_f32_16x16x32_bf16 v[64:67], v[128:131], v[148:151], v[64:67]
buffer_load_dwordx4 a[176:179], v244, s[20:23], s44 offen offset:3072 sc1
v_mfma_f32_16x16x32_bf16 v[64:67], v[188:191], v[176:179], v[64:67]
v_mfma_f32_16x16x32_bf16 v[64:67], v[192:195], v[172:175], v[64:67]
v_mfma_f32_16x16x32_bf16 v[64:67], v[196:199], v[168:171], v[64:67]
v_mfma_f32_16x16x32_bf16 v[64:67], v[200:203], v[164:167], v[64:67]
s_nop 0
s_nop 0
s_nop 0
s_nop 0
s_nop 0
s_nop 0
s_nop 0
s_nop 0
v_cvt_pk_bf16_f32 v80, v60, v61
v_cvt_pk_bf16_f32 v81, v62, v63
v_cvt_pk_bf16_f32 v82, v64, v65
v_cvt_pk_bf16_f32 v83, v66, v67
s_nop 0
v_permlane16_swap_b32 v80, v82
v_permlane16_swap_b32 v81, v83
buffer_store_dwordx4 v[80:83], v3, s[20:23], s56 offen offset:3072 sc1
KF_g2:
PAD_15:
s_cmp_lg_u32 s73, 0
s_cbranch_scc1 PAD_19
v_lshrrev_b32 v2, 2, v1
v_lshlrev_b32 v2, 7, v2
v_and_b32 v3, 3, v1
v_lshl_add_u32 v2, v3, 3, v2
v_bfe_u32 v3, v1, 3, 2
v_lshl_add_u32 v2, v3, 5, v2
s_mul_i32 s56, s33, 12288
v_add_u32 v216, s56, v2
v_xor_b32 v217, 32, v216
v_xor_b32 v218, 64, v216
v_xor_b32 v219, 0x60, v216
s_barrier
ds_read_b64_tr_b16 v[180:181], v216 offset:0
ds_read_b64_tr_b16 v[182:183], v216 offset:2048
ds_read_b64_tr_b16 v[184:185], v216 offset:4096
ds_read_b64_tr_b16 v[186:187], v216 offset:6144
ds_read_b64_tr_b16 v[188:189], v216 offset:8192
ds_read_b64_tr_b16 v[190:191], v216 offset:10240
ds_read_b64_tr_b16 v[192:193], v217 offset:0
ds_read_b64_tr_b16 v[194:195], v217 offset:2048
ds_read_b64_tr_b16 v[196:197], v217 offset:4096
ds_read_b64_tr_b16 v[198:199], v217 offset:6144
ds_read_b64_tr_b16 v[200:201], v217 offset:8192
ds_read_b64_tr_b16 v[202:203], v217 offset:10240
s_waitcnt vmcnt(22) lgkmcnt(6)
v_mfma_f32_16x16x32_bf16 v[44:47], v[180:183], a[8:11], 0
s_mov_b32 s62, 0xffff0000
ds_read_b64_tr_b16 v[204:205], v218 offset:0
v_mov_b32 v224, 1
v_mfma_f32_16x16x32_bf16 v[44:47], v[184:187], a[24:27], v[44:47]
s_mov_b32 s63, 0x3f80
buffer_load_dwordx4 a[180:183], v244, s[20:23], s45 offen offset:3072 sc1
v_mfma_f32_16x16x32_bf16 v[44:47], v[188:191], a[40:43], v[44:47]
s_waitcnt vmcnt(22)
ds_read_b64_tr_b16 v[206:207], v218 offset:2048
v_mov_b32 v225, 0
v_mfma_f32_16x16x32_bf16 v[48:51], v[188:191], a[44:47], 0
s_mov_b32 s64, 0x3f800000
s_mul_i32 s56, s33, 10240
v_add_u32 v220, s56, v247
v_mfma_f32_16x16x32_bf16 v[48:51], v[184:187], a[28:31], v[48:51]
s_lshl_b32 s56, s3, 13
ds_read_b64_tr_b16 v[208:209], v218 offset:4096
v_add_u32 v221, 143360, v220
v_mfma_f32_16x16x32_bf16 v[48:51], v[180:183], a[12:15], v[48:51]
s_add_u32 s56, s56, 98304
buffer_load_dwordx4 a[184:187], v244, s[20:23], s46 offen offset:3072 sc1
v_mfma_f32_16x16x32_bf16 v[36:39], v[180:183], a[0:3], 0
ds_read_b64_tr_b16 v[210:211], v218 offset:6144
v_add_u32 v222, s56, v247
v_mfma_f32_16x16x32_bf16 v[36:39], v[184:187], a[16:19], v[36:39]
s_xor_b32 s56, s56, 16384
v_add_u32 v223, s56, v247
s_lshl_b32 s56, s3, 11
v_mfma_f32_16x16x32_bf16 v[36:39], v[188:191], a[32:35], v[36:39]
s_add_u32 s56, s56, 147456
ds_read_b64_tr_b16 v[212:213], v218 offset:8192
v_add_u32 v252, s56, v247
v_mfma_f32_16x16x32_bf16 v[40:43], v[188:191], a[36:39], 0
buffer_load_dwordx4 a[188:191], v244, s[20:23], s47 offen offset:3072 sc1
v_mfma_f32_16x16x32_bf16 v[40:43], v[184:187], a[20:23], v[40:43]
ds_read_b64_tr_b16 v[214:215], v218 offset:10240
v_xor_b32 v253, 4096, v252
v_mfma_f32_16x16x32_bf16 v[40:43], v[180:183], a[4:7], v[40:43]
s_waitcnt lgkmcnt(6)
v_mfma_f32_16x16x32_bf16 v[60:63], v[192:195], a[8:11], 0
ds_read_b64_tr_b16 v[180:181], v219 offset:0
v_mfma_f32_16x16x32_bf16 v[60:63], v[196:199], a[24:27], v[60:63]
ds_read_b64_tr_b16 v[182:183], v219 offset:2048
v_mfma_f32_16x16x32_bf16 v[60:63], v[200:203], a[40:43], v[60:63]
ds_read_b64_tr_b16 v[184:185], v219 offset:4096
v_mfma_f32_16x16x32_bf16 v[64:67], v[200:203], a[44:47], 0
ds_read_b64_tr_b16 v[186:187], v219 offset:6144
v_mfma_f32_16x16x32_bf16 v[64:67], v[196:199], a[28:31], v[64:67]
s_add_u32 m0, s34, 0
ds_read_b64_tr_b16 v[188:189], v219 offset:8192
s_add_u32 s69, s30, 442368
v_mfma_f32_16x16x32_bf16 v[64:67], v[192:195], a[12:15], v[64:67]
ds_read_b64_tr_b16 v[190:191], v219 offset:10240
v_mfma_f32_16x16x32_bf16 v[52:55], v[192:195], a[0:3], 0
buffer_load_dwordx4 a[224:227], v245, s[20:23], s44 offen offset:2048 sc1
v_mfma_f32_16x16x32_bf16 v[52:55], v[196:199], a[16:19], v[52:55]
buffer_load_dwordx4 a[228:231], v245, s[20:23], s45 offen offset:2048 sc1
v_mfma_f32_16x16x32_bf16 v[52:55], v[200:203], a[32:35], v[52:55]
buffer_load_dwordx4 a[232:235], v245, s[20:23], s46 offen offset:2048 sc1
v_mfma_f32_16x16x32_bf16 v[56:59], v[200:203], a[36:39], 0
v_mfma_f32_16x16x32_bf16 v[56:59], v[196:199], a[20:23], v[56:59]
v_mfma_f32_16x16x32_bf16 v[56:59], v[192:195], a[4:7], v[56:59]
s_waitcnt lgkmcnt(0)
s_barrier
v_mfma_f32_16x16x32_bf16 v[76:79], v[204:207], a[8:11], 0
s_and_b32 s72, s78, 0xffffff80
ds_read_b64_tr_b16 v[192:193], v216 offset:24576
v_cmp_gt_u32 vcc, 32, v1
v_mfma_f32_16x16x32_bf16 v[76:79], v[208:211], a[24:27], v[76:79]
s_mul_i32 s56, s67, 18432
buffer_load_dwordx4 v237, s[16:19], s69 offen offset:0 lds
v_mfma_f32_16x16x32_bf16 v[76:79], v[212:215], a[40:43], v[76:79]
s_add_u32 s69, s30, 458752
ds_read_b64_tr_b16 v[194:195], v216 offset:26624
s_add_u32 s57, s37, s56
v_mfma_f32_16x16x32_bf16 v[80:83], v[212:215], a[44:47], 0
s_lshl_b32 s58, s59, 5
buffer_load_dwordx4 a[236:239], v245, s[20:23], s47 offen offset:2048 sc1
v_mfma_f32_16x16x32_bf16 v[80:83], v[208:211], a[28:31], v[80:83]
s_add_u32 s57, s57, s58
ds_read_b64_tr_b16 v[196:197], v216 offset:28672
s_add_u32 s13, s57, 1024
v_mfma_f32_16x16x32_bf16 v[80:83], v[204:207], a[12:15], v[80:83]
s_and_b32 s57, s32, 1
s_lshl1_add_u32 s57, s59, s57
s_lshl_b32 s58, s57, 7
v_mfma_f32_16x16x32_bf16 v[68:71], v[204:207], a[0:3], 0
s_add_u32 s12, s58, s56
ds_read_b64_tr_b16 v[198:199], v216 offset:30720
s_lshl2_add_u32 s56, s57, s3
v_mfma_f32_16x16x32_bf16 v[68:71], v[208:211], a[16:19], v[68:71]
s_lshl_b32 s56, s56, 4
buffer_load_dwordx4 v237, s[16:19], s69 offen offset:2048 lds
v_mfma_f32_16x16x32_bf16 v[68:71], v[212:215], a[32:35], v[68:71]
s_add_u32 m0, s34, 4096
ds_read_b64_tr_b16 v[200:201], v216 offset:32768
v_mov_b32 v2, s56
v_mfma_f32_16x16x32_bf16 v[72:75], v[212:215], a[36:39], 0
s_add_u32 s69, s30, 479232
s_lshl_b32 s57, s59, 4
s_add_u32 s57, s57, 512
v_mfma_f32_16x16x32_bf16 v[72:75], v[208:211], a[20:23], v[72:75]
s_mov_b32 s76, 47448064
ds_read_b64_tr_b16 v[202:203], v216 offset:34816
v_mov_b32 v3, s57
v_mfma_f32_16x16x32_bf16 v[72:75], v[204:207], a[4:7], v[72:75]
s_lshr_b32 s58, s67, 2
buffer_load_dwordx4 a[240:243], v245, s[20:23], s44 offen offset:3072 sc1
v_mfma_f32_16x16x32_bf16 v[92:95], v[180:183], a[8:11], 0
s_lshl_b32 s58, s58, 7
ds_read_b64_tr_b16 v[204:205], v217 offset:24576
v_add_u32 v216, 0xc000, v216
v_mfma_f32_16x16x32_bf16 v[92:95], v[184:187], a[24:27], v[92:95]
s_add_u32 s58, s58, 41943040
v_cndmask_b32 v3, v3, v2, vcc
v_and_b32 v2, 15, v1
v_mfma_f32_16x16x32_bf16 v[92:95], v[188:191], a[40:43], v[92:95]
s_mul_i32 s50, s56, 4224
ds_read_b64_tr_b16 v[206:207], v217 offset:26624
v_add_lshl_u32 v227, v3, v2, 5
v_mfma_f32_16x16x32_bf16 v[96:99], v[188:191], a[44:47], 0
s_add_u32 s50, s50, s58
buffer_load_dwordx4 v237, s[16:19], s69 offen offset:0 lds
v_mfma_f32_16x16x32_bf16 v[96:99], v[184:187], a[28:31], v[96:99]
s_add_u32 s69, s30, 495616
ds_read_b64_tr_b16 v[208:209], v217 offset:28672
v_and_b32 v2, 15, v1
v_mfma_f32_16x16x32_bf16 v[96:99], v[180:183], a[12:15], v[96:99]
s_and_b32 s56, s3, 1
v_lshlrev_b32 v3, 2, v2
v_mul_u32_u24 v230, 1152, v2
v_mfma_f32_16x16x32_bf16 v[84:87], v[180:183], a[0:3], 0
s_lshl3_add_u32 s57, s56, s57
ds_read_b64_tr_b16 v[210:211], v217 offset:30720
v_lshrrev_b32 v2, 3, v1
v_mfma_f32_16x16x32_bf16 v[84:87], v[184:187], a[16:19], v[84:87]
s_mul_i32 s51, s57, 4224
buffer_load_dwordx4 a[244:247], v245, s[20:23], s45 offen offset:3072 sc1
v_mfma_f32_16x16x32_bf16 v[84:87], v[188:191], a[32:35], v[84:87]
s_add_u32 s51, s51, s58
ds_read_b64_tr_b16 v[212:213], v217 offset:32768
v_mul_u32_u24 v249, 4224, v2
v_mfma_f32_16x16x32_bf16 v[88:91], v[188:191], a[36:39], 0
s_lshl_b32 s48, s3, 11
buffer_load_dwordx4 v237, s[16:19], s69 offen offset:2048 lds
v_mfma_f32_16x16x32_bf16 v[88:91], v[184:187], a[20:23], v[88:91]
s_add_u32 m0, s34, 8192
ds_read_b64_tr_b16 v[214:215], v217 offset:34816
v_lshrrev_b32 v2, 2, v1
v_mfma_f32_16x16x32_bf16 v[88:91], v[180:183], a[4:7], v[88:91]
s_waitcnt vmcnt(31) lgkmcnt(6)
s_add_u32 s69, s30, 516096
s_add_u32 s48, s48, 131072
v_mfma_f32_16x16x32_bf16 v[44:47], v[192:195], a[56:59], v[44:47]
s_lshl_b32 s49, s56, 10
ds_read_b64_tr_b16 v[180:181], v218 offset:24576
v_add_u32 v217, 0xc000, v217
v_mfma_f32_16x16x32_bf16 v[44:47], v[196:199], a[72:75], v[44:47]
s_add_u32 s49, s49, 139264
s_lshl_b32 s57, s67, 6
s_add_u32 s57, s57, 46137344
v_mfma_f32_16x16x32_bf16 v[44:47], v[200:203], a[88:91], v[44:47]
s_waitcnt vmcnt(30)
ds_read_b64_tr_b16 v[182:183], v218 offset:26624
s_and_b32 s56, s67, 3
v_mfma_f32_16x16x32_bf16 v[48:51], v[200:203], a[92:95], v[48:51]
s_lshl_b32 s56, s56, 5
buffer_load_dwordx4 a[248:251], v245, s[20:23], s46 offen offset:3072 sc1
v_mfma_f32_16x16x32_bf16 v[48:51], v[196:199], a[76:79], v[48:51]
s_add_u32 s56, s56, 131072
ds_read_b64_tr_b16 v[184:185], v218 offset:28672
v_lshl_add_u32 v2, v2, 7, s56
v_mfma_f32_16x16x32_bf16 v[48:51], v[192:195], a[60:63], v[48:51]
buffer_load_dwordx4 v238, s[16:19], s69 offen offset:0 lds
v_mfma_f32_16x16x32_bf16 v[36:39], v[192:195], a[48:51], v[36:39]
s_add_u32 s69, s30, 532480
ds_read_b64_tr_b16 v[186:187], v218 offset:30720
v_mfma_f32_16x16x32_bf16 v[36:39], v[196:199], a[64:67], v[36:39]
buffer_load_dword v228, v3, s[20:23], s57 offen sc1
v_mfma_f32_16x16x32_bf16 v[36:39], v[200:203], a[80:83], v[36:39]
ds_read_b64_tr_b16 v[188:189], v218 offset:32768
v_bfe_u32 v3, v1, 4, 1
v_mfma_f32_16x16x32_bf16 v[40:43], v[200:203], a[84:87], v[40:43]
v_lshl_add_u32 v248, v3, 5, v230
v_lshrrev_b32 v3, 5, v1
v_mfma_f32_16x16x32_bf16 v[40:43], v[196:199], a[68:71], v[40:43]
ds_read_b64_tr_b16 v[190:191], v218 offset:34816
v_lshl_add_u32 v248, v3, 4, v248
v_mfma_f32_16x16x32_bf16 v[40:43], v[192:195], a[52:55], v[40:43]
s_waitcnt lgkmcnt(6)
buffer_load_dwordx4 v238, s[16:19], s69 offen offset:2048 lds
v_mfma_f32_16x16x32_bf16 v[60:63], v[204:207], a[56:59], v[60:63]
ds_read_b64_tr_b16 v[192:193], v219 offset:24576
v_add_u32 v218, 0xc000, v218
v_mfma_f32_16x16x32_bf16 v[60:63], v[208:211], a[72:75], v[60:63]
ds_read_b64_tr_b16 v[194:195], v219 offset:26624
v_lshrrev_b32 v3, 4, v1
v_mfma_f32_16x16x32_bf16 v[60:63], v[212:215], a[88:91], v[60:63]
ds_read_b64_tr_b16 v[196:197], v219 offset:28672
v_lshl_add_u32 v230, v3, 3, v230
v_mfma_f32_16x16x32_bf16 v[64:67], v[212:215], a[92:95], v[64:67]
ds_read_b64_tr_b16 v[198:199], v219 offset:30720
v_and_b32 v3, 7, v1
v_mfma_f32_16x16x32_bf16 v[64:67], v[208:211], a[76:79], v[64:67]
s_add_u32 m0, s34, 24576
ds_read_b64_tr_b16 v[200:201], v219 offset:32768
v_lshl_add_u32 v249, v3, 4, v249
v_mfma_f32_16x16x32_bf16 v[64:67], v[204:207], a[60:63], v[64:67]
s_add_u32 s69, s30, 552960
ds_read_b64_tr_b16 v[202:203], v219 offset:34816
v_and_b32 v3, 3, v1
v_mfma_f32_16x16x32_bf16 v[52:55], v[204:207], a[48:51], v[52:55]
buffer_load_dwordx4 a[252:255], v245, s[20:23], s47 offen offset:3072 sc1
v_mfma_f32_16x16x32_bf16 v[52:55], v[208:211], a[64:67], v[52:55]
buffer_load_dwordx2 v[4:5], v246, s[20:23], s44 offen offset:0 sc1
v_mfma_f32_16x16x32_bf16 v[52:55], v[212:215], a[80:83], v[52:55]
v_lshl_add_u32 v250, v3, 3, v2
v_lshlrev_b32 v231, 2, v3
v_mfma_f32_16x16x32_bf16 v[56:59], v[212:215], a[84:87], v[56:59]
v_mfma_f32_16x16x32_bf16 v[56:59], v[208:211], a[68:71], v[56:59]
v_mfma_f32_16x16x32_bf16 v[56:59], v[204:207], a[52:55], v[56:59]
s_waitcnt lgkmcnt(0)
s_barrier
v_mfma_f32_16x16x32_bf16 v[76:79], v[180:183], a[56:59], v[76:79]
ds_read_b64_tr_b16 v[204:205], v216 offset:0
v_add_u32 v219, 0xc000, v219
v_mfma_f32_16x16x32_bf16 v[76:79], v[184:187], a[72:75], v[76:79]
buffer_load_dwordx4 v238, s[16:19], s69 offen offset:0 lds
v_mfma_f32_16x16x32_bf16 v[76:79], v[188:191], a[88:91], v[76:79]
s_add_u32 s69, s30, 569344
ds_read_b64_tr_b16 v[206:207], v216 offset:2048
v_mfma_f32_16x16x32_bf16 v[80:83], v[188:191], a[92:95], v[80:83]
buffer_load_dwordx2 v[6:7], v246, s[20:23], s44 offen offset:512 sc1
v_mfma_f32_16x16x32_bf16 v[80:83], v[184:187], a[76:79], v[80:83]
ds_read_b64_tr_b16 v[208:209], v216 offset:4096
v_mfma_f32_16x16x32_bf16 v[80:83], v[180:183], a[60:63], v[80:83]
v_mfma_f32_16x16x32_bf16 v[68:71], v[180:183], a[48:51], v[68:71]
ds_read_b64_tr_b16 v[210:211], v216 offset:6144
v_mfma_f32_16x16x32_bf16 v[68:71], v[184:187], a[64:67], v[68:71]
buffer_load_dwordx4 v238, s[16:19], s69 offen offset:2048 lds
v_mfma_f32_16x16x32_bf16 v[68:71], v[188:191], a[80:83], v[68:71]
s_add_u32 m0, s34, 28672
ds_read_b64_tr_b16 v[212:213], v216 offset:8192
s_add_u32 s69, s30, 589824
v_mfma_f32_16x16x32_bf16 v[72:75], v[188:191], a[84:87], v[72:75]
v_mfma_f32_16x16x32_bf16 v[72:75], v[184:187], a[68:71], v[72:75]
ds_read_b64_tr_b16 v[214:215], v216 offset:10240
v_mfma_f32_16x16x32_bf16 v[72:75], v[180:183], a[52:55], v[72:75]
buffer_load_dwordx2 v[8:9], v246, s[20:23], s45 offen offset:0 sc1
v_mfma_f32_16x16x32_bf16 v[92:95], v[192:195], a[56:59], v[92:95]
ds_read_b64_tr_b16 v[180:181], v217 offset:0
v_mfma_f32_16x16x32_bf16 v[92:95], v[196:199], a[72:75], v[92:95]
v_mfma_f32_16x16x32_bf16 v[92:95], v[200:203], a[88:91], v[92:95]
ds_read_b64_tr_b16 v[182:183], v217 offset:2048
v_mfma_f32_16x16x32_bf16 v[96:99], v[200:203], a[92:95], v[96:99]
buffer_load_dwordx4 v236, s[16:19], s69 offen offset:0 lds
v_mfma_f32_16x16x32_bf16 v[96:99], v[196:199], a[76:79], v[96:99]
s_add_u32 s69, s30, 606208
ds_read_b64_tr_b16 v[184:185], v217 offset:4096
v_mfma_f32_16x16x32_bf16 v[96:99], v[192:195], a[60:63], v[96:99]
v_mfma_f32_16x16x32_bf16 v[84:87], v[192:195], a[48:51], v[84:87]
ds_read_b64_tr_b16 v[186:187], v217 offset:6144
v_mfma_f32_16x16x32_bf16 v[84:87], v[196:199], a[64:67], v[84:87]
buffer_load_dwordx2 v[10:11], v246, s[20:23], s45 offen offset:512 sc1
v_mfma_f32_16x16x32_bf16 v[84:87], v[200:203], a[80:83], v[84:87]
ds_read_b64_tr_b16 v[188:189], v217 offset:8192
v_mfma_f32_16x16x32_bf16 v[88:91], v[200:203], a[84:87], v[88:91]
buffer_load_dwordx4 v236, s[16:19], s69 offen offset:2048 lds
v_mfma_f32_16x16x32_bf16 v[88:91], v[196:199], a[68:71], v[88:91]
s_add_u32 m0, s34, 32768
ds_read_b64_tr_b16 v[190:191], v217 offset:10240
s_add_u32 s69, s30, 626688
v_mfma_f32_16x16x32_bf16 v[88:91], v[192:195], a[52:55], v[88:91]
s_waitcnt vmcnt(36) lgkmcnt(6)
v_mfma_f32_16x16x32_bf16 v[44:47], v[204:207], a[104:107], v[44:47]
ds_read_b64_tr_b16 v[192:193], v218 offset:0
v_mfma_f32_16x16x32_bf16 v[44:47], v[208:211], a[120:123], v[44:47]
v_mfma_f32_16x16x32_bf16 v[44:47], v[212:215], a[136:139], v[44:47]
s_waitcnt vmcnt(35)
ds_read_b64_tr_b16 v[194:195], v218 offset:2048
v_mfma_f32_16x16x32_bf16 v[48:51], v[212:215], a[140:143], v[48:51]
buffer_load_dwordx2 v[12:13], v246, s[20:23], s46 offen offset:0 sc1
v_mfma_f32_16x16x32_bf16 v[48:51], v[208:211], a[124:127], v[48:51]
ds_read_b64_tr_b16 v[196:197], v218 offset:4096
v_mfma_f32_16x16x32_bf16 v[48:51], v[204:207], a[108:111], v[48:51]
buffer_load_dwordx4 v236, s[16:19], s69 offen offset:0 lds
v_mfma_f32_16x16x32_bf16 v[36:39], v[204:207], a[96:99], v[36:39]
s_add_u32 s69, s30, 643072
ds_read_b64_tr_b16 v[198:199], v218 offset:6144
v_mfma_f32_16x16x32_bf16 v[36:39], v[208:211], a[112:115], v[36:39]
v_mfma_f32_16x16x32_bf16 v[36:39], v[212:215], a[128:131], v[36:39]
ds_read_b64_tr_b16 v[200:201], v218 offset:8192
v_mfma_f32_16x16x32_bf16 v[40:43], v[212:215], a[132:135], v[40:43]
v_mfma_f32_16x16x32_bf16 v[40:43], v[208:211], a[116:119], v[40:43]
ds_read_b64_tr_b16 v[202:203], v218 offset:10240
v_mfma_f32_16x16x32_bf16 v[40:43], v[204:207], a[100:103], v[40:43]
s_waitcnt lgkmcnt(6)
buffer_load_dwordx4 v236, s[16:19], s69 offen offset:2048 lds
v_mfma_f32_16x16x32_bf16 v[60:63], v[180:183], a[104:107], v[60:63]
ds_read_b64_tr_b16 v[204:205], v219 offset:0
v_mfma_f32_16x16x32_bf16 v[60:63], v[184:187], a[120:123], v[60:63]
ds_read_b64_tr_b16 v[206:207], v219 offset:2048
v_mfma_f32_16x16x32_bf16 v[60:63], v[188:191], a[136:139], v[60:63]
ds_read_b64_tr_b16 v[208:209], v219 offset:4096
v_mfma_f32_16x16x32_bf16 v[64:67], v[188:191], a[140:143], v[64:67]
ds_read_b64_tr_b16 v[210:211], v219 offset:6144
v_mfma_f32_16x16x32_bf16 v[64:67], v[184:187], a[124:127], v[64:67]
s_add_u32 m0, s34, 49152
ds_read_b64_tr_b16 v[212:213], v219 offset:8192
s_add_u32 s69, s66, 0
v_mfma_f32_16x16x32_bf16 v[64:67], v[180:183], a[108:111], v[64:67]
ds_read_b64_tr_b16 v[214:215], v219 offset:10240
v_mfma_f32_16x16x32_bf16 v[52:55], v[180:183], a[96:99], v[52:55]
buffer_load_dwordx2 v[14:15], v246, s[20:23], s46 offen offset:512 sc1
v_mfma_f32_16x16x32_bf16 v[52:55], v[184:187], a[112:115], v[52:55]
buffer_load_dwordx2 v[16:17], v246, s[20:23], s47 offen offset:0 sc1
v_mfma_f32_16x16x32_bf16 v[52:55], v[188:191], a[128:131], v[52:55]
v_mfma_f32_16x16x32_bf16 v[56:59], v[188:191], a[132:135], v[56:59]
v_mfma_f32_16x16x32_bf16 v[56:59], v[184:187], a[116:119], v[56:59]
v_mfma_f32_16x16x32_bf16 v[56:59], v[180:183], a[100:103], v[56:59]
s_waitcnt lgkmcnt(0)
s_barrier
v_mfma_f32_16x16x32_bf16 v[76:79], v[192:195], a[104:107], v[76:79]
ds_read_b64_tr_b16 v[180:181], v216 offset:24576
v_mfma_f32_16x16x32_bf16 v[76:79], v[196:199], a[120:123], v[76:79]
buffer_load_dwordx4 v237, s[16:19], s69 offen offset:0 lds
v_mfma_f32_16x16x32_bf16 v[76:79], v[200:203], a[136:139], v[76:79]
s_add_u32 s69, s66, 16384
ds_read_b64_tr_b16 v[182:183], v216 offset:26624
v_mfma_f32_16x16x32_bf16 v[80:83], v[200:203], a[140:143], v[80:83]
buffer_load_dwordx2 v[18:19], v246, s[20:23], s47 offen offset:512 sc1
v_mfma_f32_16x16x32_bf16 v[80:83], v[196:199], a[124:127], v[80:83]
ds_read_b64_tr_b16 v[184:185], v216 offset:28672
v_mfma_f32_16x16x32_bf16 v[80:83], v[192:195], a[108:111], v[80:83]
s_waitcnt vmcnt(33)
buffer_store_dword v224, v225, s[20:23], s77 offen sc1
v_mfma_f32_16x16x32_bf16 v[68:71], v[192:195], a[96:99], v[68:71]
ds_read_b64_tr_b16 v[186:187], v216 offset:30720
v_mfma_f32_16x16x32_bf16 v[68:71], v[196:199], a[112:115], v[68:71]
buffer_load_dwordx4 v237, s[16:19], s69 offen offset:2048 lds
v_mfma_f32_16x16x32_bf16 v[68:71], v[200:203], a[128:131], v[68:71]
s_add_u32 m0, s34, 53248
ds_read_b64_tr_b16 v[188:189], v216 offset:32768
s_add_u32 s69, s66, 36864
v_mfma_f32_16x16x32_bf16 v[72:75], v[200:203], a[132:135], v[72:75]
v_mfma_f32_16x16x32_bf16 v[72:75], v[196:199], a[116:119], v[72:75]
ds_read_b64_tr_b16 v[190:191], v216 offset:34816
v_mfma_f32_16x16x32_bf16 v[72:75], v[192:195], a[100:103], v[72:75]
buffer_load_dwordx2 v[20:21], v246, s[20:23], s44 offen offset:1024 sc1
v_mfma_f32_16x16x32_bf16 v[92:95], v[204:207], a[104:107], v[92:95]
ds_read_b64_tr_b16 v[192:193], v217 offset:24576
v_add_u32 v216, 0xffff4000, v216
v_mfma_f32_16x16x32_bf16 v[92:95], v[208:211], a[120:123], v[92:95]
v_mfma_f32_16x16x32_bf16 v[92:95], v[212:215], a[136:139], v[92:95]
ds_read_b64_tr_b16 v[194:195], v217 offset:26624
v_mfma_f32_16x16x32_bf16 v[96:99], v[212:215], a[140:143], v[96:99]
buffer_load_dwordx4 v237, s[16:19], s69 offen offset:0 lds
v_mfma_f32_16x16x32_bf16 v[96:99], v[208:211], a[124:127], v[96:99]
s_add_u32 s69, s66, 53248
ds_read_b64_tr_b16 v[196:197], v217 offset:28672
v_mfma_f32_16x16x32_bf16 v[96:99], v[204:207], a[108:111], v[96:99]
v_mfma_f32_16x16x32_bf16 v[84:87], v[204:207], a[96:99], v[84:87]
ds_read_b64_tr_b16 v[198:199], v217 offset:30720
v_mfma_f32_16x16x32_bf16 v[84:87], v[208:211], a[112:115], v[84:87]
buffer_load_dwordx2 v[22:23], v246, s[20:23], s44 offen offset:1536 sc1
v_mfma_f32_16x16x32_bf16 v[84:87], v[212:215], a[128:131], v[84:87]
ds_read_b64_tr_b16 v[200:201], v217 offset:32768
v_mfma_f32_16x16x32_bf16 v[88:91], v[212:215], a[132:135], v[88:91]
buffer_load_dwordx4 v237, s[16:19], s69 offen offset:2048 lds
v_mfma_f32_16x16x32_bf16 v[88:91], v[208:211], a[116:119], v[88:91]
s_add_u32 m0, s34, 57344
ds_read_b64_tr_b16 v[202:203], v217 offset:34816
s_add_u32 s69, s66, 73728
v_mfma_f32_16x16x32_bf16 v[88:91], v[204:207], a[100:103], v[88:91]
s_waitcnt vmcnt(37) lgkmcnt(6)
v_mfma_f32_16x16x32_bf16 v[44:47], v[180:183], a[152:155], v[44:47]
ds_read_b64_tr_b16 v[204:205], v218 offset:24576
v_add_u32 v217, 0xffff4000, v217
v_mfma_f32_16x16x32_bf16 v[44:47], v[184:187], a[168:171], v[44:47]
v_mfma_f32_16x16x32_bf16 v[44:47], v[188:191], a[184:187], v[44:47]
s_waitcnt vmcnt(36)
ds_read_b64_tr_b16 v[206:207], v218 offset:26624
v_mfma_f32_16x16x32_bf16 v[48:51], v[188:191], a[188:191], v[48:51]
buffer_load_dwordx2 v[24:25], v246, s[20:23], s45 offen offset:1024 sc1
v_mfma_f32_16x16x32_bf16 v[48:51], v[184:187], a[172:175], v[48:51]
ds_read_b64_tr_b16 v[208:209], v218 offset:28672
v_mfma_f32_16x16x32_bf16 v[48:51], v[180:183], a[156:159], v[48:51]
buffer_load_dwordx4 v238, s[16:19], s69 offen offset:0 lds
v_mfma_f32_16x16x32_bf16 v[36:39], v[180:183], a[144:147], v[36:39]
s_add_u32 s69, s66, 90112
ds_read_b64_tr_b16 v[210:211], v218 offset:30720
v_mfma_f32_16x16x32_bf16 v[36:39], v[184:187], a[160:163], v[36:39]
v_mfma_f32_16x16x32_bf16 v[36:39], v[188:191], a[176:179], v[36:39]
ds_read_b64_tr_b16 v[212:213], v218 offset:32768
v_mfma_f32_16x16x32_bf16 v[40:43], v[188:191], a[180:183], v[40:43]
v_mfma_f32_16x16x32_bf16 v[40:43], v[184:187], a[164:167], v[40:43]
ds_read_b64_tr_b16 v[214:215], v218 offset:34816
v_mfma_f32_16x16x32_bf16 v[40:43], v[180:183], a[148:151], v[40:43]
s_waitcnt lgkmcnt(6)
buffer_load_dwordx4 v238, s[16:19], s69 offen offset:2048 lds
v_mfma_f32_16x16x32_bf16 v[60:63], v[192:195], a[152:155], v[60:63]
ds_read_b64_tr_b16 v[180:181], v219 offset:24576
v_add_u32 v218, 0xffff4000, v218
v_mfma_f32_16x16x32_bf16 v[60:63], v[196:199], a[168:171], v[60:63]
ds_read_b64_tr_b16 v[182:183], v219 offset:26624
v_mfma_f32_16x16x32_bf16 v[60:63], v[200:203], a[184:187], v[60:63]
ds_read_b64_tr_b16 v[184:185], v219 offset:28672
v_mfma_f32_16x16x32_bf16 v[64:67], v[200:203], a[188:191], v[64:67]
ds_read_b64_tr_b16 v[186:187], v219 offset:30720
v_mfma_f32_16x16x32_bf16 v[64:67], v[196:199], a[172:175], v[64:67]
s_add_u32 m0, s34, 73728
ds_read_b64_tr_b16 v[188:189], v219 offset:32768
s_add_u32 s69, s66, 110592
v_mfma_f32_16x16x32_bf16 v[64:67], v[192:195], a[156:159], v[64:67]
ds_read_b64_tr_b16 v[190:191], v219 offset:34816
v_mfma_f32_16x16x32_bf16 v[52:55], v[192:195], a[144:147], v[52:55]
buffer_load_dwordx2 v[26:27], v246, s[20:23], s45 offen offset:1536 sc1
v_mfma_f32_16x16x32_bf16 v[52:55], v[196:199], a[160:163], v[52:55]
buffer_load_dwordx2 v[28:29], v246, s[20:23], s46 offen offset:1024 sc1
v_mfma_f32_16x16x32_bf16 v[52:55], v[200:203], a[176:179], v[52:55]
v_mfma_f32_16x16x32_bf16 v[56:59], v[200:203], a[180:183], v[56:59]
v_mfma_f32_16x16x32_bf16 v[56:59], v[196:199], a[164:167], v[56:59]
v_mfma_f32_16x16x32_bf16 v[56:59], v[192:195], a[148:151], v[56:59]
s_waitcnt vmcnt(27) lgkmcnt(0)
s_barrier
v_mfma_f32_16x16x32_bf16 v[76:79], v[204:207], a[152:155], v[76:79]
ds_read_b64_tr_b16 v[192:193], v216 offset:0
v_add_u32 v219, 0xffff4000, v219
v_mfma_f32_16x16x32_bf16 v[76:79], v[208:211], a[168:171], v[76:79]
buffer_load_dwordx4 v238, s[16:19], s69 offen offset:0 lds
v_mfma_f32_16x16x32_bf16 v[76:79], v[212:215], a[184:187], v[76:79]
s_add_u32 s69, s66, 126976
ds_read_b64_tr_b16 v[194:195], v216 offset:2048
v_mfma_f32_16x16x32_bf16 v[80:83], v[212:215], a[188:191], v[80:83]
buffer_load_dwordx2 v[30:31], v246, s[20:23], s46 offen offset:1536 sc1
v_mfma_f32_16x16x32_bf16 v[80:83], v[208:211], a[172:175], v[80:83]
ds_read_b64_tr_b16 v[196:197], v216 offset:4096
v_mfma_f32_16x16x32_bf16 v[80:83], v[204:207], a[156:159], v[80:83]
v_mfma_f32_16x16x32_bf16 v[68:71], v[204:207], a[144:147], v[68:71]
ds_read_b64_tr_b16 v[198:199], v216 offset:6144
v_mfma_f32_16x16x32_bf16 v[68:71], v[208:211], a[160:163], v[68:71]
buffer_load_dwordx4 v238, s[16:19], s69 offen offset:2048 lds
v_mfma_f32_16x16x32_bf16 v[68:71], v[212:215], a[176:179], v[68:71]
s_add_u32 m0, s34, 77824
ds_read_b64_tr_b16 v[200:201], v216 offset:8192
s_add_u32 s69, s66, 147456
v_mfma_f32_16x16x32_bf16 v[72:75], v[212:215], a[180:183], v[72:75]
v_mfma_f32_16x16x32_bf16 v[72:75], v[208:211], a[164:167], v[72:75]
ds_read_b64_tr_b16 v[202:203], v216 offset:10240
v_mfma_f32_16x16x32_bf16 v[72:75], v[204:207], a[148:151], v[72:75]
buffer_load_dwordx2 v[32:33], v246, s[20:23], s47 offen offset:1024 sc1
v_mfma_f32_16x16x32_bf16 v[92:95], v[180:183], a[152:155], v[92:95]
ds_read_b64_tr_b16 v[204:205], v217 offset:0
v_mfma_f32_16x16x32_bf16 v[92:95], v[184:187], a[168:171], v[92:95]
v_mfma_f32_16x16x32_bf16 v[92:95], v[188:191], a[184:187], v[92:95]
ds_read_b64_tr_b16 v[206:207], v217 offset:2048
v_mfma_f32_16x16x32_bf16 v[96:99], v[188:191], a[188:191], v[96:99]
buffer_load_dwordx4 v237, s[16:19], s69 offen offset:0 lds
v_mfma_f32_16x16x32_bf16 v[96:99], v[184:187], a[172:175], v[96:99]
s_add_u32 s69, s66, 163840
ds_read_b64_tr_b16 v[208:209], v217 offset:4096
v_mfma_f32_16x16x32_bf16 v[96:99], v[180:183], a[156:159], v[96:99]
v_mfma_f32_16x16x32_bf16 v[84:87], v[180:183], a[144:147], v[84:87]
ds_read_b64_tr_b16 v[210:211], v217 offset:6144
v_mfma_f32_16x16x32_bf16 v[84:87], v[184:187], a[160:163], v[84:87]
buffer_load_dwordx2 v[34:35], v246, s[20:23], s47 offen offset:1536 sc1
v_mfma_f32_16x16x32_bf16 v[84:87], v[188:191], a[176:179], v[84:87]
ds_read_b64_tr_b16 v[212:213], v217 offset:8192
v_mfma_f32_16x16x32_bf16 v[88:91], v[188:191], a[180:183], v[88:91]
buffer_load_dwordx4 v237, s[16:19], s69 offen offset:2048 lds
v_mfma_f32_16x16x32_bf16 v[88:91], v[184:187], a[164:167], v[88:91]
s_add_u32 m0, s34, 81920
ds_read_b64_tr_b16 v[214:215], v217 offset:10240
s_add_u32 s69, s66, 184320
v_mfma_f32_16x16x32_bf16 v[88:91], v[180:183], a[148:151], v[88:91]
s_waitcnt lgkmcnt(6)
v_mfma_f32_16x16x32_bf16 v[44:47], v[192:195], a[200:203], v[44:47]
ds_read_b64_tr_b16 v[180:181], v218 offset:0
v_mfma_f32_16x16x32_bf16 v[44:47], v[196:199], a[216:219], v[44:47]
v_mfma_f32_16x16x32_bf16 v[44:47], v[200:203], a[232:235], v[44:47]
ds_read_b64_tr_b16 v[182:183], v218 offset:2048
v_mfma_f32_16x16x32_bf16 v[48:51], v[200:203], a[236:239], v[48:51]
v_mfma_f32_16x16x32_bf16 v[48:51], v[196:199], a[220:223], v[48:51]
ds_read_b64_tr_b16 v[184:185], v218 offset:4096
v_mfma_f32_16x16x32_bf16 v[48:51], v[192:195], a[204:207], v[48:51]
buffer_load_dwordx4 v237, s[16:19], s69 offen offset:0 lds
v_mfma_f32_16x16x32_bf16 v[36:39], v[192:195], a[192:195], v[36:39]
s_add_u32 s69, s66, 200704
ds_read_b64_tr_b16 v[186:187], v218 offset:6144
v_mfma_f32_16x16x32_bf16 v[36:39], v[196:199], a[208:211], v[36:39]
v_mfma_f32_16x16x32_bf16 v[36:39], v[200:203], a[224:227], v[36:39]
ds_read_b64_tr_b16 v[188:189], v218 offset:8192
v_mov_b32 v164, -1
v_mfma_f32_16x16x32_bf16 v[40:43], v[200:203], a[228:231], v[40:43]
v_mov_b32 v165, -1
v_mov_b32 v166, -1
v_mfma_f32_16x16x32_bf16 v[40:43], v[196:199], a[212:215], v[40:43]
PAD_16:
s_cmp_lg_u32 s73, 0
s_cbranch_scc1 PAD_20
ds_read_b64_tr_b16 v[190:191], v218 offset:10240
v_mov_b32 v167, -1
v_mfma_f32_16x16x32_bf16 v[40:43], v[192:195], a[196:199], v[40:43]
s_waitcnt lgkmcnt(6)
buffer_load_dwordx4 v237, s[16:19], s69 offen offset:2048 lds
v_mfma_f32_16x16x32_bf16 v[60:63], v[204:207], a[200:203], v[60:63]
ds_read_b64_tr_b16 v[192:193], v219 offset:0
v_mfma_f32_16x16x32_bf16 v[60:63], v[208:211], a[216:219], v[60:63]
ds_read_b64_tr_b16 v[194:195], v219 offset:2048
v_mfma_f32_16x16x32_bf16 v[60:63], v[212:215], a[232:235], v[60:63]
ds_read_b64_tr_b16 v[196:197], v219 offset:4096
v_mfma_f32_16x16x32_bf16 v[64:67], v[212:215], a[236:239], v[64:67]
ds_read_b64_tr_b16 v[198:199], v219 offset:6144
v_mfma_f32_16x16x32_bf16 v[64:67], v[208:211], a[220:223], v[64:67]
s_add_u32 m0, s34, 0
ds_read_b64_tr_b16 v[200:201], v219 offset:8192
s_add_u32 s69, s66, 221184
v_mfma_f32_16x16x32_bf16 v[64:67], v[204:207], a[204:207], v[64:67]
ds_read_b64_tr_b16 v[202:203], v219 offset:10240
v_mfma_f32_16x16x32_bf16 v[52:55], v[204:207], a[192:195], v[52:55]
buffer_store_dwordx4 v[164:167], v242, s[20:23], s81 offen offset:0 sc1
v_mfma_f32_16x16x32_bf16 v[52:55], v[208:211], a[208:211], v[52:55]
v_mfma_f32_16x16x32_bf16 v[52:55], v[212:215], a[224:227], v[52:55]
buffer_store_dwordx4 v[164:167], v242, s[20:23], s81 offen offset:1024 sc1
v_mfma_f32_16x16x32_bf16 v[56:59], v[212:215], a[228:231], v[56:59]
v_mfma_f32_16x16x32_bf16 v[56:59], v[208:211], a[212:215], v[56:59]
v_mfma_f32_16x16x32_bf16 v[56:59], v[204:207], a[196:199], v[56:59]
s_waitcnt vmcnt(26) lgkmcnt(0)
s_barrier
v_mfma_f32_16x16x32_bf16 v[76:79], v[180:183], a[200:203], v[76:79]
ds_read_b64_tr_b16 v[204:205], v216 offset:24576
v_mfma_f32_16x16x32_bf16 v[76:79], v[184:187], a[216:219], v[76:79]
buffer_load_dwordx4 v238, s[16:19], s69 offen offset:0 lds
v_mfma_f32_16x16x32_bf16 v[76:79], v[188:191], a[232:235], v[76:79]
s_add_u32 s69, s66, 237568
ds_read_b64_tr_b16 v[206:207], v216 offset:26624
v_mfma_f32_16x16x32_bf16 v[80:83], v[188:191], a[236:239], v[80:83]
v_mfma_f32_16x16x32_bf16 v[80:83], v[184:187], a[220:223], v[80:83]
ds_read_b64_tr_b16 v[208:209], v216 offset:28672
v_mfma_f32_16x16x32_bf16 v[80:83], v[180:183], a[204:207], v[80:83]
v_mfma_f32_16x16x32_bf16 v[68:71], v[180:183], a[192:195], v[68:71]
ds_read_b64_tr_b16 v[210:211], v216 offset:30720
v_mfma_f32_16x16x32_bf16 v[68:71], v[184:187], a[208:211], v[68:71]
buffer_load_dwordx4 v238, s[16:19], s69 offen offset:2048 lds
v_mfma_f32_16x16x32_bf16 v[68:71], v[188:191], a[224:227], v[68:71]
s_add_u32 m0, s34, 4096
ds_read_b64_tr_b16 v[212:213], v216 offset:32768
s_add_u32 s69, s66, 258048
v_mfma_f32_16x16x32_bf16 v[72:75], v[188:191], a[228:231], v[72:75]
buffer_store_dwordx2 v[164:165], v247, s[20:23], s40 offen sc1
v_mfma_f32_16x16x32_bf16 v[72:75], v[184:187], a[212:215], v[72:75]
ds_read_b64_tr_b16 v[214:215], v216 offset:34816
v_mfma_f32_16x16x32_bf16 v[72:75], v[180:183], a[196:199], v[72:75]
v_mfma_f32_16x16x32_bf16 v[92:95], v[192:195], a[200:203], v[92:95]
ds_read_b64_tr_b16 v[180:181], v217 offset:24576
v_add_u32 v216, 0xc000, v216
v_mfma_f32_16x16x32_bf16 v[92:95], v[196:199], a[216:219], v[92:95]
v_mfma_f32_16x16x32_bf16 v[92:95], v[200:203], a[232:235], v[92:95]
ds_read_b64_tr_b16 v[182:183], v217 offset:26624
v_mfma_f32_16x16x32_bf16 v[96:99], v[200:203], a[236:239], v[96:99]
buffer_load_dwordx4 v238, s[16:19], s69 offen offset:0 lds
v_mfma_f32_16x16x32_bf16 v[96:99], v[196:199], a[220:223], v[96:99]
s_add_u32 s69, s66, 274432
ds_read_b64_tr_b16 v[184:185], v217 offset:28672
v_mfma_f32_16x16x32_bf16 v[96:99], v[192:195], a[204:207], v[96:99]
v_mfma_f32_16x16x32_bf16 v[84:87], v[192:195], a[192:195], v[84:87]
ds_read_b64_tr_b16 v[186:187], v217 offset:30720
v_mfma_f32_16x16x32_bf16 v[84:87], v[196:199], a[208:211], v[84:87]
v_mfma_f32_16x16x32_bf16 v[84:87], v[200:203], a[224:227], v[84:87]
ds_read_b64_tr_b16 v[188:189], v217 offset:32768
v_mfma_f32_16x16x32_bf16 v[88:91], v[200:203], a[228:231], v[88:91]
buffer_load_dwordx4 v238, s[16:19], s69 offen offset:2048 lds
v_mfma_f32_16x16x32_bf16 v[88:91], v[196:199], a[212:215], v[88:91]
s_add_u32 m0, s34, 8192
ds_read_b64_tr_b16 v[190:191], v217 offset:34816
s_add_u32 s69, s66, 294912
v_mfma_f32_16x16x32_bf16 v[88:91], v[192:195], a[196:199], v[88:91]
s_waitcnt vmcnt(14) lgkmcnt(6)
buffer_store_dwordx2 v[164:165], v247, s[20:23], s41 offen sc1
v_mfma_f32_16x16x32_bf16 v[44:47], v[204:207], a[248:251], v[44:47]
ds_read_b64_tr_b16 v[192:193], v218 offset:24576
v_add_u32 v217, 0xc000, v217
v_mfma_f32_16x16x32_bf16 v[44:47], v[208:211], v[12:15], v[44:47]
v_mfma_f32_16x16x32_bf16 v[44:47], v[212:215], v[28:31], v[44:47]
s_waitcnt vmcnt(11)
ds_read_b64_tr_b16 v[194:195], v218 offset:26624
v_mfma_f32_16x16x32_bf16 v[48:51], v[212:215], v[32:35], v[48:51]
v_mfma_f32_16x16x32_bf16 v[48:51], v[208:211], v[16:19], v[48:51]
ds_read_b64_tr_b16 v[196:197], v218 offset:28672
v_mfma_f32_16x16x32_bf16 v[48:51], v[204:207], a[252:255], v[48:51]
buffer_load_dwordx4 v237, s[16:19], s69 offen offset:0 lds
v_mfma_f32_16x16x32_bf16 v[36:39], v[204:207], a[240:243], v[36:39]
s_add_u32 s69, s66, 311296
ds_read_b64_tr_b16 v[198:199], v218 offset:30720
v_mfma_f32_16x16x32_bf16 v[36:39], v[208:211], v[4:7], v[36:39]
ds_write_b64 v222, v[44:45] offset:0
v_mfma_f32_16x16x32_bf16 v[36:39], v[212:215], v[20:23], v[36:39]
ds_read_b64_tr_b16 v[200:201], v218 offset:32768
v_mfma_f32_16x16x32_bf16 v[40:43], v[212:215], v[24:27], v[40:43]
ds_write_b64 v222, v[46:47] offset:512
v_mfma_f32_16x16x32_bf16 v[40:43], v[208:211], v[8:11], v[40:43]
ds_read_b64_tr_b16 v[202:203], v218 offset:34816
v_mfma_f32_16x16x32_bf16 v[40:43], v[204:207], a[244:247], v[40:43]
s_waitcnt lgkmcnt(8)
buffer_load_dwordx4 v237, s[16:19], s69 offen offset:2048 lds
v_mfma_f32_16x16x32_bf16 v[60:63], v[180:183], a[248:251], v[60:63]
ds_read_b64_tr_b16 v[204:205], v219 offset:24576
v_add_u32 v218, 0xc000, v218
v_mfma_f32_16x16x32_bf16 v[60:63], v[184:187], v[12:15], v[60:63]
ds_read_b64_tr_b16 v[206:207], v219 offset:26624
v_mfma_f32_16x16x32_bf16 v[60:63], v[188:191], v[28:31], v[60:63]
ds_read_b64_tr_b16 v[208:209], v219 offset:28672
v_mfma_f32_16x16x32_bf16 v[64:67], v[188:191], v[32:35], v[64:67]
ds_read_b64_tr_b16 v[210:211], v219 offset:30720
v_mfma_f32_16x16x32_bf16 v[64:67], v[184:187], v[16:19], v[64:67]
s_add_u32 m0, s34, 24576
ds_read_b64_tr_b16 v[212:213], v219 offset:32768
s_add_u32 s69, s66, 331776
v_mfma_f32_16x16x32_bf16 v[64:67], v[180:183], a[252:255], v[64:67]
ds_read_b64_tr_b16 v[214:215], v219 offset:34816
v_mfma_f32_16x16x32_bf16 v[52:55], v[180:183], a[240:243], v[52:55]
v_mfma_f32_16x16x32_bf16 v[52:55], v[184:187], v[4:7], v[52:55]
v_mfma_f32_16x16x32_bf16 v[52:55], v[188:191], v[20:23], v[52:55]
v_mfma_f32_16x16x32_bf16 v[56:59], v[188:191], v[24:27], v[56:59]
v_mfma_f32_16x16x32_bf16 v[56:59], v[184:187], v[8:11], v[56:59]
v_mfma_f32_16x16x32_bf16 v[56:59], v[180:183], a[244:247], v[56:59]
s_waitcnt lgkmcnt(0)
s_barrier
v_mfma_f32_16x16x32_bf16 v[76:79], v[192:195], a[248:251], v[76:79]
ds_read_b64_tr_b16 v[180:181], v216 offset:0
v_add_u32 v219, 0xc000, v219
v_mfma_f32_16x16x32_bf16 v[76:79], v[196:199], v[12:15], v[76:79]
buffer_load_dwordx4 v237, s[16:19], s69 offen offset:0 lds
v_mfma_f32_16x16x32_bf16 v[76:79], v[200:203], v[28:31], v[76:79]
s_add_u32 s69, s66, 348160
ds_read_b64_tr_b16 v[182:183], v216 offset:2048
v_mfma_f32_16x16x32_bf16 v[80:83], v[200:203], v[32:35], v[80:83]
ds_write_b64 v222, v[48:49] offset:1024
v_mfma_f32_16x16x32_bf16 v[80:83], v[196:199], v[16:19], v[80:83]
ds_read_b64_tr_b16 v[184:185], v216 offset:4096
v_mfma_f32_16x16x32_bf16 v[80:83], v[192:195], a[252:255], v[80:83]
ds_write_b64 v222, v[50:51] offset:1536
v_mfma_f32_16x16x32_bf16 v[68:71], v[192:195], a[240:243], v[68:71]
ds_read_b64_tr_b16 v[186:187], v216 offset:6144
v_mfma_f32_16x16x32_bf16 v[68:71], v[196:199], v[4:7], v[68:71]
buffer_load_dwordx4 v237, s[16:19], s69 offen offset:2048 lds
v_mfma_f32_16x16x32_bf16 v[68:71], v[200:203], v[20:23], v[68:71]
s_add_u32 m0, s34, 28672
ds_read_b64_tr_b16 v[188:189], v216 offset:8192
s_add_u32 s69, s66, 368640
v_mfma_f32_16x16x32_bf16 v[72:75], v[200:203], v[24:27], v[72:75]
ds_write_b64 v222, v[60:61] offset:2048
v_mfma_f32_16x16x32_bf16 v[72:75], v[196:199], v[8:11], v[72:75]
ds_read_b64_tr_b16 v[190:191], v216 offset:10240
v_mfma_f32_16x16x32_bf16 v[72:75], v[192:195], a[244:247], v[72:75]
ds_write_b64 v222, v[62:63] offset:2560
v_mfma_f32_16x16x32_bf16 v[92:95], v[204:207], a[248:251], v[92:95]
ds_read_b64_tr_b16 v[192:193], v217 offset:0
v_mfma_f32_16x16x32_bf16 v[92:95], v[208:211], v[12:15], v[92:95]
ds_write_b64 v222, v[64:65] offset:3072
v_mfma_f32_16x16x32_bf16 v[92:95], v[212:215], v[28:31], v[92:95]
ds_read_b64_tr_b16 v[194:195], v217 offset:2048
v_mfma_f32_16x16x32_bf16 v[96:99], v[212:215], v[32:35], v[96:99]
buffer_load_dwordx4 v238, s[16:19], s69 offen offset:0 lds
v_mfma_f32_16x16x32_bf16 v[96:99], v[208:211], v[16:19], v[96:99]
s_add_u32 s69, s66, 385024
ds_read_b64_tr_b16 v[196:197], v217 offset:4096
v_mfma_f32_16x16x32_bf16 v[96:99], v[204:207], a[252:255], v[96:99]
ds_write_b64 v222, v[66:67] offset:3584
v_mfma_f32_16x16x32_bf16 v[84:87], v[204:207], a[240:243], v[84:87]
ds_read_b64_tr_b16 v[198:199], v217 offset:6144
v_mfma_f32_16x16x32_bf16 v[84:87], v[208:211], v[4:7], v[84:87]
ds_write_b64 v222, v[76:77] offset:4096
v_mfma_f32_16x16x32_bf16 v[84:87], v[212:215], v[20:23], v[84:87]
ds_read_b64_tr_b16 v[200:201], v217 offset:8192
v_mfma_f32_16x16x32_bf16 v[88:91], v[212:215], v[24:27], v[88:91]
buffer_load_dwordx4 v238, s[16:19], s69 offen offset:2048 lds
v_mfma_f32_16x16x32_bf16 v[88:91], v[208:211], v[8:11], v[88:91]
s_add_u32 m0, s34, 32768
ds_read_b64_tr_b16 v[202:203], v217 offset:10240
s_add_u32 s69, s66, 405504
v_mfma_f32_16x16x32_bf16 v[88:91], v[204:207], a[244:247], v[88:91]
s_waitcnt lgkmcnt(10)
ds_write_b64 v222, v[78:79] offset:4608
v_mfma_f32_16x16x32_bf16 v[108:111], v[180:183], a[8:11], 0
ds_read_b64_tr_b16 v[204:205], v218 offset:0
v_mfma_f32_16x16x32_bf16 v[108:111], v[184:187], a[24:27], v[108:111]
ds_write_b64 v222, v[80:81] offset:5120
v_mfma_f32_16x16x32_bf16 v[108:111], v[188:191], a[40:43], v[108:111]
ds_read_b64_tr_b16 v[206:207], v218 offset:2048
v_mfma_f32_16x16x32_bf16 v[112:115], v[188:191], a[44:47], 0
ds_write_b64 v222, v[82:83] offset:5632
v_mfma_f32_16x16x32_bf16 v[112:115], v[184:187], a[28:31], v[112:115]
ds_read_b64_tr_b16 v[208:209], v218 offset:4096
v_mfma_f32_16x16x32_bf16 v[112:115], v[180:183], a[12:15], v[112:115]
buffer_load_dwordx4 v238, s[16:19], s69 offen offset:0 lds
v_mfma_f32_16x16x32_bf16 v[100:103], v[180:183], a[0:3], 0
s_add_u32 s69, s66, 421888
ds_read_b64_tr_b16 v[210:211], v218 offset:6144
v_mfma_f32_16x16x32_bf16 v[100:103], v[184:187], a[16:19], v[100:103]
ds_write_b64 v222, v[92:93] offset:6144
v_mfma_f32_16x16x32_bf16 v[100:103], v[188:191], a[32:35], v[100:103]
ds_read_b64_tr_b16 v[212:213], v218 offset:8192
v_mfma_f32_16x16x32_bf16 v[104:107], v[188:191], a[36:39], 0
ds_write_b64 v222, v[94:95] offset:6656
v_mfma_f32_16x16x32_bf16 v[104:107], v[184:187], a[20:23], v[104:107]
ds_read_b64_tr_b16 v[214:215], v218 offset:10240
v_mfma_f32_16x16x32_bf16 v[104:107], v[180:183], a[4:7], v[104:107]
s_waitcnt lgkmcnt(11)
buffer_load_dwordx4 v238, s[16:19], s69 offen offset:2048 lds
v_mfma_f32_16x16x32_bf16 v[124:127], v[192:195], a[8:11], 0
ds_read_b64_tr_b16 v[180:181], v219 offset:0
v_mfma_f32_16x16x32_bf16 v[124:127], v[196:199], a[24:27], v[124:127]
ds_read_b64_tr_b16 v[182:183], v219 offset:2048
v_mfma_f32_16x16x32_bf16 v[124:127], v[200:203], a[40:43], v[124:127]
ds_read_b64_tr_b16 v[184:185], v219 offset:4096
v_mfma_f32_16x16x32_bf16 v[128:131], v[200:203], a[44:47], 0
ds_read_b64_tr_b16 v[186:187], v219 offset:6144
ds_write_b64 v222, v[96:97] offset:7168
ds_write_b64 v222, v[98:99] offset:7680
v_mfma_f32_16x16x32_bf16 v[128:131], v[196:199], a[28:31], v[128:131]
s_add_u32 m0, s34, 49152
ds_read_b64_tr_b16 v[188:189], v219 offset:8192
s_add_u32 s69, s66, 442368
v_mfma_f32_16x16x32_bf16 v[128:131], v[192:195], a[12:15], v[128:131]
ds_read_b64_tr_b16 v[190:191], v219 offset:10240
v_mfma_f32_16x16x32_bf16 v[116:119], v[192:195], a[0:3], 0
v_mfma_f32_16x16x32_bf16 v[116:119], v[196:199], a[16:19], v[116:119]
v_mfma_f32_16x16x32_bf16 v[116:119], v[200:203], a[32:35], v[116:119]
v_mfma_f32_16x16x32_bf16 v[120:123], v[200:203], a[36:39], 0
v_mfma_f32_16x16x32_bf16 v[120:123], v[196:199], a[20:23], v[120:123]
v_mfma_f32_16x16x32_bf16 v[120:123], v[192:195], a[4:7], v[120:123]
s_waitcnt vmcnt(16) lgkmcnt(0)
s_barrier
v_mfma_f32_16x16x32_bf16 v[140:143], v[204:207], a[8:11], 0
ds_read_b64_tr_b16 v[192:193], v216 offset:24576
v_mfma_f32_16x16x32_bf16 v[140:143], v[208:211], a[24:27], v[140:143]
buffer_load_dwordx4 v237, s[16:19], s69 offen offset:0 lds
v_mfma_f32_16x16x32_bf16 v[140:143], v[212:215], a[40:43], v[140:143]
s_add_u32 s69, s66, 458752
ds_read_b64_tr_b16 v[194:195], v216 offset:26624
v_mfma_f32_16x16x32_bf16 v[144:147], v[212:215], a[44:47], 0
ds_read2st64_b64 v[44:47], v223 offset0:0 offset1:1
v_mfma_f32_16x16x32_bf16 v[144:147], v[208:211], a[28:31], v[144:147]
ds_read_b64_tr_b16 v[196:197], v216 offset:28672
v_mfma_f32_16x16x32_bf16 v[144:147], v[204:207], a[12:15], v[144:147]
ds_read2st64_b64 v[60:63], v223 offset0:4 offset1:5
v_mfma_f32_16x16x32_bf16 v[132:135], v[204:207], a[0:3], 0
ds_read_b64_tr_b16 v[198:199], v216 offset:30720
v_mfma_f32_16x16x32_bf16 v[132:135], v[208:211], a[16:19], v[132:135]
buffer_load_dwordx4 v237, s[16:19], s69 offen offset:2048 lds
v_mfma_f32_16x16x32_bf16 v[132:135], v[212:215], a[32:35], v[132:135]
s_add_u32 m0, s34, 53248
ds_read_b64_tr_b16 v[200:201], v216 offset:32768
s_add_u32 s69, s66, 479232
v_mfma_f32_16x16x32_bf16 v[136:139], v[212:215], a[36:39], 0
s_waitcnt lgkmcnt(4)
ds_read2st64_b64 v[76:79], v223 offset0:8 offset1:9
v_add_f32 v44, v36, v44
v_mfma_f32_16x16x32_bf16 v[136:139], v[208:211], a[20:23], v[136:139]
s_waitcnt lgkmcnt(3)
ds_read_b64_tr_b16 v[202:203], v216 offset:34816
v_add_f32 v45, v37, v45
v_mfma_f32_16x16x32_bf16 v[136:139], v[204:207], a[4:7], v[136:139]
ds_read2st64_b64 v[92:95], v223 offset0:12 offset1:13
v_add_f32 v46, v38, v46
v_mfma_f32_16x16x32_bf16 v[156:159], v[180:183], a[8:11], 0
s_waitcnt lgkmcnt(2)
ds_read_b64_tr_b16 v[204:205], v217 offset:24576
v_add_u32 v216, 0xffff4000, v216
v_mfma_f32_16x16x32_bf16 v[156:159], v[184:187], a[24:27], v[156:159]
ds_read2st64_b64 v[48:51], v223 offset0:2 offset1:3
v_add_f32 v47, v39, v47
v_mfma_f32_16x16x32_bf16 v[156:159], v[188:191], a[40:43], v[156:159]
s_waitcnt lgkmcnt(2)
ds_read_b64_tr_b16 v[206:207], v217 offset:26624
v_cvt_pk_bf16_f32 v36, v44, v45
v_mfma_f32_16x16x32_bf16 v[160:163], v[188:191], a[44:47], 0
buffer_load_dwordx4 v237, s[16:19], s69 offen offset:0 lds
v_mfma_f32_16x16x32_bf16 v[160:163], v[184:187], a[28:31], v[160:163]
s_add_u32 s69, s66, 495616
ds_read_b64_tr_b16 v[208:209], v217 offset:28672
v_cvt_pk_bf16_f32 v37, v46, v47
v_mfma_f32_16x16x32_bf16 v[160:163], v[180:183], a[12:15], v[160:163]
s_waitcnt lgkmcnt(2)
ds_read2st64_b64 v[64:67], v223 offset0:6 offset1:7
v_add_f32 v60, v52, v60
v_mfma_f32_16x16x32_bf16 v[148:151], v[180:183], a[0:3], 0
ds_read_b64_tr_b16 v[210:211], v217 offset:30720
v_add_f32 v61, v53, v61
v_mfma_f32_16x16x32_bf16 v[148:151], v[184:187], a[16:19], v[148:151]
ds_read2st64_b64 v[80:83], v223 offset0:10 offset1:11
v_add_f32 v62, v54, v62
v_mfma_f32_16x16x32_bf16 v[148:151], v[188:191], a[32:35], v[148:151]
ds_read_b64_tr_b16 v[212:213], v217 offset:32768
v_add_f32 v63, v55, v63
v_mfma_f32_16x16x32_bf16 v[152:155], v[188:191], a[36:39], 0
s_waitcnt lgkmcnt(3)
buffer_load_dwordx4 v237, s[16:19], s69 offen offset:2048 lds
v_mfma_f32_16x16x32_bf16 v[152:155], v[184:187], a[20:23], v[152:155]
s_add_u32 m0, s34, 57344
ds_read_b64_tr_b16 v[214:215], v217 offset:34816
v_cvt_pk_bf16_f32 v38, v60, v61
v_mfma_f32_16x16x32_bf16 v[152:155], v[180:183], a[4:7], v[152:155]
s_add_u32 s69, s66, 516096
ds_read2st64_b64 v[96:99], v223 offset0:14 offset1:15
v_cvt_pk_bf16_f32 v39, v62, v63
v_mfma_f32_16x16x32_bf16 v[108:111], v[192:195], a[56:59], v[108:111]
ds_read_b64_tr_b16 v[180:181], v218 offset:24576
v_add_u32 v217, 0xffff4000, v217
v_mfma_f32_16x16x32_bf16 v[108:111], v[196:199], a[72:75], v[108:111]
buffer_store_dwordx4 v[36:39], v242, s[20:23], s80 offen offset:0 sc1
v_mfma_f32_16x16x32_bf16 v[108:111], v[200:203], a[88:91], v[108:111]
ds_read_b64_tr_b16 v[182:183], v218 offset:26624
v_add_f32 v76, v68, v76
v_mfma_f32_16x16x32_bf16 v[112:115], v[200:203], a[92:95], v[112:115]
buffer_load_dword v226, v227, s[20:23], s76 offen sc1
v_mfma_f32_16x16x32_bf16 v[112:115], v[196:199], a[76:79], v[112:115]
ds_read_b64_tr_b16 v[184:185], v218 offset:28672
v_add_f32 v77, v69, v77
v_mfma_f32_16x16x32_bf16 v[112:115], v[192:195], a[60:63], v[112:115]
buffer_load_dwordx4 v238, s[16:19], s69 offen offset:0 lds
v_mfma_f32_16x16x32_bf16 v[100:103], v[192:195], a[48:51], v[100:103]
s_add_u32 s69, s66, 532480
ds_read_b64_tr_b16 v[186:187], v218 offset:30720
v_add_f32 v78, v70, v78
v_mfma_f32_16x16x32_bf16 v[100:103], v[196:199], a[64:67], v[100:103]
s_waitcnt lgkmcnt(7)
v_add_f32 v79, v71, v79
v_cvt_pk_bf16_f32 v68, v76, v77
v_mfma_f32_16x16x32_bf16 v[100:103], v[200:203], a[80:83], v[100:103]
ds_read_b64_tr_b16 v[188:189], v218 offset:32768
v_cvt_pk_bf16_f32 v69, v78, v79
v_mfma_f32_16x16x32_bf16 v[104:107], v[200:203], a[84:87], v[104:107]
v_add_f32 v92, v84, v92
v_add_f32 v93, v85, v93
v_mfma_f32_16x16x32_bf16 v[104:107], v[196:199], a[68:71], v[104:107]
ds_read_b64_tr_b16 v[190:191], v218 offset:34816
v_add_f32 v94, v86, v94
v_mfma_f32_16x16x32_bf16 v[104:107], v[192:195], a[52:55], v[104:107]
s_waitcnt lgkmcnt(7)
buffer_load_dwordx4 v238, s[16:19], s69 offen offset:2048 lds
v_mfma_f32_16x16x32_bf16 v[124:127], v[204:207], a[56:59], v[124:127]
s_waitcnt lgkmcnt(6)
ds_read_b64_tr_b16 v[192:193], v219 offset:24576
v_add_u32 v218, 0xffff4000, v218
v_mfma_f32_16x16x32_bf16 v[124:127], v[208:211], a[72:75], v[124:127]
ds_read_b64_tr_b16 v[194:195], v219 offset:26624
v_add_f32 v95, v87, v95
v_mfma_f32_16x16x32_bf16 v[124:127], v[212:215], a[88:91], v[124:127]
ds_read_b64_tr_b16 v[196:197], v219 offset:28672
v_cvt_pk_bf16_f32 v70, v92, v93
v_mfma_f32_16x16x32_bf16 v[128:131], v[212:215], a[92:95], v[128:131]
ds_read_b64_tr_b16 v[198:199], v219 offset:30720
v_cvt_pk_bf16_f32 v71, v94, v95
v_mfma_f32_16x16x32_bf16 v[128:131], v[208:211], a[76:79], v[128:131]
s_add_u32 m0, s34, 73728
ds_read_b64_tr_b16 v[200:201], v219 offset:32768
v_add_f32 v48, v40, v48
v_mfma_f32_16x16x32_bf16 v[128:131], v[204:207], a[60:63], v[128:131]
s_add_u32 s69, s66, 552960
ds_read_b64_tr_b16 v[202:203], v219 offset:34816
v_add_f32 v49, v41, v49
v_mfma_f32_16x16x32_bf16 v[116:119], v[204:207], a[48:51], v[116:119]
buffer_store_dwordx4 v[68:71], v242, s[20:23], s80 offen offset:1024 sc1
v_mfma_f32_16x16x32_bf16 v[116:119], v[208:211], a[64:67], v[116:119]
v_add_f32 v50, v42, v50
v_add_f32 v51, v43, v51
v_mfma_f32_16x16x32_bf16 v[116:119], v[212:215], a[80:83], v[116:119]
v_cvt_pk_bf16_f32 v40, v48, v49
v_cvt_pk_bf16_f32 v41, v50, v51
v_mfma_f32_16x16x32_bf16 v[120:123], v[212:215], a[84:87], v[120:123]
v_add_f32 v64, v56, v64
v_add_f32 v65, v57, v65
v_mfma_f32_16x16x32_bf16 v[120:123], v[208:211], a[68:71], v[120:123]
v_add_f32 v66, v58, v66
v_add_f32 v67, v59, v67
v_mfma_f32_16x16x32_bf16 v[120:123], v[204:207], a[52:55], v[120:123]
s_waitcnt vmcnt(15) lgkmcnt(0)
s_barrier
v_mfma_f32_16x16x32_bf16 v[140:143], v[180:183], a[56:59], v[140:143]
ds_read_b64_tr_b16 v[204:205], v216 offset:0
v_add_u32 v219, 0xffff4000, v219
v_mfma_f32_16x16x32_bf16 v[140:143], v[184:187], a[72:75], v[140:143]
buffer_load_dwordx4 v238, s[16:19], s69 offen offset:0 lds
v_mfma_f32_16x16x32_bf16 v[140:143], v[188:191], a[88:91], v[140:143]
s_add_u32 s69, s66, 569344
ds_read_b64_tr_b16 v[206:207], v216 offset:2048
v_cvt_pk_bf16_f32 v42, v64, v65
v_mfma_f32_16x16x32_bf16 v[144:147], v[188:191], a[92:95], v[144:147]
v_cvt_pk_bf16_f32 v43, v66, v67
v_add_f32 v80, v72, v80
v_mfma_f32_16x16x32_bf16 v[144:147], v[184:187], a[76:79], v[144:147]
ds_read_b64_tr_b16 v[208:209], v216 offset:4096
v_add_f32 v81, v73, v81
v_mfma_f32_16x16x32_bf16 v[144:147], v[180:183], a[60:63], v[144:147]
buffer_store_dwordx4 v[40:43], v242, s[20:23], s79 offen offset:0 sc1
v_mfma_f32_16x16x32_bf16 v[132:135], v[180:183], a[48:51], v[132:135]
ds_read_b64_tr_b16 v[210:211], v216 offset:6144
v_add_f32 v82, v74, v82
v_mfma_f32_16x16x32_bf16 v[132:135], v[184:187], a[64:67], v[132:135]
buffer_load_dwordx4 v238, s[16:19], s69 offen offset:2048 lds
v_mfma_f32_16x16x32_bf16 v[132:135], v[188:191], a[80:83], v[132:135]
s_add_u32 m0, s34, 77824
ds_read_b64_tr_b16 v[212:213], v216 offset:8192
v_add_f32 v83, v75, v83
v_mfma_f32_16x16x32_bf16 v[136:139], v[188:191], a[84:87], v[136:139]
s_add_u32 s69, s66, 589824
v_cvt_pk_bf16_f32 v72, v80, v81
v_cvt_pk_bf16_f32 v73, v82, v83
v_mfma_f32_16x16x32_bf16 v[136:139], v[184:187], a[68:71], v[136:139]
ds_read_b64_tr_b16 v[214:215], v216 offset:10240
v_add_f32 v96, v88, v96
v_mfma_f32_16x16x32_bf16 v[136:139], v[180:183], a[52:55], v[136:139]
v_add_f32 v97, v89, v97
v_add_f32 v98, v90, v98
v_mfma_f32_16x16x32_bf16 v[156:159], v[192:195], a[56:59], v[156:159]
ds_read_b64_tr_b16 v[180:181], v217 offset:0
v_add_f32 v99, v91, v99
v_mfma_f32_16x16x32_bf16 v[156:159], v[196:199], a[72:75], v[156:159]
v_cvt_pk_bf16_f32 v74, v96, v97
v_cvt_pk_bf16_f32 v75, v98, v99
v_mfma_f32_16x16x32_bf16 v[156:159], v[200:203], a[88:91], v[156:159]
ds_read_b64_tr_b16 v[182:183], v217 offset:2048
v_mfma_f32_16x16x32_bf16 v[160:163], v[200:203], a[92:95], v[160:163]
buffer_load_dwordx4 v236, s[16:19], s69 offen offset:0 lds
v_mfma_f32_16x16x32_bf16 v[160:163], v[196:199], a[76:79], v[160:163]
s_add_u32 s69, s66, 606208
ds_read_b64_tr_b16 v[184:185], v217 offset:4096
v_mfma_f32_16x16x32_bf16 v[160:163], v[192:195], a[60:63], v[160:163]
buffer_store_dwordx4 v[72:75], v242, s[20:23], s79 offen offset:1024 sc1
v_mfma_f32_16x16x32_bf16 v[148:151], v[192:195], a[48:51], v[148:151]
ds_read_b64_tr_b16 v[186:187], v217 offset:6144
v_mfma_f32_16x16x32_bf16 v[148:151], v[196:199], a[64:67], v[148:151]
v_mfma_f32_16x16x32_bf16 v[148:151], v[200:203], a[80:83], v[148:151]
ds_read_b64_tr_b16 v[188:189], v217 offset:8192
v_mfma_f32_16x16x32_bf16 v[152:155], v[200:203], a[84:87], v[152:155]
buffer_load_dwordx4 v236, s[16:19], s69 offen offset:2048 lds
v_mfma_f32_16x16x32_bf16 v[152:155], v[196:199], a[68:71], v[152:155]
s_add_u32 m0, s34, 81920
ds_read_b64_tr_b16 v[190:191], v217 offset:10240
s_add_u32 s69, s66, 626688
v_mfma_f32_16x16x32_bf16 v[152:155], v[192:195], a[52:55], v[152:155]
s_waitcnt lgkmcnt(6)
v_mfma_f32_16x16x32_bf16 v[108:111], v[204:207], a[104:107], v[108:111]
ds_read_b64_tr_b16 v[192:193], v218 offset:0
v_mfma_f32_16x16x32_bf16 v[108:111], v[208:211], a[120:123], v[108:111]
v_mfma_f32_16x16x32_bf16 v[108:111], v[212:215], a[136:139], v[108:111]
ds_read_b64_tr_b16 v[194:195], v218 offset:2048
v_mfma_f32_16x16x32_bf16 v[112:115], v[212:215], a[140:143], v[112:115]
v_mfma_f32_16x16x32_bf16 v[112:115], v[208:211], a[124:127], v[112:115]
ds_read_b64_tr_b16 v[196:197], v218 offset:4096
v_mfma_f32_16x16x32_bf16 v[112:115], v[204:207], a[108:111], v[112:115]
buffer_load_dwordx4 v236, s[16:19], s69 offen offset:0 lds
v_mfma_f32_16x16x32_bf16 v[100:103], v[204:207], a[96:99], v[100:103]
s_add_u32 s69, s66, 643072
ds_read_b64_tr_b16 v[198:199], v218 offset:6144
v_mfma_f32_16x16x32_bf16 v[100:103], v[208:211], a[112:115], v[100:103]
v_mfma_f32_16x16x32_bf16 v[100:103], v[212:215], a[128:131], v[100:103]
ds_read_b64_tr_b16 v[200:201], v218 offset:8192
v_mfma_f32_16x16x32_bf16 v[104:107], v[212:215], a[132:135], v[104:107]
v_mfma_f32_16x16x32_bf16 v[104:107], v[208:211], a[116:119], v[104:107]
s_waitcnt vmcnt(10)
ds_read_b64_tr_b16 v[202:203], v218 offset:10240
v_cmp_gt_u32 vcc, 1, v226
v_mfma_f32_16x16x32_bf16 v[104:107], v[204:207], a[100:103], v[104:107]
s_waitcnt lgkmcnt(6)
buffer_load_dwordx4 v236, s[16:19], s69 offen offset:2048 lds
v_mfma_f32_16x16x32_bf16 v[124:127], v[180:183], a[104:107], v[124:127]
s_cbranch_vccnz SLOW_y
RET_y:
ds_read_b64_tr_b16 v[204:205], v219 offset:0
v_sub_f32 v229, 1.0, v228
v_mfma_f32_16x16x32_bf16 v[124:127], v[184:187], a[120:123], v[124:127]
ds_read_b64_tr_b16 v[206:207], v219 offset:2048
v_mfma_f32_16x16x32_bf16 v[124:127], v[188:191], a[136:139], v[124:127]
ds_read_b64_tr_b16 v[208:209], v219 offset:4096
v_mfma_f32_16x16x32_bf16 v[128:131], v[188:191], a[140:143], v[128:131]
ds_read_b64_tr_b16 v[210:211], v219 offset:6144
v_mfma_f32_16x16x32_bf16 v[128:131], v[184:187], a[124:127], v[128:131]
ds_read_b64_tr_b16 v[212:213], v219 offset:8192
v_mfma_f32_16x16x32_bf16 v[128:131], v[180:183], a[108:111], v[128:131]
ds_read_b64_tr_b16 v[214:215], v219 offset:10240
v_mfma_f32_16x16x32_bf16 v[116:119], v[180:183], a[96:99], v[116:119]
s_mov_b32 m0, s48
v_mfma_f32_16x16x32_bf16 v[116:119], v[184:187], a[112:115], v[116:119]
buffer_load_dwordx4 v249, s[20:23], s50 offen sc1 lds
v_mfma_f32_16x16x32_bf16 v[116:119], v[188:191], a[128:131], v[116:119]
s_add_u32 s50, s50, 32768
buffer_load_dwordx4 v249, s[20:23], s50 offen offset:1024 sc1 lds
v_mfma_f32_16x16x32_bf16 v[120:123], v[188:191], a[132:135], v[120:123]
v_mfma_f32_16x16x32_bf16 v[120:123], v[184:187], a[116:119], v[120:123]
s_mov_b32 m0, s49
s_and_b32 s70, s3, 1
s_add_u32 s69, s70, 9
v_mfma_f32_16x16x32_bf16 v[120:123], v[180:183], a[100:103], v[120:123]
s_waitcnt vmcnt(11) lgkmcnt(0)
s_barrier
v_mfma_f32_16x16x32_bf16 v[140:143], v[192:195], a[104:107], v[140:143]
s_lshl_b32 s69, s69, 5
ds_read_b64_tr_b16 v[180:181], v216 offset:24576
s_xor_b32 s69, s69, s83
v_mfma_f32_16x16x32_bf16 v[140:143], v[196:199], a[120:123], v[140:143]
s_mul_i32 s69, s69, 1152
buffer_load_dwordx4 v249, s[20:23], s51 offen sc1 lds
v_mfma_f32_16x16x32_bf16 v[140:143], v[200:203], a[136:139], v[140:143]
s_add_u32 s69, s69, s31
ds_read_b64_tr_b16 v[182:183], v216 offset:26624
s_add_u32 m0, s35, 0
v_mfma_f32_16x16x32_bf16 v[144:147], v[200:203], a[140:143], v[144:147]
s_and_b32 s70, s3, 1
v_mfma_f32_16x16x32_bf16 v[144:147], v[196:199], a[124:127], v[144:147]
ds_read_b64_tr_b16 v[184:185], v216 offset:28672
v_mfma_f32_16x16x32_bf16 v[144:147], v[192:195], a[108:111], v[144:147]
v_mfma_f32_16x16x32_bf16 v[132:135], v[192:195], a[96:99], v[132:135]
ds_read_b64_tr_b16 v[186:187], v216 offset:30720
v_mfma_f32_16x16x32_bf16 v[132:135], v[196:199], a[112:115], v[132:135]
buffer_load_dwordx4 v239, s[16:19], s69 offen offset:0 lds
v_mfma_f32_16x16x32_bf16 v[132:135], v[200:203], a[128:131], v[132:135]
s_add_u32 s69, s70, 11
ds_read_b64_tr_b16 v[188:189], v216 offset:32768
s_lshl_b32 s69, s69, 5
v_mfma_f32_16x16x32_bf16 v[136:139], v[200:203], a[132:135], v[136:139]
s_xor_b32 s69, s69, s83
s_mul_i32 s69, s69, 1152
s_add_u32 s69, s69, s31
v_mfma_f32_16x16x32_bf16 v[136:139], v[196:199], a[116:119], v[136:139]
s_add_u32 m0, s35, 2048
ds_read_b64_tr_b16 v[190:191], v216 offset:34816
s_and_b32 s70, s3, 1
v_mfma_f32_16x16x32_bf16 v[136:139], v[192:195], a[100:103], v[136:139]
v_mfma_f32_16x16x32_bf16 v[156:159], v[204:207], a[104:107], v[156:159]
ds_read_b64_tr_b16 v[192:193], v217 offset:24576
v_add_u32 v216, 0xc000, v216
v_mfma_f32_16x16x32_bf16 v[156:159], v[208:211], a[120:123], v[156:159]
v_mfma_f32_16x16x32_bf16 v[156:159], v[212:215], a[136:139], v[156:159]
ds_read_b64_tr_b16 v[194:195], v217 offset:26624
v_mfma_f32_16x16x32_bf16 v[160:163], v[212:215], a[140:143], v[160:163]
v_mfma_f32_16x16x32_bf16 v[160:163], v[208:211], a[124:127], v[160:163]
ds_read_b64_tr_b16 v[196:197], v217 offset:28672
v_mfma_f32_16x16x32_bf16 v[160:163], v[204:207], a[108:111], v[160:163]
v_mfma_f32_16x16x32_bf16 v[148:151], v[204:207], a[96:99], v[148:151]
ds_read_b64_tr_b16 v[198:199], v217 offset:30720
v_mfma_f32_16x16x32_bf16 v[148:151], v[208:211], a[112:115], v[148:151]
v_mfma_f32_16x16x32_bf16 v[148:151], v[212:215], a[128:131], v[148:151]
ds_read_b64_tr_b16 v[200:201], v217 offset:32768
v_mfma_f32_16x16x32_bf16 v[152:155], v[212:215], a[132:135], v[152:155]
v_mfma_f32_16x16x32_bf16 v[152:155], v[208:211], a[116:119], v[152:155]
ds_read_b64_tr_b16 v[202:203], v217 offset:34816
v_mfma_f32_16x16x32_bf16 v[152:155], v[204:207], a[100:103], v[152:155]
PAD_17:
s_cmp_lg_u32 s73, 0
s_cbranch_scc1 PAD_ret
s_waitcnt lgkmcnt(6)
buffer_load_dwordx4 v239, s[16:19], s69 offen offset:0 lds
v_mfma_f32_16x16x32_bf16 v[108:111], v[180:183], a[152:155], v[108:111]
s_add_u32 s69, s70, 13
ds_read_b64_tr_b16 v[204:205], v218 offset:24576
v_add_u32 v217, 0xc000, v217
v_mfma_f32_16x16x32_bf16 v[108:111], v[184:187], a[168:171], v[108:111]
s_lshl_b32 s69, s69, 5
ds_read_b64_tr_b16 v[206:207], v218 offset:26624
s_xor_b32 s69, s69, s83
v_mfma_f32_16x16x32_bf16 v[108:111], v[188:191], a[184:187], v[108:111]
s_mul_i32 s69, s69, 1152
ds_read_b64_tr_b16 v[208:209], v218 offset:28672
s_add_u32 s69, s69, s31
v_mfma_f32_16x16x32_bf16 v[100:103], v[188:191], a[176:179], v[100:103]
s_add_u32 m0, s35, 4096
ds_read_b64_tr_b16 v[210:211], v218 offset:30720
s_and_b32 s70, s3, 1
v_mfma_f32_16x16x32_bf16 v[100:103], v[184:187], a[160:163], v[100:103]
ds_read_b64_tr_b16 v[212:213], v218 offset:32768
v_mfma_f32_16x16x32_bf16 v[100:103], v[180:183], a[144:147], v[100:103]
s_waitcnt lgkmcnt(5)
ds_read_b64_tr_b16 v[214:215], v218 offset:34816
v_mfma_f32_16x16x32_bf16 v[124:127], v[192:195], a[152:155], v[124:127]
ds_read_b64_tr_b16 v[180:181], v219 offset:24576
v_add_u32 v218, 0xc000, v218
v_mfma_f32_16x16x32_bf16 v[124:127], v[196:199], a[168:171], v[124:127]
ds_read_b64_tr_b16 v[182:183], v219 offset:26624
v_mfma_f32_16x16x32_bf16 v[124:127], v[200:203], a[184:187], v[124:127]
ds_read_b64_tr_b16 v[184:185], v219 offset:28672
v_mfma_f32_16x16x32_bf16 v[116:119], v[200:203], a[176:179], v[116:119]
ds_read_b64_tr_b16 v[186:187], v219 offset:30720
v_mfma_f32_16x16x32_bf16 v[116:119], v[196:199], a[160:163], v[116:119]
ds_read_b64_tr_b16 v[188:189], v219 offset:32768
v_mfma_f32_16x16x32_bf16 v[116:119], v[192:195], a[144:147], v[116:119]
s_waitcnt lgkmcnt(5)
ds_read_b64_tr_b16 v[190:191], v219 offset:34816
v_mfma_f32_16x16x32_bf16 v[140:143], v[204:207], a[152:155], v[140:143]
ds_read_b64_tr_b16 v[192:193], v216 offset:0
v_add_u32 v219, 0xc000, v219
v_mfma_f32_16x16x32_bf16 v[140:143], v[208:211], a[168:171], v[140:143]
ds_read_b64_tr_b16 v[194:195], v216 offset:2048
v_mfma_f32_16x16x32_bf16 v[140:143], v[212:215], a[184:187], v[140:143]
ds_read_b64_tr_b16 v[196:197], v216 offset:4096
buffer_load_dwordx4 v239, s[16:19], s69 offen offset:0 lds
v_mfma_f32_16x16x32_bf16 v[132:135], v[212:215], a[176:179], v[132:135]
s_add_u32 s69, s70, 15
ds_read_b64_tr_b16 v[198:199], v216 offset:6144
s_lshl_b32 s69, s69, 5
v_mfma_f32_16x16x32_bf16 v[132:135], v[208:211], a[160:163], v[132:135]
s_xor_b32 s69, s69, s84
ds_read_b64_tr_b16 v[200:201], v216 offset:8192
s_mul_i32 s69, s69, 1152
v_mfma_f32_16x16x32_bf16 v[132:135], v[204:207], a[144:147], v[132:135]
s_waitcnt lgkmcnt(5)
ds_read_b64_tr_b16 v[202:203], v216 offset:10240
s_add_u32 s69, s69, s31
v_mfma_f32_16x16x32_bf16 v[156:159], v[180:183], a[152:155], v[156:159]
s_add_u32 m0, s35, 6144
ds_read_b64_tr_b16 v[204:205], v217 offset:0
s_and_b32 s70, s3, 1
v_mfma_f32_16x16x32_bf16 v[156:159], v[184:187], a[168:171], v[156:159]
ds_read_b64_tr_b16 v[206:207], v217 offset:2048
v_mfma_f32_16x16x32_bf16 v[156:159], v[188:191], a[184:187], v[156:159]
ds_read_b64_tr_b16 v[208:209], v217 offset:4096
v_mfma_f32_16x16x32_bf16 v[148:151], v[188:191], a[176:179], v[148:151]
ds_read_b64_tr_b16 v[210:211], v217 offset:6144
v_mfma_f32_16x16x32_bf16 v[148:151], v[184:187], a[160:163], v[148:151]
ds_read_b64_tr_b16 v[212:213], v217 offset:8192
v_mfma_f32_16x16x32_bf16 v[148:151], v[180:183], a[144:147], v[148:151]
s_waitcnt lgkmcnt(5)
ds_read_b64_tr_b16 v[214:215], v217 offset:10240
v_mfma_f32_16x16x32_bf16 v[108:111], v[192:195], a[200:203], v[108:111]
ds_read_b64_tr_b16 v[180:181], v218 offset:0
v_mfma_f32_16x16x32_bf16 v[108:111], v[196:199], a[216:219], v[108:111]
ds_read_b64_tr_b16 v[182:183], v218 offset:2048
v_mfma_f32_16x16x32_bf16 v[108:111], v[200:203], a[232:235], v[108:111]
ds_read_b64_tr_b16 v[184:185], v218 offset:4096
v_mfma_f32_16x16x32_bf16 v[100:103], v[200:203], a[224:227], v[100:103]
ds_read_b64_tr_b16 v[186:187], v218 offset:6144
v_mfma_f32_16x16x32_bf16 v[100:103], v[196:199], a[208:211], v[100:103]
ds_read_b64_tr_b16 v[188:189], v218 offset:8192
v_mfma_f32_16x16x32_bf16 v[100:103], v[192:195], a[192:195], v[100:103]
s_waitcnt lgkmcnt(5)
ds_read_b64_tr_b16 v[190:191], v218 offset:10240
v_mfma_f32_16x16x32_bf16 v[124:127], v[204:207], a[200:203], v[124:127]
ds_read_b64_tr_b16 v[192:193], v219 offset:0
buffer_load_dwordx4 v239, s[16:19], s69 offen offset:0 lds
v_mfma_f32_16x16x32_bf16 v[124:127], v[208:211], a[216:219], v[124:127]
s_add_u32 s69, s70, 17
ds_read_b64_tr_b16 v[194:195], v219 offset:2048
s_lshl_b32 s69, s69, 5
v_mfma_f32_16x16x32_bf16 v[124:127], v[212:215], a[232:235], v[124:127]
s_mul_i32 s69, s69, 1152
ds_read_b64_tr_b16 v[196:197], v219 offset:4096
s_add_u32 s69, s69, s31
v_mfma_f32_16x16x32_bf16 v[116:119], v[212:215], a[224:227], v[116:119]
s_lshl_b32 s70, s70, 28
ds_read_b64_tr_b16 v[198:199], v219 offset:6144
s_add_u32 s69, s69, s70
v_mfma_f32_16x16x32_bf16 v[116:119], v[208:211], a[208:211], v[116:119]
s_add_u32 m0, s35, 8192
ds_read_b64_tr_b16 v[200:201], v219 offset:8192
v_mfma_f32_16x16x32_bf16 v[116:119], v[204:207], a[192:195], v[116:119]
s_waitcnt vmcnt(4) lgkmcnt(5)
s_barrier
ds_read_b64_tr_b16 v[202:203], v219 offset:10240
v_mfma_f32_16x16x32_bf16 v[140:143], v[180:183], a[200:203], v[140:143]
ds_read_b64_tr_b16 v[204:205], v216 offset:24576
v_mfma_f32_16x16x32_bf16 v[140:143], v[184:187], a[216:219], v[140:143]
ds_read_b64_tr_b16 v[206:207], v216 offset:26624
v_mfma_f32_16x16x32_bf16 v[140:143], v[188:191], a[232:235], v[140:143]
ds_read_b64_tr_b16 v[208:209], v216 offset:28672
v_mfma_f32_16x16x32_bf16 v[132:135], v[188:191], a[224:227], v[132:135]
ds_read_b64_tr_b16 v[210:211], v216 offset:30720
v_mfma_f32_16x16x32_bf16 v[132:135], v[184:187], a[208:211], v[132:135]
ds_read_b64_tr_b16 v[212:213], v216 offset:32768
v_mfma_f32_16x16x32_bf16 v[132:135], v[180:183], a[192:195], v[132:135]
s_waitcnt lgkmcnt(5)
ds_read_b64_tr_b16 v[214:215], v216 offset:34816
v_mfma_f32_16x16x32_bf16 v[156:159], v[192:195], a[200:203], v[156:159]
ds_read_b64_tr_b16 v[180:181], v217 offset:24576
v_add_u32 v216, 0xffff4000, v216
v_mfma_f32_16x16x32_bf16 v[156:159], v[196:199], a[216:219], v[156:159]
ds_read_b64_tr_b16 v[182:183], v217 offset:26624
buffer_store_dword v224, v225, s[20:23], s78 offen sc1
v_mfma_f32_16x16x32_bf16 v[156:159], v[200:203], a[232:235], v[156:159]
ds_read_b64_tr_b16 v[184:185], v217 offset:28672
v_mfma_f32_16x16x32_bf16 v[148:151], v[200:203], a[224:227], v[148:151]
ds_read_b64_tr_b16 v[186:187], v217 offset:30720
v_mfma_f32_16x16x32_bf16 v[148:151], v[196:199], a[208:211], v[148:151]
ds_read_b64_tr_b16 v[188:189], v217 offset:32768
buffer_load_dwordx4 v239, s[16:19], s69 offen offset:0 lds
v_mfma_f32_16x16x32_bf16 v[148:151], v[192:195], a[192:195], v[148:151]
s_waitcnt lgkmcnt(5)
ds_read_b64_tr_b16 v[190:191], v217 offset:34816
v_mfma_f32_16x16x32_bf16 v[108:111], v[204:207], a[248:251], v[108:111]
ds_read_b64_tr_b16 v[192:193], v218 offset:24576
v_add_u32 v217, 0xffff4000, v217
v_mfma_f32_16x16x32_bf16 v[108:111], v[208:211], v[12:15], v[108:111]
ds_read_b64_tr_b16 v[194:195], v218 offset:26624
v_mfma_f32_16x16x32_bf16 v[108:111], v[212:215], v[28:31], v[108:111]
ds_read_b64_tr_b16 v[196:197], v218 offset:28672
v_mfma_f32_16x16x32_bf16 v[100:103], v[212:215], v[20:23], v[100:103]
ds_read_b64_tr_b16 v[198:199], v218 offset:30720
v_mfma_f32_16x16x32_bf16 v[100:103], v[208:211], v[4:7], v[100:103]
ds_read_b64_tr_b16 v[200:201], v218 offset:32768
v_mfma_f32_16x16x32_bf16 v[100:103], v[204:207], a[240:243], v[100:103]
s_waitcnt lgkmcnt(5)
ds_read_b64_tr_b16 v[202:203], v218 offset:34816
ds_write_b64 v222, v[108:109] offset:0
v_mfma_f32_16x16x32_bf16 v[124:127], v[180:183], a[248:251], v[124:127]
ds_read_b64_tr_b16 v[204:205], v219 offset:24576
v_add_u32 v218, 0xffff4000, v218
v_mfma_f32_16x16x32_bf16 v[124:127], v[184:187], v[12:15], v[124:127]
ds_read_b64_tr_b16 v[206:207], v219 offset:26624
ds_write_b64 v222, v[110:111] offset:512
v_mfma_f32_16x16x32_bf16 v[124:127], v[188:191], v[28:31], v[124:127]
ds_read_b64_tr_b16 v[208:209], v219 offset:28672
v_mfma_f32_16x16x32_bf16 v[116:119], v[188:191], v[20:23], v[116:119]
ds_read_b64_tr_b16 v[210:211], v219 offset:30720
v_mfma_f32_16x16x32_bf16 v[116:119], v[184:187], v[4:7], v[116:119]
ds_read_b64_tr_b16 v[212:213], v219 offset:32768
v_mfma_f32_16x16x32_bf16 v[116:119], v[180:183], a[240:243], v[116:119]
s_waitcnt lgkmcnt(7)
ds_read_b64_tr_b16 v[214:215], v219 offset:34816
ds_write_b64 v222, v[124:125] offset:2048
v_mfma_f32_16x16x32_bf16 v[140:143], v[192:195], a[248:251], v[140:143]
ds_read_b64_tr_b16 v[180:181], v221 offset:0
v_add_u32 v219, 0xffff4000, v219
v_mfma_f32_16x16x32_bf16 v[140:143], v[196:199], v[12:15], v[140:143]
ds_read_b64_tr_b16 v[182:183], v221 offset:512
ds_write_b64 v222, v[126:127] offset:2560
v_mfma_f32_16x16x32_bf16 v[140:143], v[200:203], v[28:31], v[140:143]
ds_read_b64_tr_b16 v[184:185], v221 offset:1024
v_mfma_f32_16x16x32_bf16 v[132:135], v[200:203], v[20:23], v[132:135]
ds_read_b64_tr_b16 v[186:187], v221 offset:1536
v_mfma_f32_16x16x32_bf16 v[132:135], v[196:199], v[4:7], v[132:135]
ds_read_b64_tr_b16 v[188:189], v221 offset:2048
v_mfma_f32_16x16x32_bf16 v[132:135], v[192:195], a[240:243], v[132:135]
s_waitcnt lgkmcnt(7)
ds_read_b64_tr_b16 v[190:191], v221 offset:2560
ds_write_b64 v222, v[140:141] offset:4096
v_mfma_f32_16x16x32_bf16 v[156:159], v[204:207], a[248:251], v[156:159]
ds_read_b64_tr_b16 v[192:193], v221 offset:3072
ds_write_b64 v222, v[142:143] offset:4608
v_mfma_f32_16x16x32_bf16 v[156:159], v[208:211], v[12:15], v[156:159]
ds_read_b64_tr_b16 v[194:195], v221 offset:3584
v_mfma_f32_16x16x32_bf16 v[156:159], v[212:215], v[28:31], v[156:159]
ds_read_b64_tr_b16 v[196:197], v221 offset:4096
v_mfma_f32_16x16x32_bf16 v[148:151], v[212:215], v[20:23], v[148:151]
ds_read_b64_tr_b16 v[198:199], v221 offset:4608
v_mfma_f32_16x16x32_bf16 v[148:151], v[208:211], v[4:7], v[148:151]
ds_read_b64_tr_b16 v[200:201], v221 offset:5120
v_mfma_f32_16x16x32_bf16 v[148:151], v[204:207], a[240:243], v[148:151]
s_waitcnt lgkmcnt(7)
ds_read_b64_tr_b16 v[202:203], v221 offset:5632
ds_write_b64 v222, v[156:157] offset:6144
v_mfma_f32_16x16x32_bf16 v[172:175], v[180:183], a[8:11], 0
ds_read_b64_tr_b16 v[204:205], v221 offset:6144
v_mfma_f32_16x16x32_bf16 v[172:175], v[184:187], a[24:27], v[172:175]
ds_read_b64_tr_b16 v[206:207], v221 offset:6656
v_mfma_f32_16x16x32_bf16 v[172:175], v[188:191], a[40:43], v[172:175]
ds_read_b64_tr_b16 v[208:209], v221 offset:7168
v_mfma_f32_16x16x32_bf16 v[176:179], v[188:191], a[44:47], 0
ds_read_b64_tr_b16 v[210:211], v221 offset:7680
v_mfma_f32_16x16x32_bf16 v[176:179], v[184:187], a[28:31], v[176:179]
ds_read_b64_tr_b16 v[212:213], v221 offset:8192
v_mfma_f32_16x16x32_bf16 v[176:179], v[180:183], a[12:15], v[176:179]
ds_read_b64_tr_b16 v[214:215], v221 offset:8704
v_mfma_f32_16x16x32_bf16 v[164:167], v[180:183], a[0:3], 0
ds_write_b64 v222, v[158:159] offset:6656
v_mfma_f32_16x16x32_bf16 v[164:167], v[184:187], a[16:19], v[164:167]
buffer_load_dword v251, v231, s[20:23], s72 offen sc1
v_mfma_f32_16x16x32_bf16 v[164:167], v[188:191], a[32:35], v[164:167]
ds_read_b64_tr_b16 v[36:37], v250 offset:0
v_mfma_f32_16x16x32_bf16 v[168:171], v[188:191], a[36:39], 0
ds_read_b64_tr_b16 v[38:39], v250 offset:2048
v_mfma_f32_16x16x32_bf16 v[168:171], v[184:187], a[20:23], v[168:171]
ds_read_b64_tr_b16 v[40:41], v250 offset:4096
v_mfma_f32_16x16x32_bf16 v[168:171], v[180:183], a[4:7], v[168:171]
s_waitcnt vmcnt(1) lgkmcnt(3)
s_barrier
v_mfma_f32_16x16x32_bf16 v[172:175], v[192:195], a[56:59], v[172:175]
ds_read_b64_tr_b16 v[180:181], v220 offset:0
v_mfma_f32_16x16x32_bf16 v[172:175], v[196:199], a[72:75], v[172:175]
ds_read2st64_b64 v[108:111], v223 offset0:0 offset1:1
v_mfma_f32_16x16x32_bf16 v[172:175], v[200:203], a[88:91], v[172:175]
ds_read_b64_tr_b16 v[182:183], v220 offset:512
v_mfma_f32_16x16x32_bf16 v[176:179], v[200:203], a[92:95], v[176:179]
ds_read2st64_b64 v[124:127], v223 offset0:4 offset1:5
v_mfma_f32_16x16x32_bf16 v[176:179], v[196:199], a[76:79], v[176:179]
ds_read_b64_tr_b16 v[184:185], v220 offset:1024
v_mfma_f32_16x16x32_bf16 v[176:179], v[192:195], a[60:63], v[176:179]
ds_read2st64_b64 v[140:143], v223 offset0:8 offset1:9
v_mfma_f32_16x16x32_bf16 v[164:167], v[192:195], a[48:51], v[164:167]
ds_read_b64_tr_b16 v[186:187], v220 offset:1536
v_mfma_f32_16x16x32_bf16 v[164:167], v[196:199], a[64:67], v[164:167]
s_waitcnt lgkmcnt(5)
ds_read2st64_b64 v[156:159], v223 offset0:12 offset1:13
v_add_f32 v108, v100, v108
v_mfma_f32_16x16x32_bf16 v[164:167], v[200:203], a[80:83], v[164:167]
ds_read_b64_tr_b16 v[188:189], v220 offset:2048
v_add_f32 v109, v101, v109
v_mfma_f32_16x16x32_bf16 v[168:171], v[200:203], a[84:87], v[168:171]
s_waitcnt lgkmcnt(5)
ds_read_b64_tr_b16 v[42:43], v250 offset:6144
v_add_f32 v110, v102, v110
v_mfma_f32_16x16x32_bf16 v[168:171], v[196:199], a[68:71], v[168:171]
ds_read_b64_tr_b16 v[190:191], v220 offset:2560
v_add_f32 v111, v103, v111
v_mfma_f32_16x16x32_bf16 v[168:171], v[192:195], a[52:55], v[168:171]
s_waitcnt lgkmcnt(5)
ds_read_b64_tr_b16 v[44:45], v250 offset:8192
v_cvt_pk_bf16_f32 v100, v108, v109
v_mfma_f32_16x16x32_bf16 v[172:175], v[204:207], a[104:107], v[172:175]
s_waitcnt lgkmcnt(0)
ds_read_b64_tr_b16 v[192:193], v220 offset:3072
v_cvt_pk_bf16_f32 v101, v110, v111
v_mfma_f32_16x16x32_bf16 v[172:175], v[208:211], a[120:123], v[172:175]
v_add_f32 v124, v116, v124
v_add_f32 v125, v117, v125
v_mfma_f32_16x16x32_bf16 v[172:175], v[212:215], a[136:139], v[172:175]
ds_read_b64_tr_b16 v[194:195], v220 offset:3584
v_add_f32 v126, v118, v126
v_mfma_f32_16x16x32_bf16 v[176:179], v[212:215], a[140:143], v[176:179]
v_add_f32 v127, v119, v127
v_cvt_pk_bf16_f32 v102, v124, v125
v_mfma_f32_16x16x32_bf16 v[176:179], v[208:211], a[124:127], v[176:179]
ds_read_b64_tr_b16 v[196:197], v220 offset:4096
v_cvt_pk_bf16_f32 v103, v126, v127
v_mfma_f32_16x16x32_bf16 v[176:179], v[204:207], a[108:111], v[176:179]
buffer_store_dwordx4 v[100:103], v242, s[20:23], s81 offen offset:0 sc1
v_mfma_f32_16x16x32_bf16 v[164:167], v[204:207], a[96:99], v[164:167]
ds_read_b64_tr_b16 v[198:199], v220 offset:4608
v_add_f32 v140, v132, v140
v_mfma_f32_16x16x32_bf16 v[164:167], v[208:211], a[112:115], v[164:167]
v_add_f32 v141, v133, v141
v_add_f32 v142, v134, v142
v_mfma_f32_16x16x32_bf16 v[164:167], v[212:215], a[128:131], v[164:167]
ds_read_b64_tr_b16 v[200:201], v220 offset:5120
v_add_f32 v143, v135, v143
v_mfma_f32_16x16x32_bf16 v[168:171], v[212:215], a[132:135], v[168:171]
v_cvt_pk_bf16_f32 v132, v140, v141
v_cvt_pk_bf16_f32 v133, v142, v143
v_mfma_f32_16x16x32_bf16 v[168:171], v[208:211], a[116:119], v[168:171]
ds_read_b64_tr_b16 v[202:203], v220 offset:5632
v_add_f32 v156, v148, v156
v_mfma_f32_16x16x32_bf16 v[168:171], v[204:207], a[100:103], v[168:171]
s_waitcnt vmcnt(1)
v_add_f32 v157, v149, v157
v_add_f32 v158, v150, v158
v_mfma_f32_16x16x32_bf16 v[172:175], v[180:183], a[152:155], v[172:175]
ds_read_b64_tr_b16 v[204:205], v220 offset:6144
v_add_f32 v159, v151, v159
v_mfma_f32_16x16x32_bf16 v[172:175], v[184:187], a[168:171], v[172:175]
v_cvt_pk_bf16_f32 v134, v156, v157
v_cvt_pk_bf16_f32 v135, v158, v159
v_mfma_f32_16x16x32_bf16 v[172:175], v[188:191], a[184:187], v[172:175]
ds_read_b64_tr_b16 v[206:207], v220 offset:6656
v_cmp_gt_u32 vcc, 1, v251
v_mfma_f32_16x16x32_bf16 v[176:179], v[188:191], a[188:191], v[176:179]
buffer_store_dwordx4 v[132:135], v242, s[20:23], s81 offen offset:1024 sc1
v_mfma_f32_16x16x32_bf16 v[176:179], v[184:187], a[172:175], v[176:179]
s_cbranch_vccnz SLOW_pa
RET_pa:
ds_read_b64_tr_b16 v[208:209], v220 offset:7168
v_lshlrev_b32 v48, 16, v36
v_mfma_f32_16x16x32_bf16 v[176:179], v[180:183], a[156:159], v[176:179]
buffer_load_dwordx4 v[68:71], v242, s[20:23], s82 offen offset:0 sc1
v_mfma_f32_16x16x32_bf16 v[164:167], v[180:183], a[144:147], v[164:167]
ds_read_b64_tr_b16 v[210:211], v220 offset:7680
v_and_b32 v49, s62, v36
v_mfma_f32_16x16x32_bf16 v[164:167], v[184:187], a[160:163], v[164:167]
v_mul_f32 v48, v228, v48
v_mul_f32 v49, v228, v49
v_mfma_f32_16x16x32_bf16 v[164:167], v[188:191], a[176:179], v[164:167]
ds_read_b64_tr_b16 v[212:213], v220 offset:8192
v_lshlrev_b32 v50, 16, v37
v_mfma_f32_16x16x32_bf16 v[168:171], v[188:191], a[180:183], v[168:171]
v_and_b32 v51, s62, v37
v_mul_f32 v50, v228, v50
v_mfma_f32_16x16x32_bf16 v[168:171], v[184:187], a[164:167], v[168:171]
ds_read_b64_tr_b16 v[214:215], v220 offset:8704
v_mul_f32 v51, v228, v51
v_mfma_f32_16x16x32_bf16 v[168:171], v[180:183], a[148:151], v[168:171]
s_waitcnt lgkmcnt(6)
buffer_load_dwordx4 v[72:75], v242, s[20:23], s82 offen offset:1024 sc1
v_mfma_f32_16x16x32_bf16 v[172:175], v[192:195], a[200:203], v[172:175]
ds_read_b64_tr_b16 v[180:181], v216 offset:24576
v_lshlrev_b32 v52, 16, v38
v_mfma_f32_16x16x32_bf16 v[172:175], v[196:199], a[216:219], v[172:175]
v_and_b32 v53, s62, v38
v_mul_f32 v52, v228, v52
v_mfma_f32_16x16x32_bf16 v[172:175], v[200:203], a[232:235], v[172:175]
ds_read_b64_tr_b16 v[182:183], v216 offset:26624
v_mul_f32 v53, v228, v53
v_mfma_f32_16x16x32_bf16 v[176:179], v[200:203], a[236:239], v[176:179]
v_lshlrev_b32 v54, 16, v39
v_and_b32 v55, s62, v39
v_mfma_f32_16x16x32_bf16 v[176:179], v[196:199], a[220:223], v[176:179]
ds_read_b64_tr_b16 v[184:185], v216 offset:28672
v_mul_f32 v54, v228, v54
v_mfma_f32_16x16x32_bf16 v[176:179], v[192:195], a[204:207], v[176:179]
buffer_load_dwordx4 v[76:79], v242, s[20:23], s82 offen offset:2048 sc1
v_mfma_f32_16x16x32_bf16 v[164:167], v[192:195], a[192:195], v[164:167]
ds_read_b64_tr_b16 v[186:187], v216 offset:30720
v_mul_f32 v55, v228, v55
v_mfma_f32_16x16x32_bf16 v[164:167], v[196:199], a[208:211], v[164:167]
v_lshlrev_b32 v56, 16, v40
v_and_b32 v57, s62, v40
v_mfma_f32_16x16x32_bf16 v[164:167], v[200:203], a[224:227], v[164:167]
s_mul_i32 s49, s3, 2304
ds_read_b64_tr_b16 v[188:189], v216 offset:32768
v_mul_f32 v56, v228, v56
v_mfma_f32_16x16x32_bf16 v[168:171], v[200:203], a[228:231], v[168:171]
s_add_u32 s49, s49, 73728
v_mul_f32 v57, v228, v57
v_lshlrev_b32 v58, 16, v41
v_mfma_f32_16x16x32_bf16 v[168:171], v[196:199], a[212:215], v[168:171]
ds_read_b64_tr_b16 v[190:191], v216 offset:34816
v_and_b32 v59, s62, v41
v_mfma_f32_16x16x32_bf16 v[168:171], v[192:195], a[196:199], v[168:171]
s_waitcnt lgkmcnt(6)
buffer_load_dwordx4 v[80:83], v242, s[20:23], s82 offen offset:3072 sc1
v_mfma_f32_16x16x32_bf16 v[172:175], v[204:207], a[248:251], v[172:175]
ds_read_b64_tr_b16 v[192:193], v217 offset:24576
v_add_u32 v216, 0xc000, v216
v_mfma_f32_16x16x32_bf16 v[172:175], v[208:211], v[12:15], v[172:175]
v_mul_f32 v58, v228, v58
v_mul_f32 v59, v228, v59
v_mfma_f32_16x16x32_bf16 v[172:175], v[212:215], v[28:31], v[172:175]
ds_read_b64_tr_b16 v[194:195], v217 offset:26624
v_lshlrev_b32 v60, 16, v42
v_mfma_f32_16x16x32_bf16 v[176:179], v[212:215], v[32:35], v[176:179]
v_and_b32 v61, s62, v42
v_mul_f32 v60, v228, v60
v_mfma_f32_16x16x32_bf16 v[176:179], v[208:211], v[16:19], v[176:179]
ds_read_b64_tr_b16 v[196:197], v217 offset:28672
v_mul_f32 v61, v228, v61
v_mfma_f32_16x16x32_bf16 v[176:179], v[204:207], a[252:255], v[176:179]
ds_write_b64 v252, v[172:173] offset:0
v_mfma_f32_16x16x32_bf16 v[164:167], v[204:207], a[240:243], v[164:167]
ds_read_b64_tr_b16 v[198:199], v217 offset:30720
v_lshlrev_b32 v62, 16, v43
v_mfma_f32_16x16x32_bf16 v[164:167], v[208:211], v[4:7], v[164:167]
s_add_u32 s48, s12, 9216
ds_write_b64 v252, v[174:175] offset:512
v_mfma_f32_16x16x32_bf16 v[164:167], v[212:215], v[20:23], v[164:167]
ds_read_b64_tr_b16 v[200:201], v217 offset:32768
v_and_b32 v63, s62, v43
v_mfma_f32_16x16x32_bf16 v[168:171], v[212:215], v[24:27], v[168:171]
ds_write_b64 v252, v[176:177] offset:1024
v_mfma_f32_16x16x32_bf16 v[168:171], v[208:211], v[8:11], v[168:171]
ds_read_b64_tr_b16 v[202:203], v217 offset:34816
v_mul_f32 v62, v228, v62
v_mfma_f32_16x16x32_bf16 v[168:171], v[204:207], a[244:247], v[168:171]
s_waitcnt lgkmcnt(9)
ds_write_b64 v252, v[178:179] offset:1536
v_mfma_f32_16x16x32_bf16 v[112:115], v[180:183], a[156:159], v[112:115]
ds_read_b64_tr_b16 v[204:205], v218 offset:24576
v_add_u32 v217, 0xc000, v217
v_mfma_f32_16x16x32_bf16 v[112:115], v[184:187], a[172:175], v[112:115]
ds_read_b64_tr_b16 v[206:207], v218 offset:26624
v_mul_f32 v63, v228, v63
v_mfma_f32_16x16x32_bf16 v[112:115], v[188:191], a[188:191], v[112:115]
ds_read_b64_tr_b16 v[208:209], v218 offset:28672
v_lshlrev_b32 v64, 16, v44
v_mfma_f32_16x16x32_bf16 v[104:107], v[188:191], a[180:183], v[104:107]
ds_read_b64_tr_b16 v[210:211], v218 offset:30720
v_and_b32 v65, s62, v44
v_mfma_f32_16x16x32_bf16 v[104:107], v[184:187], a[164:167], v[104:107]
ds_read_b64_tr_b16 v[212:213], v218 offset:32768
v_mul_f32 v64, v228, v64
v_mfma_f32_16x16x32_bf16 v[104:107], v[180:183], a[148:151], v[104:107]
s_waitcnt lgkmcnt(5)
s_barrier
ds_read_b64_tr_b16 v[214:215], v218 offset:34816
v_mfma_f32_16x16x32_bf16 v[128:131], v[192:195], a[156:159], v[128:131]
ds_read_b64_tr_b16 v[180:181], v219 offset:24576
v_add_u32 v218, 0xc000, v218
v_mfma_f32_16x16x32_bf16 v[128:131], v[196:199], a[172:175], v[128:131]
ds_read_b64_tr_b16 v[182:183], v219 offset:26624
ds_read2st64_b64 v[172:175], v253 offset0:0 offset1:1
v_mfma_f32_16x16x32_bf16 v[128:131], v[200:203], a[188:191], v[128:131]
ds_read_b64_tr_b16 v[184:185], v219 offset:28672
ds_read2st64_b64 v[176:179], v253 offset0:2 offset1:3
v_mfma_f32_16x16x32_bf16 v[120:123], v[200:203], a[180:183], v[120:123]
ds_read_b64_tr_b16 v[186:187], v219 offset:30720
v_mul_f32 v65, v228, v65
v_mfma_f32_16x16x32_bf16 v[120:123], v[196:199], a[164:167], v[120:123]
s_waitcnt lgkmcnt(3)
ds_read_b64_tr_b16 v[188:189], v219 offset:32768
v_add_f32 v172, v164, v172
v_mfma_f32_16x16x32_bf16 v[120:123], v[192:195], a[148:151], v[120:123]
ds_read_b64_tr_b16 v[190:191], v219 offset:34816
v_add_f32 v173, v165, v173
v_mfma_f32_16x16x32_bf16 v[144:147], v[204:207], a[156:159], v[144:147]
s_waitcnt lgkmcnt(3)
ds_read_b64_tr_b16 v[192:193], v216 offset:0
v_add_u32 v219, 0xc000, v219
v_mfma_f32_16x16x32_bf16 v[144:147], v[208:211], a[172:175], v[144:147]
ds_read_b64_tr_b16 v[194:195], v216 offset:2048
v_add_f32 v174, v166, v174
v_mfma_f32_16x16x32_bf16 v[144:147], v[212:215], a[188:191], v[144:147]
ds_read_b64_tr_b16 v[196:197], v216 offset:4096
v_add_f32 v175, v167, v175
v_mfma_f32_16x16x32_bf16 v[136:139], v[212:215], a[180:183], v[136:139]
ds_read_b64_tr_b16 v[198:199], v216 offset:6144
v_cvt_pk_bf16_f32 v164, v172, v173
v_mfma_f32_16x16x32_bf16 v[136:139], v[208:211], a[164:167], v[136:139]
ds_read_b64_tr_b16 v[200:201], v216 offset:8192
v_cvt_pk_bf16_f32 v165, v174, v175
v_mfma_f32_16x16x32_bf16 v[136:139], v[204:207], a[148:151], v[136:139]
s_waitcnt lgkmcnt(5)
ds_read_b64_tr_b16 v[202:203], v216 offset:10240
buffer_store_dwordx2 v[164:165], v247, s[20:23], s40 offen sc1
v_mfma_f32_16x16x32_bf16 v[160:163], v[180:183], a[156:159], v[160:163]
ds_read_b64_tr_b16 v[204:205], v217 offset:0
v_add_f32 v176, v168, v176
v_mfma_f32_16x16x32_bf16 v[160:163], v[184:187], a[172:175], v[160:163]
ds_read_b64_tr_b16 v[206:207], v217 offset:2048
v_add_f32 v177, v169, v177
v_mfma_f32_16x16x32_bf16 v[160:163], v[188:191], a[188:191], v[160:163]
ds_read_b64_tr_b16 v[208:209], v217 offset:4096
v_add_f32 v178, v170, v178
v_mfma_f32_16x16x32_bf16 v[152:155], v[188:191], a[180:183], v[152:155]
ds_read_b64_tr_b16 v[210:211], v217 offset:6144
v_add_f32 v179, v171, v179
v_mfma_f32_16x16x32_bf16 v[152:155], v[184:187], a[164:167], v[152:155]
ds_read_b64_tr_b16 v[212:213], v217 offset:8192
v_cvt_pk_bf16_f32 v168, v176, v177
v_mfma_f32_16x16x32_bf16 v[152:155], v[180:183], a[148:151], v[152:155]
s_waitcnt lgkmcnt(5)
ds_read_b64_tr_b16 v[214:215], v217 offset:10240
v_cvt_pk_bf16_f32 v169, v178, v179
v_mfma_f32_16x16x32_bf16 v[112:115], v[192:195], a[204:207], v[112:115]
ds_read_b64_tr_b16 v[180:181], v218 offset:0
buffer_store_dwordx2 v[168:169], v247, s[20:23], s41 offen sc1
v_mfma_f32_16x16x32_bf16 v[112:115], v[196:199], a[220:223], v[112:115]
ds_read_b64_tr_b16 v[182:183], v218 offset:2048
v_lshlrev_b32 v66, 16, v45
v_mfma_f32_16x16x32_bf16 v[112:115], v[200:203], a[236:239], v[112:115]
ds_read_b64_tr_b16 v[184:185], v218 offset:4096
v_and_b32 v67, s62, v45
v_mfma_f32_16x16x32_bf16 v[104:107], v[200:203], a[228:231], v[104:107]
ds_read_b64_tr_b16 v[186:187], v218 offset:6144
v_mul_f32 v66, v228, v66
v_mfma_f32_16x16x32_bf16 v[104:107], v[196:199], a[212:215], v[104:107]
ds_read_b64_tr_b16 v[188:189], v218 offset:8192
v_mul_f32 v67, v228, v67
v_mfma_f32_16x16x32_bf16 v[104:107], v[192:195], a[196:199], v[104:107]
s_waitcnt lgkmcnt(5)
ds_read_b64_tr_b16 v[190:191], v218 offset:10240
buffer_load_dwordx4 v[84:87], v243, s[20:23], s82 offen offset:0 sc1
v_mfma_f32_16x16x32_bf16 v[128:131], v[204:207], a[204:207], v[128:131]
s_waitcnt vmcnt(3)
ds_read_b64_tr_b16 v[192:193], v219 offset:0
v_and_b32 v254, 15, v1
v_mfma_f32_16x16x32_bf16 v[128:131], v[208:211], a[220:223], v[128:131]
ds_read_b64_tr_b16 v[194:195], v219 offset:2048
v_mul_u32_u24 v254, 144, v254
v_mfma_f32_16x16x32_bf16 v[128:131], v[212:215], a[236:239], v[128:131]
ds_read_b64_tr_b16 v[196:197], v219 offset:4096
buffer_load_dwordx4 v[88:91], v243, s[20:23], s82 offen offset:1024 sc1
v_mfma_f32_16x16x32_bf16 v[120:123], v[212:215], a[228:231], v[120:123]
ds_read_b64_tr_b16 v[198:199], v219 offset:6144
v_lshrrev_b32 v255, 4, v1
v_mfma_f32_16x16x32_bf16 v[120:123], v[208:211], a[212:215], v[120:123]
ds_read_b64_tr_b16 v[200:201], v219 offset:8192
v_lshl_add_u32 v254, v255, 3, v254
v_mfma_f32_16x16x32_bf16 v[120:123], v[204:207], a[196:199], v[120:123]
s_waitcnt lgkmcnt(5)
ds_read_b64_tr_b16 v[202:203], v219 offset:10240
v_add_u32 v254, s49, v254
v_mfma_f32_16x16x32_bf16 v[144:147], v[180:183], a[204:207], v[144:147]
ds_read_b64_tr_b16 v[204:205], v216 offset:24576
v_lshrrev_b32 v249, 3, v1
v_mfma_f32_16x16x32_bf16 v[144:147], v[184:187], a[220:223], v[144:147]
ds_read_b64_tr_b16 v[206:207], v216 offset:26624
v_and_b32 v255, 7, v1
v_mfma_f32_16x16x32_bf16 v[144:147], v[188:191], a[236:239], v[144:147]
ds_read_b64_tr_b16 v[208:209], v216 offset:28672
v_lshlrev_b32 v255, 4, v255
v_mfma_f32_16x16x32_bf16 v[136:139], v[188:191], a[228:231], v[136:139]
ds_read_b64_tr_b16 v[210:211], v216 offset:30720
v_mul_u32_u24 v248, 1152, v249
v_mfma_f32_16x16x32_bf16 v[136:139], v[184:187], a[212:215], v[136:139]
ds_read_b64_tr_b16 v[212:213], v216 offset:32768
v_add_u32 v248, v248, v255
v_mfma_f32_16x16x32_bf16 v[136:139], v[180:183], a[196:199], v[136:139]
s_waitcnt lgkmcnt(5)
ds_read_b64_tr_b16 v[214:215], v216 offset:34816
v_mul_u32_u24 v249, 144, v249
v_mfma_f32_16x16x32_bf16 v[160:163], v[192:195], a[204:207], v[160:163]
ds_read_b64_tr_b16 v[180:181], v217 offset:24576
v_add3_u32 v255, v255, v249, s49
v_mfma_f32_16x16x32_bf16 v[160:163], v[196:199], a[220:223], v[160:163]
ds_read_b64_tr_b16 v[182:183], v217 offset:26624
v_lshlrev_b32 v36, 16, v68
v_mfma_f32_16x16x32_bf16 v[160:163], v[200:203], a[236:239], v[160:163]
ds_read_b64_tr_b16 v[184:185], v217 offset:28672
v_and_b32 v68, s62, v68
v_mfma_f32_16x16x32_bf16 v[152:155], v[200:203], a[228:231], v[152:155]
ds_read_b64_tr_b16 v[186:187], v217 offset:30720
v_fmac_f32 v48, v229, v36
v_mfma_f32_16x16x32_bf16 v[152:155], v[196:199], a[212:215], v[152:155]
ds_read_b64_tr_b16 v[188:189], v217 offset:32768
v_fmac_f32 v49, v229, v68
v_mfma_f32_16x16x32_bf16 v[152:155], v[192:195], a[196:199], v[152:155]
s_waitcnt lgkmcnt(5)
ds_read_b64_tr_b16 v[190:191], v217 offset:34816
v_lshlrev_b32 v37, 16, v69
v_mfma_f32_16x16x32_bf16 v[112:115], v[204:207], a[252:255], v[112:115]
ds_read_b64_tr_b16 v[192:193], v218 offset:24576
v_and_b32 v69, s62, v69
v_mfma_f32_16x16x32_bf16 v[112:115], v[208:211], v[16:19], v[112:115]
ds_read_b64_tr_b16 v[194:195], v218 offset:26624
v_fmac_f32 v50, v229, v37
v_mfma_f32_16x16x32_bf16 v[112:115], v[212:215], v[32:35], v[112:115]
ds_read_b64_tr_b16 v[196:197], v218 offset:28672
v_fmac_f32 v51, v229, v69
v_mfma_f32_16x16x32_bf16 v[104:107], v[212:215], v[24:27], v[104:107]
ds_read_b64_tr_b16 v[198:199], v218 offset:30720
v_lshlrev_b32 v38, 16, v70
v_mfma_f32_16x16x32_bf16 v[104:107], v[208:211], v[8:11], v[104:107]
ds_read_b64_tr_b16 v[200:201], v218 offset:32768
v_and_b32 v70, s62, v70
v_mfma_f32_16x16x32_bf16 v[104:107], v[204:207], a[244:247], v[104:107]
s_waitcnt lgkmcnt(5)
ds_read_b64_tr_b16 v[202:203], v218 offset:34816
ds_write_b64 v222, v[112:113] offset:1024
v_mfma_f32_16x16x32_bf16 v[128:131], v[180:183], a[252:255], v[128:131]
ds_read_b64_tr_b16 v[204:205], v219 offset:24576
ds_write_b64 v222, v[114:115] offset:1536
v_mfma_f32_16x16x32_bf16 v[128:131], v[184:187], v[16:19], v[128:131]
ds_read_b64_tr_b16 v[206:207], v219 offset:26624
v_fmac_f32 v52, v229, v38
v_mfma_f32_16x16x32_bf16 v[128:131], v[188:191], v[32:35], v[128:131]
ds_read_b64_tr_b16 v[208:209], v219 offset:28672
v_fmac_f32 v53, v229, v70
v_mfma_f32_16x16x32_bf16 v[120:123], v[188:191], v[24:27], v[120:123]
PAD_18:
s_cmp_lg_u32 s73, 0
s_cbranch_scc1 PAD_ret
ds_read_b64_tr_b16 v[210:211], v219 offset:30720
v_lshlrev_b32 v39, 16, v71
v_mfma_f32_16x16x32_bf16 v[120:123], v[184:187], v[8:11], v[120:123]
ds_read_b64_tr_b16 v[212:213], v219 offset:32768
v_and_b32 v71, s62, v71
v_mfma_f32_16x16x32_bf16 v[120:123], v[180:183], a[244:247], v[120:123]
s_waitcnt lgkmcnt(7)
ds_read_b64_tr_b16 v[214:215], v219 offset:34816
ds_write_b64 v222, v[128:129] offset:3072
v_mfma_f32_16x16x32_bf16 v[144:147], v[192:195], a[252:255], v[144:147]
ds_write_b64 v222, v[130:131] offset:3584
v_mfma_f32_16x16x32_bf16 v[144:147], v[196:199], v[16:19], v[144:147]
v_fmac_f32 v54, v229, v39
v_fmac_f32 v55, v229, v71
v_mfma_f32_16x16x32_bf16 v[144:147], v[200:203], v[32:35], v[144:147]
s_waitcnt lgkmcnt(2)
v_lshlrev_b32 v36, 16, v72
v_and_b32 v72, s62, v72
v_mfma_f32_16x16x32_bf16 v[160:163], v[204:207], a[252:255], v[160:163]
v_fmac_f32 v56, v229, v36
v_fmac_f32 v57, v229, v72
v_mfma_f32_16x16x32_bf16 v[160:163], v[208:211], v[16:19], v[160:163]
v_lshlrev_b32 v37, 16, v73
v_and_b32 v73, s62, v73
v_mfma_f32_16x16x32_bf16 v[160:163], v[212:215], v[32:35], v[160:163]
s_nop 2
v_mfma_f32_16x16x32_bf16 v[136:139], v[200:203], v[24:27], v[136:139]
s_nop 2
v_mfma_f32_16x16x32_bf16 v[136:139], v[196:199], v[8:11], v[136:139]
ds_write_b64 v222, v[144:145] offset:5120
v_mfma_f32_16x16x32_bf16 v[136:139], v[192:195], a[244:247], v[136:139]
ds_write_b64 v222, v[146:147] offset:5632
v_mfma_f32_16x16x32_bf16 v[152:155], v[212:215], v[24:27], v[152:155]
ds_write_b64 v222, v[160:161] offset:7168
v_mfma_f32_16x16x32_bf16 v[152:155], v[208:211], v[8:11], v[152:155]
ds_write_b64 v222, v[162:163] offset:7680
v_mfma_f32_16x16x32_bf16 v[152:155], v[204:207], a[244:247], v[152:155]
v_fmac_f32 v58, v229, v37
v_fmac_f32 v59, v229, v73
s_waitcnt vmcnt(0)
v_max3_u32 v226, v84, v85, v86
v_max3_u32 v226, v87, v88, v226
v_max3_u32 v226, v89, v90, v226
v_max3_u32 v226, v91, v91, v226
v_cmp_eq_u32 vcc, -1, v226
s_nop 1
s_cbranch_vccnz SLOW_sb
RET_sb:
buffer_load_dwordx2 v[92:93], v247, s[20:23], s36 offen offset:0 sc1
buffer_load_dwordx2 v[94:95], v247, s[20:23], s36 offen offset:512 sc1
buffer_load_dwordx2 v[96:97], v247, s[20:23], s36 offen offset:1024 sc1
v_dot2c_f32_bf16 v152, s63, v74
v_dot2c_f32_bf16 v153, s64, v74
v_dot2c_f32_bf16 v154, s63, v75
v_dot2c_f32_bf16 v155, s64, v75
v_dot2c_f32_bf16 v104, s63, v76
v_dot2c_f32_bf16 v105, s64, v76
v_dot2c_f32_bf16 v106, s63, v77
v_dot2c_f32_bf16 v107, s64, v77
v_dot2c_f32_bf16 v120, s63, v78
v_dot2c_f32_bf16 v121, s64, v78
v_dot2c_f32_bf16 v122, s63, v79
v_dot2c_f32_bf16 v123, s64, v79
v_dot2c_f32_bf16 v136, s63, v80
v_dot2c_f32_bf16 v137, s64, v80
v_dot2c_f32_bf16 v138, s63, v81
v_dot2c_f32_bf16 v139, s64, v81
v_dot2c_f32_bf16 v152, s63, v82
v_dot2c_f32_bf16 v153, s64, v82
v_dot2c_f32_bf16 v154, s63, v83
v_dot2c_f32_bf16 v155, s64, v83
s_waitcnt lgkmcnt(0)
s_barrier
ds_read2st64_b64 v[112:115], v223 offset0:2 offset1:3
ds_read2st64_b64 v[128:131], v223 offset0:6 offset1:7
ds_read2st64_b64 v[144:147], v223 offset0:10 offset1:11
ds_read2st64_b64 v[160:163], v223 offset0:14 offset1:15
v_dot2c_f32_bf16 v104, s63, v84
v_dot2c_f32_bf16 v105, s64, v84
v_dot2c_f32_bf16 v106, s63, v85
v_dot2c_f32_bf16 v107, s64, v85
v_dot2c_f32_bf16 v120, s63, v86
v_dot2c_f32_bf16 v121, s64, v86
v_dot2c_f32_bf16 v122, s63, v87
v_dot2c_f32_bf16 v123, s64, v87
v_dot2c_f32_bf16 v136, s63, v88
v_dot2c_f32_bf16 v137, s64, v88
v_dot2c_f32_bf16 v138, s63, v89
v_dot2c_f32_bf16 v139, s64, v89
v_dot2c_f32_bf16 v152, s63, v90
v_dot2c_f32_bf16 v153, s64, v90
v_dot2c_f32_bf16 v154, s63, v91
v_dot2c_f32_bf16 v155, s64, v91
v_pk_fma_f32 v[48:49], v[104:105], v[228:229], v[48:49] op_sel:[0,1,0] op_sel_hi:[1,1,1]
v_pk_fma_f32 v[50:51], v[106:107], v[228:229], v[50:51] op_sel:[0,1,0] op_sel_hi:[1,1,1]
v_pk_fma_f32 v[52:53], v[120:121], v[228:229], v[52:53] op_sel:[0,1,0] op_sel_hi:[1,1,1]
v_pk_fma_f32 v[54:55], v[122:123], v[228:229], v[54:55] op_sel:[0,1,0] op_sel_hi:[1,1,1]
v_pk_fma_f32 v[56:57], v[136:137], v[228:229], v[56:57] op_sel:[0,1,0] op_sel_hi:[1,1,1]
v_pk_fma_f32 v[58:59], v[138:139], v[228:229], v[58:59] op_sel:[0,1,0] op_sel_hi:[1,1,1]
v_pk_fma_f32 v[60:61], v[152:153], v[228:229], v[60:61] op_sel:[0,1,0] op_sel_hi:[1,1,1]
v_pk_fma_f32 v[62:63], v[154:155], v[228:229], v[62:63] op_sel:[0,1,0] op_sel_hi:[1,1,1]
s_waitcnt lgkmcnt(2)
v_pk_fma_f32 v[48:49], v[112:113], v[228:229], v[48:49] op_sel:[0,1,0] op_sel_hi:[1,1,1]
v_pk_fma_f32 v[50:51], v[114:115], v[228:229], v[50:51] op_sel:[0,1,0] op_sel_hi:[1,1,1]
v_pk_fma_f32 v[52:53], v[128:129], v[228:229], v[52:53] op_sel:[0,1,0] op_sel_hi:[1,1,1]
v_pk_fma_f32 v[54:55], v[130:131], v[228:229], v[54:55] op_sel:[0,1,0] op_sel_hi:[1,1,1]
v_cvt_pk_bf16_f32 v36, v48, v49
v_cvt_pk_bf16_f32 v37, v50, v51
v_cvt_pk_bf16_f32 v38, v52, v53
v_cvt_pk_bf16_f32 v39, v54, v55
ds_write2_b64 v254, v[36:37], v[38:39] offset0:0 offset1:4
s_waitcnt lgkmcnt(1)
v_pk_fma_f32 v[56:57], v[144:145], v[228:229], v[56:57] op_sel:[0,1,0] op_sel_hi:[1,1,1]
v_pk_fma_f32 v[58:59], v[146:147], v[228:229], v[58:59] op_sel:[0,1,0] op_sel_hi:[1,1,1]
v_pk_fma_f32 v[60:61], v[160:161], v[228:229], v[60:61] op_sel:[0,1,0] op_sel_hi:[1,1,1]
v_pk_fma_f32 v[62:63], v[162:163], v[228:229], v[62:63] op_sel:[0,1,0] op_sel_hi:[1,1,1]
v_cvt_pk_bf16_f32 v40, v56, v57
v_cvt_pk_bf16_f32 v41, v58, v59
v_cvt_pk_bf16_f32 v42, v60, v61
v_cvt_pk_bf16_f32 v43, v62, v63
ds_write2_b64 v254, v[40:41], v[42:43] offset0:8 offset1:12
ds_read_b128 v[36:39], v255 offset:0
ds_read_b128 v[40:43], v255 offset:1152
s_waitcnt lgkmcnt(1)
buffer_store_dwordx4 v[36:39], v248, s[24:27], s12 offen sc1
s_waitcnt lgkmcnt(0)
buffer_store_dwordx4 v[40:43], v248, s[24:27], s48 offen sc1
s_waitcnt vmcnt(2)
v_max3_u32 v226, v92, v93, v94
v_max3_u32 v226, v95, v96, v226
v_max3_u32 v226, v97, v97, v226
v_cmp_eq_u32 vcc, -1, v226
s_nop 1
s_cbranch_vccnz SLOW_sc
RET_sc:
v_dot2c_f32_bf16 v176, s63, v92
v_dot2c_f32_bf16 v177, s64, v92
v_dot2c_f32_bf16 v178, s63, v93
v_dot2c_f32_bf16 v179, s64, v93
v_dot2c_f32_bf16 v176, s63, v94
v_dot2c_f32_bf16 v177, s64, v94
v_dot2c_f32_bf16 v178, s63, v95
v_dot2c_f32_bf16 v179, s64, v95
v_dot2c_f32_bf16 v176, s63, v96
v_dot2c_f32_bf16 v177, s64, v96
v_dot2c_f32_bf16 v178, s63, v97
v_dot2c_f32_bf16 v179, s64, v97
v_fmac_f32 v64, v229, v176
v_fmac_f32 v65, v229, v177
v_fmac_f32 v66, v229, v178
v_fmac_f32 v67, v229, v179
v_cvt_pk_bf16_f32 v44, v64, v65
v_cvt_pk_bf16_f32 v45, v66, v67
buffer_store_dwordx2 v[44:45], v230, s[24:27], s13 offen
s_endpgm
KF_noconv_wg:
PAD_19:
s_cmp_lg_u32 s73, 0
s_cbranch_scc1 PAD_ret
buffer_load_dwordx4 a[0:3], v242, s[20:23], s44 offen offset:0 sc1
buffer_load_dwordx4 a[4:7], v242, s[20:23], s45 offen offset:0 sc1
buffer_load_dwordx4 a[8:11], v242, s[20:23], s46 offen offset:0 sc1
buffer_load_dwordx4 a[12:15], v242, s[20:23], s47 offen offset:0 sc1
buffer_load_dwordx4 a[16:19], v242, s[20:23], s44 offen offset:1024 sc1
buffer_load_dwordx4 a[20:23], v242, s[20:23], s45 offen offset:1024 sc1
buffer_load_dwordx4 a[24:27], v242, s[20:23], s46 offen offset:1024 sc1
buffer_load_dwordx4 a[28:31], v242, s[20:23], s47 offen offset:1024 sc1
buffer_load_dwordx4 a[64:67], v243, s[20:23], s44 offen offset:0 sc1
buffer_load_dwordx4 a[68:71], v243, s[20:23], s45 offen offset:0 sc1
buffer_load_dwordx4 a[72:75], v243, s[20:23], s46 offen offset:0 sc1
buffer_load_dwordx4 a[76:79], v243, s[20:23], s47 offen offset:0 sc1
buffer_load_dwordx4 a[80:83], v243, s[20:23], s44 offen offset:1024 sc1
buffer_load_dwordx4 a[84:87], v243, s[20:23], s45 offen offset:1024 sc1
buffer_load_dwordx4 a[88:91], v243, s[20:23], s46 offen offset:1024 sc1
buffer_load_dwordx4 a[92:95], v243, s[20:23], s47 offen offset:1024 sc1
s_waitcnt vmcnt(16)
buffer_store_dword v213, v214, s[20:23], s76 offen sc1
buffer_load_dwordx4 a[128:131], v244, s[20:23], s44 offen offset:0 sc1
buffer_load_dwordx4 a[132:135], v244, s[20:23], s45 offen offset:0 sc1
buffer_load_dwordx4 a[136:139], v244, s[20:23], s46 offen offset:0 sc1
buffer_load_dwordx4 a[140:143], v244, s[20:23], s47 offen offset:0 sc1
buffer_load_dwordx4 a[144:147], v244, s[20:23], s44 offen offset:1024 sc1
buffer_load_dwordx4 a[148:151], v244, s[20:23], s45 offen offset:1024 sc1
buffer_load_dwordx4 a[152:155], v244, s[20:23], s46 offen offset:1024 sc1
buffer_load_dwordx4 a[156:159], v244, s[20:23], s47 offen offset:1024 sc1
buffer_load_dwordx4 a[192:195], v245, s[20:23], s44 offen offset:0 sc1
buffer_load_dwordx4 a[196:199], v245, s[20:23], s45 offen offset:0 sc1
buffer_load_dwordx4 a[200:203], v245, s[20:23], s46 offen offset:0 sc1
buffer_load_dwordx4 a[204:207], v245, s[20:23], s47 offen offset:0 sc1
buffer_load_dwordx4 a[208:211], v245, s[20:23], s44 offen offset:1024 sc1
buffer_load_dwordx4 a[212:215], v245, s[20:23], s45 offen offset:1024 sc1
buffer_load_dwordx4 a[216:219], v245, s[20:23], s46 offen offset:1024 sc1
buffer_load_dwordx4 a[220:223], v245, s[20:23], s47 offen offset:1024 sc1
s_add_u32 m0, s34, 0
s_add_u32 s69, s30, 0
buffer_load_dwordx4 v237, s[16:19], s69 offen offset:0 lds
s_add_u32 s69, s30, 16384
buffer_load_dwordx4 v237, s[16:19], s69 offen offset:2048 lds
s_add_u32 m0, s34, 4096
s_add_u32 s69, s30, 36864
buffer_load_dwordx4 v237, s[16:19], s69 offen offset:0 lds
s_add_u32 s69, s30, 53248
buffer_load_dwordx4 v237, s[16:19], s69 offen offset:2048 lds
s_add_u32 m0, s34, 8192
s_add_u32 s69, s30, 73728
buffer_load_dwordx4 v238, s[16:19], s69 offen offset:0 lds
s_add_u32 s69, s30, 90112
buffer_load_dwordx4 v238, s[16:19], s69 offen offset:2048 lds
s_add_u32 m0, s34, 24576
s_add_u32 s69, s30, 110592
buffer_load_dwordx4 v238, s[16:19], s69 offen offset:0 lds
s_add_u32 s69, s30, 126976
buffer_load_dwordx4 v238, s[16:19], s69 offen offset:2048 lds
s_add_u32 m0, s34, 28672
s_add_u32 s69, s30, 147456
buffer_load_dwordx4 v237, s[16:19], s69 offen offset:0 lds
s_add_u32 s69, s30, 163840
buffer_load_dwordx4 v237, s[16:19], s69 offen offset:2048 lds
s_add_u32 m0, s34, 32768
s_add_u32 s69, s30, 184320
buffer_load_dwordx4 v237, s[16:19], s69 offen offset:0 lds
s_add_u32 s69, s30, 200704
buffer_load_dwordx4 v237, s[16:19], s69 offen offset:2048 lds
s_add_u32 m0, s34, 49152
s_add_u32 s69, s30, 221184
buffer_load_dwordx4 v238, s[16:19], s69 offen offset:0 lds
s_add_u32 s69, s30, 237568
buffer_load_dwordx4 v238, s[16:19], s69 offen offset:2048 lds
s_add_u32 m0, s34, 53248
s_add_u32 s69, s30, 258048
buffer_load_dwordx4 v238, s[16:19], s69 offen offset:0 lds
s_add_u32 s69, s30, 274432
buffer_load_dwordx4 v238, s[16:19], s69 offen offset:2048 lds
s_add_u32 m0, s34, 57344
s_add_u32 s69, s30, 294912
buffer_load_dwordx4 v237, s[16:19], s69 offen offset:0 lds
s_add_u32 s69, s30, 311296
buffer_load_dwordx4 v237, s[16:19], s69 offen offset:2048 lds
buffer_load_dword v212, v215, s[20:23], s72 offen sc1
s_add_u32 m0, s34, 73728
s_add_u32 s69, s30, 331776
buffer_load_dwordx4 v237, s[16:19], s69 offen offset:0 lds
s_add_u32 s69, s30, 348160
buffer_load_dwordx4 v237, s[16:19], s69 offen offset:2048 lds
s_add_u32 m0, s34, 77824
s_add_u32 s69, s30, 368640
buffer_load_dwordx4 v238, s[16:19], s69 offen offset:0 lds
s_add_u32 s69, s30, 385024
buffer_load_dwordx4 v238, s[16:19], s69 offen offset:2048 lds
s_add_u32 m0, s34, 81920
s_add_u32 s69, s30, 405504
buffer_load_dwordx4 v238, s[16:19], s69 offen offset:0 lds
s_add_u32 s69, s30, 421888
buffer_load_dwordx4 v238, s[16:19], s69 offen offset:2048 lds
s_waitcnt vmcnt(6)
v_cmp_gt_u32 vcc, 2, v212
s_nop 1
s_cbranch_vccnz SLOW_h2
RET_h2:
buffer_load_dwordx4 a[32:35], v242, s[20:23], s44 offen offset:2048 sc1
buffer_load_dwordx4 a[36:39], v242, s[20:23], s45 offen offset:2048 sc1
buffer_load_dwordx4 a[40:43], v242, s[20:23], s46 offen offset:2048 sc1
buffer_load_dwordx4 a[44:47], v242, s[20:23], s47 offen offset:2048 sc1
buffer_load_dwordx4 a[48:51], v242, s[20:23], s44 offen offset:3072 sc1
buffer_load_dwordx4 a[52:55], v242, s[20:23], s45 offen offset:3072 sc1
buffer_load_dwordx4 a[56:59], v242, s[20:23], s46 offen offset:3072 sc1
buffer_load_dwordx4 a[60:63], v242, s[20:23], s47 offen offset:3072 sc1
buffer_load_dwordx4 a[96:99], v243, s[20:23], s44 offen offset:2048 sc1
buffer_load_dwordx4 a[100:103], v243, s[20:23], s45 offen offset:2048 sc1
buffer_load_dwordx4 a[104:107], v243, s[20:23], s46 offen offset:2048 sc1
buffer_load_dwordx4 a[108:111], v243, s[20:23], s47 offen offset:2048 sc1
buffer_load_dwordx4 a[112:115], v243, s[20:23], s44 offen offset:3072 sc1
buffer_load_dwordx4 a[116:119], v243, s[20:23], s45 offen offset:3072 sc1
buffer_load_dwordx4 a[120:123], v243, s[20:23], s46 offen offset:3072 sc1
buffer_load_dwordx4 a[124:127], v243, s[20:23], s47 offen offset:3072 sc1
buffer_load_dwordx4 a[160:163], v244, s[20:23], s44 offen offset:2048 sc1
buffer_load_dwordx4 a[164:167], v244, s[20:23], s45 offen offset:2048 sc1
buffer_load_dwordx4 a[168:171], v244, s[20:23], s46 offen offset:2048 sc1
buffer_load_dwordx4 a[172:175], v244, s[20:23], s47 offen offset:2048 sc1
buffer_load_dwordx4 a[176:179], v244, s[20:23], s44 offen offset:3072 sc1
buffer_store_dword v213, v214, s[20:23], s77 offen
buffer_store_dword v213, v214, s[20:23], s77 offen
buffer_store_dword v213, v214, s[20:23], s77 offen
buffer_store_dword v213, v214, s[20:23], s77 offen
s_waitcnt vmcnt(37)
s_branch KF_g2
KF_noconv_wave:
PAD_20:
s_cmp_lg_u32 s73, 0
s_cbranch_scc1 PAD_ret
s_barrier
buffer_load_dwordx4 a[204:207], v245, s[20:23], s47 offen offset:0 sc1
s_waitcnt vmcnt(8)
buffer_load_dwordx4 a[208:211], v245, s[20:23], s44 offen offset:1024 sc1
s_waitcnt vmcnt(8)
buffer_load_dwordx4 a[212:215], v245, s[20:23], s45 offen offset:1024 sc1
s_waitcnt vmcnt(8)
buffer_load_dwordx4 a[216:219], v245, s[20:23], s46 offen offset:1024 sc1
s_waitcnt vmcnt(8)
buffer_load_dwordx4 a[220:223], v245, s[20:23], s47 offen offset:1024 sc1
s_waitcnt vmcnt(8)
s_add_u32 m0, s34, 0
s_add_u32 s69, s30, 0
buffer_load_dwordx4 v237, s[16:19], s69 offen offset:0 lds
s_waitcnt vmcnt(8)
s_add_u32 s69, s30, 16384
buffer_load_dwordx4 v237, s[16:19], s69 offen offset:2048 lds
s_waitcnt vmcnt(8)
s_add_u32 m0, s34, 4096
s_add_u32 s69, s30, 36864
buffer_load_dwordx4 v237, s[16:19], s69 offen offset:0 lds
s_waitcnt vmcnt(8)
s_add_u32 s69, s30, 53248
buffer_load_dwordx4 v237, s[16:19], s69 offen offset:2048 lds
s_waitcnt vmcnt(8)
s_add_u32 m0, s34, 8192
s_add_u32 s69, s30, 73728
buffer_load_dwordx4 v238, s[16:19], s69 offen offset:0 lds
s_waitcnt vmcnt(8)
s_add_u32 s69, s30, 90112
buffer_load_dwordx4 v238, s[16:19], s69 offen offset:2048 lds
s_waitcnt vmcnt(8)
s_add_u32 m0, s34, 24576
s_add_u32 s69, s30, 110592
buffer_load_dwordx4 v238, s[16:19], s69 offen offset:0 lds
s_waitcnt vmcnt(8)
s_add_u32 s69, s30, 126976
buffer_load_dwordx4 v238, s[16:19], s69 offen offset:2048 lds
s_waitcnt vmcnt(8)
s_add_u32 m0, s34, 28672
s_add_u32 s69, s30, 147456
buffer_load_dwordx4 v237, s[16:19], s69 offen offset:0 lds
s_waitcnt vmcnt(8)
s_add_u32 s69, s30, 163840
buffer_load_dwordx4 v237, s[16:19], s69 offen offset:2048 lds
s_waitcnt vmcnt(8)
s_add_u32 m0, s34, 32768
s_add_u32 s69, s30, 184320
buffer_load_dwordx4 v237, s[16:19], s69 offen offset:0 lds
s_waitcnt vmcnt(8)
s_add_u32 s69, s30, 200704
buffer_load_dwordx4 v237, s[16:19], s69 offen offset:2048 lds
s_waitcnt vmcnt(8)
s_add_u32 m0, s34, 49152
s_add_u32 s69, s30, 221184
buffer_load_dwordx4 v238, s[16:19], s69 offen offset:0 lds
s_waitcnt vmcnt(8)
s_add_u32 s69, s30, 237568
buffer_load_dwordx4 v238, s[16:19], s69 offen offset:2048 lds
s_waitcnt vmcnt(8)
s_add_u32 m0, s34, 53248
s_add_u32 s69, s30, 258048
buffer_load_dwordx4 v238, s[16:19], s69 offen offset:0 lds
s_waitcnt vmcnt(8)
s_add_u32 s69, s30, 274432
buffer_load_dwordx4 v238, s[16:19], s69 offen offset:2048 lds
s_waitcnt vmcnt(8)
s_add_u32 m0, s34, 57344
s_add_u32 s69, s30, 294912
buffer_load_dwordx4 v237, s[16:19], s69 offen offset:0 lds
s_waitcnt vmcnt(8)
s_add_u32 s69, s30, 311296
buffer_load_dwordx4 v237, s[16:19], s69 offen offset:2048 lds
s_waitcnt vmcnt(8)
buffer_load_dword v212, v215, s[20:23], s72 offen sc1
s_waitcnt vmcnt(8)
s_add_u32 m0, s34, 73728
s_add_u32 s69, s30, 331776
buffer_load_dwordx4 v237, s[16:19], s69 offen offset:0 lds
s_waitcnt vmcnt(8)
s_add_u32 s69, s30, 348160
buffer_load_dwordx4 v237, s[16:19], s69 offen offset:2048 lds
s_waitcnt vmcnt(8)
s_add_u32 m0, s34, 77824
s_add_u32 s69, s30, 368640
buffer_load_dwordx4 v238, s[16:19], s69 offen offset:0 lds
s_waitcnt vmcnt(8)
s_add_u32 s69, s30, 385024
buffer_load_dwordx4 v238, s[16:19], s69 offen offset:2048 lds
s_waitcnt vmcnt(8)
s_add_u32 m0, s34, 81920
s_add_u32 s69, s30, 405504
buffer_load_dwordx4 v238, s[16:19], s69 offen offset:0 lds
s_waitcnt vmcnt(8)
s_add_u32 s69, s30, 421888
buffer_load_dwordx4 v238, s[16:19], s69 offen offset:2048 lds
s_waitcnt vmcnt(8)
s_waitcnt vmcnt(6)
v_cmp_gt_u32 vcc, 2, v212
s_nop 1
s_cbranch_vccnz SLOW_h4
RET_h4:
buffer_load_dwordx4 a[32:35], v242, s[20:23], s44 offen offset:2048 sc1
s_waitcnt vmcnt(8)
buffer_load_dwordx4 a[36:39], v242, s[20:23], s45 offen offset:2048 sc1
s_waitcnt vmcnt(8)
buffer_load_dwordx4 a[40:43], v242, s[20:23], s46 offen offset:2048 sc1
s_waitcnt vmcnt(8)
buffer_load_dwordx4 a[44:47], v242, s[20:23], s47 offen offset:2048 sc1
s_waitcnt vmcnt(8)
buffer_load_dwordx4 a[48:51], v242, s[20:23], s44 offen offset:3072 sc1
s_waitcnt vmcnt(8)
buffer_load_dwordx4 a[52:55], v242, s[20:23], s45 offen offset:3072 sc1
s_waitcnt vmcnt(8)
buffer_load_dwordx4 a[56:59], v242, s[20:23], s46 offen offset:3072 sc1
s_waitcnt vmcnt(8)
buffer_load_dwordx4 a[60:63], v242, s[20:23], s47 offen offset:3072 sc1
s_waitcnt vmcnt(8)
buffer_load_dwordx4 a[96:99], v243, s[20:23], s44 offen offset:2048 sc1
s_waitcnt vmcnt(8)
buffer_load_dwordx4 a[100:103], v243, s[20:23], s45 offen offset:2048 sc1
s_waitcnt vmcnt(8)
buffer_load_dwordx4 a[104:107], v243, s[20:23], s46 offen offset:2048 sc1
s_waitcnt vmcnt(8)
buffer_load_dwordx4 a[108:111], v243, s[20:23], s47 offen offset:2048 sc1
s_waitcnt vmcnt(8)
buffer_load_dwordx4 a[112:115], v243, s[20:23], s44 offen offset:3072 sc1
s_waitcnt vmcnt(8)
buffer_load_dwordx4 a[116:119], v243, s[20:23], s45 offen offset:3072 sc1
s_waitcnt vmcnt(8)
buffer_load_dwordx4 a[120:123], v243, s[20:23], s46 offen offset:3072 sc1
s_waitcnt vmcnt(8)
buffer_load_dwordx4 a[124:127], v243, s[20:23], s47 offen offset:3072 sc1
s_waitcnt vmcnt(8)
buffer_load_dwordx4 a[160:163], v244, s[20:23], s44 offen offset:2048 sc1
s_waitcnt vmcnt(8)
buffer_load_dwordx4 a[164:167], v244, s[20:23], s45 offen offset:2048 sc1
s_waitcnt vmcnt(8)
buffer_load_dwordx4 a[168:171], v244, s[20:23], s46 offen offset:2048 sc1
s_waitcnt vmcnt(8)
buffer_load_dwordx4 a[172:175], v244, s[20:23], s47 offen offset:2048 sc1
s_waitcnt vmcnt(8)
buffer_load_dwordx4 a[176:179], v244, s[20:23], s44 offen offset:3072 sc1
s_waitcnt vmcnt(8)
buffer_store_dword v213, v214, s[20:23], s77 offen
buffer_store_dword v213, v214, s[20:23], s77 offen
buffer_store_dword v213, v214, s[20:23], s77 offen
buffer_store_dword v213, v214, s[20:23], s77 offen
s_waitcnt vmcnt(37)
s_branch KF_g2
KF_pre1:
s_and_b32 s76, s2, 7
s_lshr_b32 s77, s2, 3
s_lshl3_add_u32 s76, s76, s77
s_sub_u32 s76, s76, 24
s_lshl2_add_u32 s77, s76, s3
s_mul_i32 s69, s77, 9216
s_and_b32 s78, s3, 1
s_lshl_b32 s78, s78, 6
v_xor_b32 v152, s78, v224
s_lshl_b32 s78, s3, 10
v_lshlrev_b32 v148, 4, v0
s_mov_b32 s48, s40
s_mov_b32 s49, s41
s_mov_b32 s50, 1152
s_add_u32 m0, s78, 86016
s_mov_b32 s51, 0x00020000
buffer_load_dwordx4 v148, s[48:51], 0 offen lds
s_add_u32 m0, s78, 49152
s_nop 0
buffer_load_dwordx4 v152, s[4:7], s69 offen offset:0 lds
s_add_u32 m0, s78, 53120
s_nop 0
buffer_load_dwordx4 v152, s[4:7], s69 offen offset:128 lds
s_add_u32 m0, s78, 57088
s_nop 0
buffer_load_dwordx4 v152, s[4:7], s69 offen offset:256 lds
s_add_u32 m0, s78, 61056
s_nop 0
buffer_load_dwordx4 v152, s[4:7], s69 offen offset:384 lds
s_add_u32 m0, s78, 65024
s_nop 0
buffer_load_dwordx4 v152, s[4:7], s69 offen offset:512 lds
s_add_u32 m0, s78, 68992
s_nop 0
buffer_load_dwordx4 v152, s[4:7], s69 offen offset:640 lds
s_add_u32 m0, s78, 72960
s_nop 0
buffer_load_dwordx4 v152, s[4:7], s69 offen offset:768 lds
s_add_u32 m0, s78, 76928
s_nop 0
buffer_load_dwordx4 v152, s[4:7], s69 offen offset:896 lds
s_add_u32 m0, s78, 80896
s_nop 0
buffer_load_dwordx4 v152, s[4:7], s69 offen offset:1024 lds
s_branch KF_pre1_ret
KF_pre2:
v_lshlrev_b32 v148, 4, v0
v_mov_b32 v146, 0
v_and_b32 v2, 3, v1
v_lshlrev_b32 v2, 2, v2
v_min_u32 v3, 8, v1
v_lshlrev_b32 v3, 5, v3
s_sub_u32 s56, s2, 192
s_mul_i32 s57, s56, 288
s_add_u32 s57, s57, 47448064
s_lshl2_add_u32 s56, s56, s3
s_lshl_b32 s56, s56, 7
s_add_u32 s58, s56, 47185920
s_add_u32 s56, s56, 47316992
buffer_store_dword v146, v2, s[20:23], s58 offen sc1
buffer_store_dword v146, v2, s[20:23], s56 offen sc1
buffer_store_dword v146, v3, s[20:23], s57 offen sc1
v_bfe_u32 v2, v1, 2, 2
v_lshrrev_b32 v3, 4, v1
v_lshlrev_b32 v3, 3, v3
v_sub_u32 v2, v3, v2
v_add_u32 v2, 7, v2
v_bfe_u32 v3, v2, 1, 3
v_bfe_u32 v215, v1, 1, 1
v_xor_b32 v3, v3, v215
v_lshlrev_b32 v3, 4, v3
v_lshl_add_u32 v2, v2, 7, v3
v_and_b32 v3, 1, v1
v_lshl_add_u32 v2, v3, 3, v2
s_lshl_b32 s58, s3, 5
v_xor_b32 v2, s58, v2
v_add_u32 v2, 49152, v2
v_xor_b32 v3, 0x220, v2
v_and_b32 v215, 15, v1
v_and_b32 v149, 48, v1
v_sub_u32 v149, 48, v149
v_lshl_add_u32 v215, v215, 6, v149
v_add_u32 v151, s78, v215
v_bfe_u32 v149, v1, 1, 2
v_lshlrev_b32 v149, 4, v149
v_xor_b32 v215, v151, v149
v_add_u32 v215, 0, v215
v_bfe_u32 v149, v1, 3, 2
v_lshlrev_b32 v149, 4, v149
v_xor_b32 v149, v149, v148
v_add_u32 v150, 49152, v148
v_and_b32 v152, 127, v152
v_add_u32 v152, 86016, v152
s_sub_u32 s56, 63, s76
s_mul_i32 s56, s56, 36992
s_add_u32 s56, s56, 48234496
s_waitcnt vmcnt(17)
s_barrier
ds_read_b64_tr_b16 v[108:109], v2 offset:0
ds_read_b64_tr_b16 v[110:111], v3 offset:0
ds_read_b64_tr_b16 v[112:113], v2 offset:4096
ds_read_b64_tr_b16 v[114:115], v3 offset:4096
ds_read_b64_tr_b16 v[116:117], v2 offset:8192
ds_read_b64_tr_b16 v[118:119], v3 offset:8192
ds_read_b64_tr_b16 v[120:121], v2 offset:12288
ds_read_b64_tr_b16 v[122:123], v3 offset:12288
ds_read_b64_tr_b16 v[124:125], v2 offset:16384
ds_read_b64_tr_b16 v[126:127], v3 offset:16384
ds_read_b64_tr_b16 v[128:129], v2 offset:20480
ds_read_b64_tr_b16 v[130:131], v3 offset:20480
ds_read_b64_tr_b16 v[132:133], v2 offset:24576
ds_read_b64_tr_b16 v[134:135], v3 offset:24576
ds_read_b64_tr_b16 v[136:137], v2 offset:28672
ds_read_b64_tr_b16 v[138:139], v3 offset:28672
ds_read_b64_tr_b16 v[140:141], v2 offset:32768
ds_read_b64_tr_b16 v[142:143], v3 offset:32768
ds_read_b128 v[72:75], v152 offset:0
ds_read_b128 v[36:39], v150 offset:0
ds_read_b128 v[76:79], v152 offset:128
ds_read_b128 v[40:43], v150 offset:4096
ds_read_b128 v[80:83], v152 offset:256
ds_read_b128 v[44:47], v150 offset:8192
ds_read_b128 v[84:87], v152 offset:384
ds_read_b128 v[48:51], v150 offset:12288
ds_read_b128 v[88:91], v152 offset:512
ds_read_b128 v[52:55], v150 offset:16384
ds_read_b128 v[92:95], v152 offset:640
ds_read_b128 v[56:59], v150 offset:20480
ds_read_b128 v[96:99], v152 offset:768
ds_read_b128 v[60:63], v150 offset:24576
ds_read_b128 v[100:103], v152 offset:896
ds_read_b128 v[64:67], v150 offset:28672
ds_read_b128 v[104:107], v152 offset:1024
ds_read_b128 v[68:71], v150 offset:32768
s_waitcnt lgkmcnt(15)
buffer_store_dwordx4 v[108:111], v151, s[20:23], s56 offen sc1
s_add_u32 s56, s56, 4096
buffer_store_dwordx4 v[112:115], v151, s[20:23], s56 offen sc1
s_add_u32 s56, s56, 4096
buffer_store_dwordx4 v[116:119], v151, s[20:23], s56 offen sc1
s_add_u32 s56, s56, 4096
buffer_store_dwordx4 v[120:123], v151, s[20:23], s56 offen sc1
s_add_u32 s56, s56, 4096
buffer_store_dwordx4 v[124:127], v151, s[20:23], s56 offen sc1
s_add_u32 s56, s56, 4096
buffer_store_dwordx4 v[128:131], v151, s[20:23], s56 offen sc1
s_add_u32 s56, s56, 4096
buffer_store_dwordx4 v[132:135], v151, s[20:23], s56 offen sc1
s_add_u32 s56, s56, 4096
buffer_store_dwordx4 v[136:139], v151, s[20:23], s56 offen sc1
s_add_u32 s56, s56, 4096
buffer_store_dwordx4 v[140:143], v151, s[20:23], s56 offen sc1
s_add_u32 s56, s56, 4096
s_waitcnt lgkmcnt(0)
v_dot2_f32_bf16 v144, v36, v72, 0
v_dot2_f32_bf16 v145, v37, v73, 0
v_dot2_f32_bf16 v144, v38, v74, v144
v_dot2_f32_bf16 v145, v39, v75, v145
v_dot2_f32_bf16 v144, v40, v76, v144
v_dot2_f32_bf16 v145, v41, v77, v145
v_dot2_f32_bf16 v144, v42, v78, v144
v_dot2_f32_bf16 v145, v43, v79, v145
v_dot2_f32_bf16 v144, v44, v80, v144
v_dot2_f32_bf16 v145, v45, v81, v145
v_dot2_f32_bf16 v144, v46, v82, v144
v_dot2_f32_bf16 v145, v47, v83, v145
v_dot2_f32_bf16 v144, v48, v84, v144
v_dot2_f32_bf16 v145, v49, v85, v145
v_dot2_f32_bf16 v144, v50, v86, v144
v_dot2_f32_bf16 v145, v51, v87, v145
v_dot2_f32_bf16 v144, v52, v88, v144
v_dot2_f32_bf16 v145, v53, v89, v145
v_dot2_f32_bf16 v144, v54, v90, v144
v_dot2_f32_bf16 v145, v55, v91, v145
v_dot2_f32_bf16 v144, v56, v92, v144
v_dot2_f32_bf16 v145, v57, v93, v145
v_dot2_f32_bf16 v144, v58, v94, v144
v_dot2_f32_bf16 v145, v59, v95, v145
v_dot2_f32_bf16 v144, v60, v96, v144
v_dot2_f32_bf16 v145, v61, v97, v145
v_dot2_f32_bf16 v144, v62, v98, v144
v_dot2_f32_bf16 v145, v63, v99, v145
v_dot2_f32_bf16 v144, v64, v100, v144
v_dot2_f32_bf16 v145, v65, v101, v145
v_dot2_f32_bf16 v144, v66, v102, v144
v_dot2_f32_bf16 v145, v67, v103, v145
v_dot2_f32_bf16 v144, v68, v104, v144
v_dot2_f32_bf16 v145, v69, v105, v145
v_dot2_f32_bf16 v144, v70, v106, v144
v_dot2_f32_bf16 v145, v71, v107, v145
s_nop 2
v_add_f32 v144, v144, v145
s_nop 1
v_add_f32_dpp v144, v144, v144 quad_perm:[1,0,3,2] row_mask:0xf bank_mask:0xf
s_nop 1
v_add_f32_dpp v144, v144, v144 quad_perm:[2,3,0,1] row_mask:0xf bank_mask:0xf
s_nop 1
v_add_f32_dpp v144, v144, v144 row_half_mirror row_mask:0xf bank_mask:0xf
v_mul_f32 v144, s74, v144
v_exp_f32 v144, v144
v_lshrrev_b32 v2, 3, v1
v_add_f32 v144, 1.0, v144
v_rcp_f32 v144, v144
v_lshlrev_b32 v2, 2, v2
s_lshl_b32 s57, s77, 5
s_add_u32 s57, s57, 46137344
buffer_store_dword v144, v2, s[20:23], s57 offen sc1
s_bfe_u32 s65, s54, 0x40004
s_lshl_b32 s65, s65, 7
s_add_u32 m0, s72, 8192
s_add_u32 s70, s44, s65
buffer_load_dwordx4 v224, s[4:7], s70 offen offset:0  lds
buffer_load_dwordx4 v225, s[4:7], s70 offen offset:1024  lds
s_add_u32 m0, s72, 10240
s_add_u32 s70, s45, s65
buffer_load_dwordx4 v224, s[4:7], s70 offen offset:0  lds
buffer_load_dwordx4 v225, s[4:7], s70 offen offset:1024  lds
s_add_u32 m0, s72, 12288
s_add_u32 s70, s46, s65
buffer_load_dwordx4 v224, s[4:7], s70 offen offset:0  lds
buffer_load_dwordx4 v225, s[4:7], s70 offen offset:1024  lds
s_add_u32 m0, s72, 14336
s_add_u32 s70, s47, s65
buffer_load_dwordx4 v224, s[4:7], s70 offen offset:0  lds
buffer_load_dwordx4 v225, s[4:7], s70 offen offset:1024  lds
s_waitcnt lgkmcnt(0)
s_branch KF_pre2_ret
SLOW_guard:
s_mov_b32 s61, 0
SLOWL_guard:
buffer_load_dword v255, v248, s[24:27], 0 offen sc1
s_add_u32 s61, s61, 1
s_cmp_gt_u32 s61, 131072
s_waitcnt vmcnt(0)
v_cmp_gt_u32 vcc, 1, v255
s_cbranch_scc1 RET_guard
s_nop 1
s_cbranch_vccz RET_guard
s_branch SLOWL_guard
SLOW_hA:
s_mov_b32 s61, 0
SLOWL_hA:
buffer_load_dword v212, v215, s[20:23], s72 offen sc1
s_add_u32 s61, s61, 1
s_cmp_gt_u32 s61, 131072
s_waitcnt vmcnt(0)
v_cmp_gt_u32 vcc, 1, v212
s_cbranch_scc1 RET_hA
s_nop 1
s_cbranch_vccz RET_hA
s_branch SLOWL_hA
SLOW_h1:
s_mov_b32 s61, 0
SLOWL_h1:
buffer_load_dword v212, v215, s[20:23], s72 offen sc1
s_add_u32 s61, s61, 1
s_cmp_gt_u32 s61, 131072
s_waitcnt vmcnt(0)
v_cmp_gt_u32 vcc, 2, v212
s_cbranch_scc1 RET_h1
s_nop 1
s_cbranch_vccz RET_h1
s_branch SLOWL_h1
SLOW_h2:
s_mov_b32 s61, 0
SLOWL_h2:
buffer_load_dword v212, v215, s[20:23], s72 offen sc1
s_add_u32 s61, s61, 1
s_cmp_gt_u32 s61, 131072
s_waitcnt vmcnt(0)
v_cmp_gt_u32 vcc, 2, v212
s_cbranch_scc1 RET_h2
s_nop 1
s_cbranch_vccz RET_h2
s_branch SLOWL_h2
SLOW_h4:
s_mov_b32 s61, 0
SLOWL_h4:
buffer_load_dword v212, v215, s[20:23], s72 offen sc1
s_add_u32 s61, s61, 1
s_cmp_gt_u32 s61, 131072
s_waitcnt vmcnt(0)
v_cmp_gt_u32 vcc, 2, v212
s_cbranch_scc1 RET_h4
s_nop 1
s_cbranch_vccz RET_h4
s_branch SLOWL_h4
SLOW_y:
s_mov_b32 s61, 0
SLOWL_y:
buffer_load_dword v226, v227, s[20:23], s76 offen sc1
s_add_u32 s61, s61, 1
s_cmp_gt_u32 s61, 131072
s_waitcnt vmcnt(0)
v_cmp_gt_u32 vcc, 1, v226
s_cbranch_scc1 RET_y
s_nop 1
s_cbranch_vccz RET_y
s_branch SLOWL_y
SLOW_pa:
s_mov_b32 s61, 0
SLOWL_pa:
buffer_load_dword v251, v231, s[20:23], s72 offen sc1
s_add_u32 s61, s61, 1
s_cmp_gt_u32 s61, 131072
s_waitcnt vmcnt(0)
v_cmp_gt_u32 vcc, 1, v251
s_cbranch_scc1 RET_pa
s_nop 1
s_cbranch_vccz RET_pa
s_branch SLOWL_pa
SLOW_sb:
s_mov_b32 s61, 0
SLOWL_sb:
buffer_load_dwordx4 v[84:87], v243, s[20:23], s82 offen offset:0 sc1
buffer_load_dwordx4 v[88:91], v243, s[20:23], s82 offen offset:1024 sc1
s_add_u32 s61, s61, 1
s_cmp_gt_u32 s61, 131072
s_waitcnt vmcnt(0)
v_max3_u32 v226, v84, v85, v86
v_max3_u32 v226, v87, v88, v226
v_max3_u32 v226, v89, v90, v226
v_max3_u32 v226, v91, v91, v226
v_cmp_eq_u32 vcc, -1, v226
s_cbranch_scc1 RET_sb
s_nop 1
s_cbranch_vccz RET_sb
s_branch SLOWL_sb
SLOW_sc:
s_mov_b32 s61, 0
SLOWL_sc:
buffer_load_dwordx2 v[92:93], v247, s[20:23], s36 offen offset:0 sc1
buffer_load_dwordx2 v[94:95], v247, s[20:23], s36 offen offset:512 sc1
buffer_load_dwordx2 v[96:97], v247, s[20:23], s36 offen offset:1024 sc1
s_add_u32 s61, s61, 1
s_cmp_gt_u32 s61, 131072
s_waitcnt vmcnt(0)
v_max3_u32 v226, v92, v93, v94
v_max3_u32 v226, v95, v96, v226
v_max3_u32 v226, v97, v97, v226
v_cmp_eq_u32 vcc, -1, v226
s_cbranch_scc1 RET_sc
s_nop 1
s_cbranch_vccz RET_sc
s_branch SLOWL_sc
KF_done:

s_endpgm
.section .rodata,"a"
.p2align 6
.amdhsa_kernel gated_mix__ssm_conv_s4d__swiglu_ffn__prompt_kernel
  .amdhsa_next_free_vgpr 512
  .amdhsa_next_free_sgpr 102
  .amdhsa_accum_offset 256
  .amdhsa_group_segment_fixed_size 0
  .amdhsa_kernarg_size 120
  .amdhsa_user_sgpr_count 2
  .amdhsa_user_sgpr_kernarg_segment_ptr 1
  .amdhsa_system_sgpr_workgroup_id_x 1
  .amdhsa_float_denorm_mode_32 3
.end_amdhsa_kernel
```
